```python
import torch

def _softmax(x, axis=-1):
    return torch.softmax(x, dim=axis)
def _gelu(x):
    return torch.nn.functional.gelu(x, approximate="tanh")
def _silu(x):
    return torch.nn.functional.silu(x)
def _sigmoid(x):
    return torch.sigmoid(x)
def _layernorm(x, axis=-1, eps=1e-5):
    m = x.mean(dim=axis, keepdim=True)
    v = x.var(dim=axis, keepdim=True, unbiased=False)
    return (x - m) / torch.sqrt(v + eps)
def _scatter_add(tgt, idx, src, axis=0):
    return tgt.clone().index_add_(axis, idx, src)
def _segment_sum(src, seg, n):
    out = torch.zeros((n,) + src.shape[1:], dtype=src.dtype)
    return out.index_add_(0, seg, src)
def _pad(x, pw):
    flat = tuple(v for pair in reversed(pw) for v in pair)
    return torch.nn.functional.pad(x, flat)

kernel_name = 'gated_mix__softmax_full_mha__ssm_conv_s4__prompt'

def setup_inputs():

    _w = (lambda a: (lambda t: t.to(torch.bfloat16) if t.is_floating_point() else t)(torch.as_tensor(a)))
    def _A_setup():
        B, S, D = 1, 2048, 640
        return {
            "x": _w((lambda *s: torch.randn(*s, dtype=torch.bfloat16) * 0.05)(B, S, D)),
            "wqkv": _w((lambda *s: torch.randn(*s, dtype=torch.bfloat16) * 0.8)(D, 3 * D)),
            "wo": _w((lambda *s: torch.randn(*s, dtype=torch.bfloat16) * 0.05)(D, D)),
        }
    _A_in = _A_setup()

    def _B_setup():
        B, L, D, N = 1, 2048, 640, 128
        A_re = -(lambda _x: torch.exp(torch.as_tensor(_x)))((lambda *s: torch.randn(*s, dtype=torch.bfloat16) * 6.4)(D, N))
        A_im = torch.pi * (lambda *s: torch.randn(*s, dtype=torch.bfloat16) * 0.1)(D, N)
        B_re = (lambda *s: torch.randn(*s, dtype=torch.bfloat16) * 0.2)(D, N)
        B_im = (lambda *s: torch.randn(*s, dtype=torch.bfloat16) * 0.2)(D, N)
        C_re = (lambda *s: torch.randn(*s, dtype=torch.bfloat16) * 0.2)(D, N)
        C_im = (lambda *s: torch.randn(*s, dtype=torch.bfloat16) * 0.2)(D, N)
        log_dt = (lambda *s: torch.randn(*s, dtype=torch.bfloat16) * 0.1)(D) * 0.5 - 4.0
        Dskip = (lambda *s: torch.randn(*s, dtype=torch.bfloat16) * 0.1)(D)
        return {
            "u": _w((lambda *s: torch.randn(*s, dtype=torch.bfloat16) * 0.05)(B, L, D)),
            "A_re": _w(A_re),
            "A_im": _w(A_im),
            "B_re": _w(B_re),
            "B_im": _w(B_im),
            "C_re": _w(C_re),
            "C_im": _w(C_im),
            "log_dt": _w(log_dt),
            "Dskip": _w(Dskip),
        }
    _B_in = _B_setup()

    return {
        "A_x": _A_in["x"],
        "A_wqkv": _A_in["wqkv"],
        "A_wo": _A_in["wo"],
        "B_u": _B_in["u"],
        "B_A_re": _B_in["A_re"],
        "B_A_im": _B_in["A_im"],
        "B_B_re": _B_in["B_re"],
        "B_B_im": _B_in["B_im"],
        "B_C_re": _B_in["C_re"],
        "B_C_im": _B_in["C_im"],
        "B_log_dt": _B_in["log_dt"],
        "B_Dskip": _B_in["Dskip"],
        "gate_w": _w((lambda *s: torch.randn(*s, dtype=torch.bfloat16) * 0.05)(640) * 16.0),
    }

def reference(A_x, A_wqkv, A_wo, B_u, B_A_re, B_A_im, B_B_re, B_B_im, B_C_re, B_C_im, B_log_dt, B_Dskip, gate_w):
    def _A_ref(x, wqkv, wo):
        B, S, D = x.shape
        H = 32; Dh = D // H
        qkv = (lambda x, *d: x.permute(*d))((x @ wqkv).reshape(B, S, 3, H, Dh), 2, 0, 3, 1, 4)
        q, k, v = qkv[0], qkv[1], qkv[2]
        scale = Dh ** -0.5
        scores = torch.einsum("bhqd,bhkd->bhqk", q, k) * scale
        p = _softmax(scores, axis=-1)
        o = torch.einsum("bhqk,bhkd->bhqd", p, v)
        return (lambda x, *d: x.permute(*d))(o, 0, 2, 1, 3).reshape(B, S, D) @ wo

    def _B_ref(u, A_re, A_im, B_re, B_im, C_re, C_im, log_dt, Dskip):
        Bsz, L, D = u.shape
        dt = torch.exp(log_dt)[:, None]
        A = A_re + 1j * A_im
        Bc = B_re + 1j * B_im
        Cc = C_re + 1j * C_im
        logdA = dt * A
        dB = dt * Bc
        l = (lambda x, dt: x.to(dt))(torch.arange(L), A_re.dtype)
        P = torch.exp(logdA[:, :, None] * l[None, None, :])
        K = torch.einsum("dn,dnl,dn->dl", Cc, P, dB).real
        L2 = 2 * L
        Kp = _pad(K, ((0, 0), (0, L)))
        up = (lambda x, *d: x.permute(*d))(u, 0, 2, 1)
        up = _pad(up, ((0, 0), (0, 0), (0, L)))
        Kf = (lambda x, axes=(-2,-1): torch.fft.rfft2(x.float(), dim=axes))(Kp[:, None, :], axes=(-2, -1))
        Uf = (lambda x, axes=(-2,-1): torch.fft.rfft2(x.float(), dim=axes))(up[:, :, None, :], axes=(-2, -1))
        Yf = Uf * Kf[None, :, :, :]
        y = (lambda x, s, axes=(-2,-1): torch.fft.irfft2(x, s=s, dim=axes).to(torch.bfloat16))(Yf, (1, L2), axes=(-2, -1))[:, :, 0, :L]
        y = (lambda x, *d: x.permute(*d))(y, 0, 2, 1) + u * Dskip[None, None, :]
        return y

    x = A_x
    g = _sigmoid((x * gate_w).sum(-1, keepdims=True))
    a = _A_ref(x, A_wqkv, A_wo)
    b = _B_ref(x, B_A_re, B_A_im, B_B_re, B_B_im, B_C_re, B_C_im, B_log_dt, B_Dskip)
    return g * a + (1 - g) * b
```

```asm
; @launch grid=(256,1,1) block=(768,1,1) lds=163840
.amdgcn_target "amdgcn-amd-amdhsa--gfx950"
.text
.globl gated_mix__softmax_full_mha__ssm_conv_s4__prompt_kernel
.p2align 8
.type gated_mix__softmax_full_mha__ssm_conv_s4__prompt_kernel,@function
gated_mix__softmax_full_mha__ssm_conv_s4__prompt_kernel:
    s_cmp_ge_u32 s2, 256
    s_cbranch_scc1 K_END
    s_load_dwordx8 s[36:43], s[0:1], 0
    s_load_dwordx16 s[48:63], s[0:1], 32
    s_load_dwordx8 s[64:71], s[0:1], 96
    s_and_b32 s44, s2, 7
    s_lshl_b32 s44, s44, 2
    s_bfe_u32 s45, s2, 0x20003
    s_add_u32 s44, s44, s45
    s_lshr_b32 s45, s2, 5
    v_lshrrev_b32 v1, 6, v0
    v_and_b32 v0, 63, v0
    s_nop 0
    v_readfirstlane_b32 s3, v1
    s_nop 0
    s_cmp_eq_u32 s3, 11
    s_cbranch_scc1 K_LOADER
    s_cmp_ge_u32 s3, 8
    s_cbranch_scc1 K_KGEN
    s_setprio 3
    s_and_b32 s16, s2, 6
    s_lshl_b32 s16, s16, 1
    s_bfe_u32 s17, s2, 0x20003
    s_add_u32 s16, s16, s17
    s_and_b32 s17, s2, 1
    s_mul_i32 s18, s17, 5
    s_add_u32 s18, s18, 3
    s_mul_i32 s17, s17, 3
    s_cmp_lt_u32 s2, 96
    s_cselect_b32 s17, s17, s18
    s_lshr_b32 s18, s2, 5
    s_add_u32 s17, s17, s18
    s_mul_i32 s20, s16, 163840
    s_mul_i32 s21, s17, 240
    s_lshl_b32 s22, s3, 11
    s_and_b32 s18, s16, 3
    s_mul_i32 s18, s18, 5
    s_lshr_b32 s18, s18, 1
    s_add_u32 s18, s18, s17
    s_sub_u32 s29, s18, 4
    s_cmp_ge_u32 s17, 10
    s_cselect_b32 s18, s29, s18
    s_sub_u32 s29, s18, 10
    s_cmp_ge_u32 s18, 10
    s_cselect_b32 s18, s29, s18
    s_sub_u32 s29, s18, 10
    s_cmp_ge_u32 s18, 10
    s_cselect_b32 s29, s29, s18
    s_lshl_b32 s18, s29, 18
    v_lshrrev_b32 v6, 3, v0
    s_lshl_b32 s25, s3, 4
    v_add_u32 v6, s25, v6
    v_mul_u32_u24 v6, 1280, v6
    v_lshrrev_b32 v7, 4, v0
    v_and_b32 v8, 7, v0
    v_xor_b32 v9, v8, v7
    v_lshl_add_u32 v2, v9, 4, v6
    v_xor_b32 v9, 4, v9
    v_lshl_add_u32 v3, v9, 4, v6
    v_add_u32 v3, 10240, v3
    s_lshl_b32 s25, s3, 3
    v_add_u32 v6, s25, v7
    v_mul_u32_u24 v6, 3840, v6
    v_and_b32 v8, 15, v0
    v_lshlrev_b32 v9, 2, v7
    v_xor_b32 v9, v8, v9
    s_sub_u32 s28, 0, s17
    s_and_b32 s28, s28, 3
    v_subrev_u32 v9, s28, v9
    v_and_b32 v9, 15, v9
    s_cmp_lg_u32 s28, 0
    s_cselect_b32 s25, 15, 16
    v_cmp_ne_u32 vcc, s25, v9
    s_nop 1
    v_cndmask_b32 v9, 0, v9, vcc
    v_lshl_add_u32 v4, v9, 4, v6
    v_add_u32 v5, 15360, v4
    s_waitcnt lgkmcnt(0)
    s_mov_b32 s4, s36
    s_mov_b32 s5, s37
    s_mov_b32 s6, 0x280000
    s_mov_b32 s7, 0x00020000
    s_mov_b32 s8, s38
    s_mov_b32 s9, s39
    s_mov_b32 s10, 0x258000
    s_mov_b32 s11, 0x00020000
    s_lshl_b32 s23, s29, 7
    s_mul_i32 s24, s29, 245760
    s_add_u32 m0, s22, 0
    s_add_u32 s23, s23, s20
    buffer_load_dwordx4 v2, s[4:7], s23 offen lds
    s_add_u32 m0, s22, 1024
    s_add_u32 s24, s24, s21
    buffer_load_dwordx4 v3, s[4:7], s23 offen lds
    s_add_u32 m0, s22, 16384
    s_add_u32 s29, s29, 1
    buffer_load_dwordx4 v4, s[8:11], s24 offen lds
    s_add_u32 m0, s22, 17408
    s_cmp_eq_u32 s29, 10
    buffer_load_dwordx4 v5, s[8:11], s24 offen lds
    s_cselect_b32 s29, 0, s29
    s_lshl_b32 s23, s29, 7
    s_mul_i32 s24, s29, 245760
    s_add_u32 m0, s22, 32768
    s_add_u32 s23, s23, s20
    buffer_load_dwordx4 v2, s[4:7], s23 offen lds
    s_add_u32 m0, s22, 33792
    s_add_u32 s24, s24, s21
    buffer_load_dwordx4 v3, s[4:7], s23 offen lds
    s_add_u32 m0, s22, 49152
    s_add_u32 s29, s29, 1
    buffer_load_dwordx4 v4, s[8:11], s24 offen lds
    s_add_u32 m0, s22, 50176
    s_cmp_eq_u32 s29, 10
    buffer_load_dwordx4 v5, s[8:11], s24 offen lds
    s_cselect_b32 s29, 0, s29
    s_and_b32 s26, s3, 1
    s_lshr_b32 s27, s3, 1
    v_and_b32 v16, 31, v0
    v_lshrrev_b32 v17, 5, v0
    s_lshl_b32 s25, s26, 6
    v_add_u32 v18, s25, v16
    v_lshlrev_b32 v18, 7, v18
    v_bfe_u32 v19, v0, 1, 3
    v_xor_b32 v19, v19, v17
    v_xor_b32 v20, 0, v19
    v_lshl_add_u32 v6, v20, 4, v18
    v_add_u32 v10, 0x10000, v6
    v_xor_b32 v20, 2, v19
    v_lshl_add_u32 v7, v20, 4, v18
    v_add_u32 v11, 0x10000, v7
    v_xor_b32 v20, 4, v19
    v_lshl_add_u32 v8, v20, 4, v18
    v_add_u32 v12, 0x10000, v8
    v_xor_b32 v20, 6, v19
    v_lshl_add_u32 v9, v20, 4, v18
    v_add_u32 v13, 0x10000, v9
    v_bfe_u32 v20, v0, 2, 2
    v_lshl_add_u32 v21, v17, 3, v20
    v_lshlrev_b32 v21, 8, v21
    v_bfe_u32 v22, v0, 4, 1
    v_lshlrev_b32 v22, 1, v22
    v_bfe_u32 v23, v0, 1, 1
    v_add_u32 v22, v22, v23
    s_lshl_b32 s25, s27, 2
    s_add_u32 s25, s25, s28
    v_add_u32 v22, s25, v22
    v_and_b32 v22, 15, v22
    v_lshlrev_b32 v20, 2, v20
    v_xor_b32 v22, v22, v20
    v_lshl_add_u32 v21, v22, 4, v21
    v_and_b32 v23, 1, v0
    v_lshl_add_u32 v14, v23, 3, v21
    v_add_u32 v15, 0x10000, v14
    s_mov_b32 s12, s70
    s_mov_b32 s13, s71
    s_mov_b32 s14, 0x1680000
    s_mov_b32 s15, 0x00020000
    v_mov_b32 v160, 163584
    v_mov_b32 v162, 1
    s_waitcnt vmcnt(4)
    s_barrier
    ds_read_b128 v[48:51], v6 offset:0
    ds_read_b128 v[52:55], v6 offset:4096
    ds_read_b64_tr_b16 v[80:81], v14 offset:16384
    ds_read_b64_tr_b16 v[82:83], v14 offset:17408
    ds_read_b128 v[56:59], v7 offset:0
    ds_read_b128 v[60:63], v7 offset:4096
    ds_read_b64_tr_b16 v[84:85], v14 offset:20480
    ds_read_b64_tr_b16 v[86:87], v14 offset:21504
    ds_read_b128 v[64:67], v8 offset:0
    ds_read_b128 v[68:71], v8 offset:4096
    ds_read_b64_tr_b16 v[88:89], v14 offset:24576
    ds_read_b64_tr_b16 v[90:91], v14 offset:25600
    ds_read_b128 v[72:75], v9 offset:0
    ds_read_b128 v[76:79], v9 offset:4096
    ds_read_b64_tr_b16 v[92:93], v14 offset:28672
    ds_read_b64_tr_b16 v[94:95], v14 offset:29696
    s_lshl_b32 s23, s29, 7
    s_mul_i32 s24, s29, 245760
    s_add_u32 m0, s22, 65536
    s_add_u32 s23, s23, s20
    buffer_load_dwordx4 v2, s[4:7], s23 offen lds
    s_add_u32 m0, s22, 66560
    s_add_u32 s24, s24, s21
    buffer_load_dwordx4 v3, s[4:7], s23 offen lds
    s_add_u32 m0, s22, 81920
    s_add_u32 s29, s29, 1
    buffer_load_dwordx4 v4, s[8:11], s24 offen lds
    s_add_u32 m0, s22, 82944
    s_cmp_eq_u32 s29, 10
    buffer_load_dwordx4 v5, s[8:11], s24 offen lds
    s_cselect_b32 s29, 0, s29
    s_waitcnt vmcnt(4) lgkmcnt(0)
    s_barrier
    v_mfma_f32_32x32x16_bf16 v[16:31], v[80:83], v[48:51], 0
    ds_read_b128 v[96:99], v6 offset:32768
    ds_read_b128 v[100:103], v6 offset:36864
    ds_read_b64_tr_b16 v[128:129], v14 offset:49152
    s_lshl_b32 s23, s29, 7
    s_add_u32 m0, s22, 98304
    s_add_u32 s23, s23, s20
    buffer_load_dwordx4 v2, s[4:7], s23 offen lds
    v_mfma_f32_32x32x16_bf16 v[32:47], v[80:83], v[52:55], 0
    ds_read_b64_tr_b16 v[130:131], v14 offset:50176
    ds_read_b128 v[104:107], v7 offset:32768
    ds_read_b128 v[108:111], v7 offset:36864
    s_add_u32 m0, s22, 99328
    s_mul_i32 s24, s29, 245760
    buffer_load_dwordx4 v3, s[4:7], s23 offen lds
    v_mfma_f32_32x32x16_bf16 v[16:31], v[84:87], v[56:59], v[16:31]
    ds_read_b64_tr_b16 v[132:133], v14 offset:53248
    ds_read_b64_tr_b16 v[134:135], v14 offset:54272
    ds_read_b128 v[112:115], v8 offset:32768
    s_add_u32 m0, s22, 114688
    s_add_u32 s24, s24, s21
    buffer_load_dwordx4 v4, s[8:11], s24 offen lds
    s_add_u32 s29, s29, 1
    v_mfma_f32_32x32x16_bf16 v[32:47], v[84:87], v[60:63], v[32:47]
    ds_read_b128 v[116:119], v8 offset:36864
    ds_read_b64_tr_b16 v[136:137], v14 offset:57344
    ds_read_b64_tr_b16 v[138:139], v14 offset:58368
    s_add_u32 m0, s22, 115712
    s_cmp_eq_u32 s29, 10
    buffer_load_dwordx4 v5, s[8:11], s24 offen lds
    s_cselect_b32 s29, 0, s29
    v_mfma_f32_32x32x16_bf16 v[16:31], v[88:91], v[64:67], v[16:31]
    ds_read_b128 v[120:123], v9 offset:32768
    ds_read_b128 v[124:127], v9 offset:36864
    s_lshl_b32 s23, s29, 7
    s_add_u32 m0, s22, 0
    s_add_u32 s23, s23, s20
    buffer_load_dwordx4 v2, s[4:7], s23 offen lds
    v_mfma_f32_32x32x16_bf16 v[32:47], v[88:91], v[68:71], v[32:47]
    ds_read_b64_tr_b16 v[140:141], v14 offset:61440
    ds_read_b64_tr_b16 v[142:143], v14 offset:62464
    s_add_u32 m0, s22, 1024
    s_mul_i32 s24, s29, 245760
    buffer_load_dwordx4 v3, s[4:7], s23 offen lds
    v_mfma_f32_32x32x16_bf16 v[16:31], v[92:95], v[72:75], v[16:31]
    s_add_u32 m0, s22, 16384
    s_add_u32 s24, s24, s21
    buffer_load_dwordx4 v4, s[8:11], s24 offen lds
    s_add_u32 s29, s29, 1
    v_mfma_f32_32x32x16_bf16 v[32:47], v[92:95], v[76:79], v[32:47]
    s_add_u32 m0, s22, 17408
    s_cmp_eq_u32 s29, 10
    buffer_load_dwordx4 v5, s[8:11], s24 offen lds
    s_cselect_b32 s29, 0, s29
    s_waitcnt vmcnt(8) lgkmcnt(0)
    s_barrier
    v_mfma_f32_32x32x16_bf16 v[16:31], v[128:131], v[96:99], v[16:31]
    ds_read_b128 v[48:51], v10 offset:0
    ds_read_b128 v[52:55], v10 offset:4096
    ds_read_b64_tr_b16 v[80:81], v15 offset:16384
    v_mfma_f32_32x32x16_bf16 v[32:47], v[128:131], v[100:103], v[32:47]
    ds_read_b64_tr_b16 v[82:83], v15 offset:17408
    ds_read_b128 v[56:59], v11 offset:0
    ds_read_b128 v[60:63], v11 offset:4096
    v_mfma_f32_32x32x16_bf16 v[16:31], v[132:135], v[104:107], v[16:31]
    ds_read_b64_tr_b16 v[84:85], v15 offset:20480
    ds_read_b64_tr_b16 v[86:87], v15 offset:21504
    ds_read_b128 v[64:67], v12 offset:0
    v_mfma_f32_32x32x16_bf16 v[32:47], v[132:135], v[108:111], v[32:47]
    ds_read_b128 v[68:71], v12 offset:4096
    ds_read_b64_tr_b16 v[88:89], v15 offset:24576
    ds_read_b64_tr_b16 v[90:91], v15 offset:25600
    v_mfma_f32_32x32x16_bf16 v[16:31], v[136:139], v[112:115], v[16:31]
    ds_read_b128 v[72:75], v13 offset:0
    ds_read_b128 v[76:79], v13 offset:4096
    s_lshl_b32 s23, s29, 7
    s_add_u32 m0, s22, 32768
    s_add_u32 s23, s23, s20
    buffer_load_dwordx4 v2, s[4:7], s23 offen lds
    v_mfma_f32_32x32x16_bf16 v[32:47], v[136:139], v[116:119], v[32:47]
    ds_read_b64_tr_b16 v[92:93], v15 offset:28672
    ds_read_b64_tr_b16 v[94:95], v15 offset:29696
    s_add_u32 m0, s22, 33792
    s_mul_i32 s24, s29, 245760
    buffer_load_dwordx4 v3, s[4:7], s23 offen lds
    v_mfma_f32_32x32x16_bf16 v[16:31], v[140:143], v[120:123], v[16:31]
    s_add_u32 m0, s22, 49152
    s_add_u32 s24, s24, s21
    buffer_load_dwordx4 v4, s[8:11], s24 offen lds
    s_add_u32 s29, s29, 1
    v_mfma_f32_32x32x16_bf16 v[32:47], v[140:143], v[124:127], v[32:47]
    s_add_u32 m0, s22, 50176
    s_cmp_eq_u32 s29, 10
    buffer_load_dwordx4 v5, s[8:11], s24 offen lds
    s_cselect_b32 s29, 0, s29
    s_waitcnt vmcnt(8) lgkmcnt(0)
    s_barrier
    v_mfma_f32_32x32x16_bf16 v[16:31], v[80:83], v[48:51], v[16:31]
    ds_read_b128 v[96:99], v10 offset:32768
    ds_read_b128 v[100:103], v10 offset:36864
    ds_read_b64_tr_b16 v[128:129], v15 offset:49152
    v_mfma_f32_32x32x16_bf16 v[32:47], v[80:83], v[52:55], v[32:47]
    ds_read_b64_tr_b16 v[130:131], v15 offset:50176
    ds_read_b128 v[104:107], v11 offset:32768
    ds_read_b128 v[108:111], v11 offset:36864
    v_mfma_f32_32x32x16_bf16 v[16:31], v[84:87], v[56:59], v[16:31]
    ds_read_b64_tr_b16 v[132:133], v15 offset:53248
    ds_read_b64_tr_b16 v[134:135], v15 offset:54272
    ds_read_b128 v[112:115], v12 offset:32768
    v_mfma_f32_32x32x16_bf16 v[32:47], v[84:87], v[60:63], v[32:47]
    ds_read_b128 v[116:119], v12 offset:36864
    ds_read_b64_tr_b16 v[136:137], v15 offset:57344
    ds_read_b64_tr_b16 v[138:139], v15 offset:58368
    v_mfma_f32_32x32x16_bf16 v[16:31], v[88:91], v[64:67], v[16:31]
    ds_read_b128 v[120:123], v13 offset:32768
    ds_read_b128 v[124:127], v13 offset:36864
    s_lshl_b32 s23, s29, 7
    s_add_u32 m0, s22, 65536
    s_add_u32 s23, s23, s20
    buffer_load_dwordx4 v2, s[4:7], s23 offen lds
    v_mfma_f32_32x32x16_bf16 v[32:47], v[88:91], v[68:71], v[32:47]
    ds_read_b64_tr_b16 v[140:141], v15 offset:61440
    ds_read_b64_tr_b16 v[142:143], v15 offset:62464
    s_add_u32 m0, s22, 66560
    s_mul_i32 s24, s29, 245760
    buffer_load_dwordx4 v3, s[4:7], s23 offen lds
    v_mfma_f32_32x32x16_bf16 v[16:31], v[92:95], v[72:75], v[16:31]
    s_add_u32 m0, s22, 81920
    s_add_u32 s24, s24, s21
    buffer_load_dwordx4 v4, s[8:11], s24 offen lds
    s_add_u32 s29, s29, 1
    v_mfma_f32_32x32x16_bf16 v[32:47], v[92:95], v[76:79], v[32:47]
    s_add_u32 m0, s22, 82944
    s_cmp_eq_u32 s29, 10
    buffer_load_dwordx4 v5, s[8:11], s24 offen lds
    s_cselect_b32 s29, 0, s29
    s_waitcnt vmcnt(8) lgkmcnt(0)
    s_barrier
    v_mfma_f32_32x32x16_bf16 v[16:31], v[128:131], v[96:99], v[16:31]
    ds_read_b128 v[48:51], v6 offset:0
    ds_read_b128 v[52:55], v6 offset:4096
    ds_read_b64_tr_b16 v[80:81], v14 offset:16384
    v_mfma_f32_32x32x16_bf16 v[32:47], v[128:131], v[100:103], v[32:47]
    ds_read_b64_tr_b16 v[82:83], v14 offset:17408
    ds_read_b128 v[56:59], v7 offset:0
    ds_read_b128 v[60:63], v7 offset:4096
    v_mfma_f32_32x32x16_bf16 v[16:31], v[132:135], v[104:107], v[16:31]
    ds_read_b64_tr_b16 v[84:85], v14 offset:20480
    ds_read_b64_tr_b16 v[86:87], v14 offset:21504
    ds_read_b128 v[64:67], v8 offset:0
    v_mfma_f32_32x32x16_bf16 v[32:47], v[132:135], v[108:111], v[32:47]
    ds_read_b128 v[68:71], v8 offset:4096
    ds_read_b64_tr_b16 v[88:89], v14 offset:24576
    ds_read_b64_tr_b16 v[90:91], v14 offset:25600
    v_mfma_f32_32x32x16_bf16 v[16:31], v[136:139], v[112:115], v[16:31]
    ds_read_b128 v[72:75], v9 offset:0
    ds_read_b128 v[76:79], v9 offset:4096
    s_lshl_b32 s23, s29, 7
    s_add_u32 m0, s22, 98304
    s_add_u32 s23, s23, s20
    buffer_load_dwordx4 v2, s[4:7], s23 offen lds
    v_mfma_f32_32x32x16_bf16 v[32:47], v[136:139], v[116:119], v[32:47]
    ds_read_b64_tr_b16 v[92:93], v14 offset:28672
    ds_read_b64_tr_b16 v[94:95], v14 offset:29696
    s_add_u32 m0, s22, 99328
    s_mul_i32 s24, s29, 245760
    buffer_load_dwordx4 v3, s[4:7], s23 offen lds
    v_mfma_f32_32x32x16_bf16 v[16:31], v[140:143], v[120:123], v[16:31]
    s_add_u32 m0, s22, 114688
    s_add_u32 s24, s24, s21
    buffer_load_dwordx4 v4, s[8:11], s24 offen lds
    s_add_u32 s29, s29, 1
    v_mfma_f32_32x32x16_bf16 v[32:47], v[140:143], v[124:127], v[32:47]
    s_add_u32 m0, s22, 115712
    s_cmp_eq_u32 s29, 10
    buffer_load_dwordx4 v5, s[8:11], s24 offen lds
    s_cselect_b32 s29, 0, s29
    s_waitcnt vmcnt(8) lgkmcnt(0)
    s_barrier
    v_mfma_f32_32x32x16_bf16 v[16:31], v[80:83], v[48:51], v[16:31]
    ds_read_b128 v[96:99], v6 offset:32768
    ds_read_b128 v[100:103], v6 offset:36864
    ds_read_b64_tr_b16 v[128:129], v14 offset:49152
    v_mfma_f32_32x32x16_bf16 v[32:47], v[80:83], v[52:55], v[32:47]
    ds_read_b64_tr_b16 v[130:131], v14 offset:50176
    ds_read_b128 v[104:107], v7 offset:32768
    ds_read_b128 v[108:111], v7 offset:36864
    v_mfma_f32_32x32x16_bf16 v[16:31], v[84:87], v[56:59], v[16:31]
    ds_read_b64_tr_b16 v[132:133], v14 offset:53248
    ds_read_b64_tr_b16 v[134:135], v14 offset:54272
    ds_read_b128 v[112:115], v8 offset:32768
    v_mfma_f32_32x32x16_bf16 v[32:47], v[84:87], v[60:63], v[32:47]
    ds_read_b128 v[116:119], v8 offset:36864
    ds_read_b64_tr_b16 v[136:137], v14 offset:57344
    ds_read_b64_tr_b16 v[138:139], v14 offset:58368
    v_mfma_f32_32x32x16_bf16 v[16:31], v[88:91], v[64:67], v[16:31]
    ds_read_b128 v[120:123], v9 offset:32768
    ds_read_b128 v[124:127], v9 offset:36864
    s_lshl_b32 s23, s29, 7
    s_add_u32 m0, s22, 0
    s_add_u32 s23, s23, s20
    buffer_load_dwordx4 v2, s[4:7], s23 offen lds
    v_mfma_f32_32x32x16_bf16 v[32:47], v[88:91], v[68:71], v[32:47]
    ds_read_b64_tr_b16 v[140:141], v14 offset:61440
    ds_read_b64_tr_b16 v[142:143], v14 offset:62464
    s_add_u32 m0, s22, 1024
    s_mul_i32 s24, s29, 245760
    buffer_load_dwordx4 v3, s[4:7], s23 offen lds
    v_mfma_f32_32x32x16_bf16 v[16:31], v[92:95], v[72:75], v[16:31]
    s_add_u32 m0, s22, 16384
    s_add_u32 s24, s24, s21
    buffer_load_dwordx4 v4, s[8:11], s24 offen lds
    s_add_u32 s29, s29, 1
    v_mfma_f32_32x32x16_bf16 v[32:47], v[92:95], v[76:79], v[32:47]
    s_add_u32 m0, s22, 17408
    s_cmp_eq_u32 s29, 10
    buffer_load_dwordx4 v5, s[8:11], s24 offen lds
    s_cselect_b32 s29, 0, s29
    s_waitcnt vmcnt(8) lgkmcnt(0)
    s_barrier
    v_mfma_f32_32x32x16_bf16 v[16:31], v[128:131], v[96:99], v[16:31]
    ds_read_b128 v[48:51], v10 offset:0
    ds_read_b128 v[52:55], v10 offset:4096
    ds_read_b64_tr_b16 v[80:81], v15 offset:16384
    v_mfma_f32_32x32x16_bf16 v[32:47], v[128:131], v[100:103], v[32:47]
    ds_read_b64_tr_b16 v[82:83], v15 offset:17408
    ds_read_b128 v[56:59], v11 offset:0
    ds_read_b128 v[60:63], v11 offset:4096
    v_mfma_f32_32x32x16_bf16 v[16:31], v[132:135], v[104:107], v[16:31]
    ds_read_b64_tr_b16 v[84:85], v15 offset:20480
    ds_read_b64_tr_b16 v[86:87], v15 offset:21504
    ds_read_b128 v[64:67], v12 offset:0
    v_mfma_f32_32x32x16_bf16 v[32:47], v[132:135], v[108:111], v[32:47]
    ds_read_b128 v[68:71], v12 offset:4096
    ds_read_b64_tr_b16 v[88:89], v15 offset:24576
    ds_read_b64_tr_b16 v[90:91], v15 offset:25600
    v_mfma_f32_32x32x16_bf16 v[16:31], v[136:139], v[112:115], v[16:31]
    ds_read_b128 v[72:75], v13 offset:0
    ds_read_b128 v[76:79], v13 offset:4096
    s_lshl_b32 s23, s29, 7
    s_add_u32 m0, s22, 32768
    s_add_u32 s23, s23, s20
    buffer_load_dwordx4 v2, s[4:7], s23 offen lds
    v_mfma_f32_32x32x16_bf16 v[32:47], v[136:139], v[116:119], v[32:47]
    ds_read_b64_tr_b16 v[92:93], v15 offset:28672
    ds_read_b64_tr_b16 v[94:95], v15 offset:29696
    s_add_u32 m0, s22, 33792
    s_mul_i32 s24, s29, 245760
    buffer_load_dwordx4 v3, s[4:7], s23 offen lds
    v_mfma_f32_32x32x16_bf16 v[16:31], v[140:143], v[120:123], v[16:31]
    s_add_u32 m0, s22, 49152
    s_add_u32 s24, s24, s21
    buffer_load_dwordx4 v4, s[8:11], s24 offen lds
    s_add_u32 s29, s29, 1
    v_mfma_f32_32x32x16_bf16 v[32:47], v[140:143], v[124:127], v[32:47]
    s_add_u32 m0, s22, 50176
    s_cmp_eq_u32 s29, 10
    buffer_load_dwordx4 v5, s[8:11], s24 offen lds
    s_cselect_b32 s29, 0, s29
    s_waitcnt vmcnt(8) lgkmcnt(0)
    s_barrier
    v_mfma_f32_32x32x16_bf16 v[16:31], v[80:83], v[48:51], v[16:31]
    ds_read_b128 v[96:99], v10 offset:32768
    ds_read_b128 v[100:103], v10 offset:36864
    ds_read_b64_tr_b16 v[128:129], v15 offset:49152
    v_mfma_f32_32x32x16_bf16 v[32:47], v[80:83], v[52:55], v[32:47]
    ds_read_b64_tr_b16 v[130:131], v15 offset:50176
    ds_read_b128 v[104:107], v11 offset:32768
    ds_read_b128 v[108:111], v11 offset:36864
    v_mfma_f32_32x32x16_bf16 v[16:31], v[84:87], v[56:59], v[16:31]
    ds_read_b64_tr_b16 v[132:133], v15 offset:53248
    ds_read_b64_tr_b16 v[134:135], v15 offset:54272
    ds_read_b128 v[112:115], v12 offset:32768
    v_mfma_f32_32x32x16_bf16 v[32:47], v[84:87], v[60:63], v[32:47]
    ds_read_b128 v[116:119], v12 offset:36864
    ds_read_b64_tr_b16 v[136:137], v15 offset:57344
    ds_read_b64_tr_b16 v[138:139], v15 offset:58368
    v_mfma_f32_32x32x16_bf16 v[16:31], v[88:91], v[64:67], v[16:31]
    ds_read_b128 v[120:123], v13 offset:32768
    ds_read_b128 v[124:127], v13 offset:36864
    v_mfma_f32_32x32x16_bf16 v[32:47], v[88:91], v[68:71], v[32:47]
    ds_read_b64_tr_b16 v[140:141], v15 offset:61440
    ds_read_b64_tr_b16 v[142:143], v15 offset:62464
    v_and_b32 v163, 31, v0
    v_lshrrev_b32 v164, 5, v0
    s_lshl_b32 s25, s27, 3
    v_add_u32 v164, s25, v164
    s_mul_i32 s25, s26, 2560
    s_add_u32 s25, s25, 65536
    s_mul_i32 s30, s17, 6
    s_mov_b32 s31, 0x3ea52b5c
    v_add_u32 v165, 0, v164
    v_mul_u32_u24 v166, 52, v165
    v_lshrrev_b32 v166, 8, v166
    v_mul_u32_u24 v167, 5, v166
    v_sub_u32 v165, v165, v167
    v_add_u32 v167, s30, v166
    v_cmp_gt_u32 vcc, 6, v166
    v_cmp_gt_u32 s[4:5], 64, v167
    s_nop 0
    s_andn2_b64 s[6:7], vcc, s[4:5]
    s_and_b64 s[4:5], vcc, s[4:5]
    v_cmp_gt_u32 vcc, 32, v167
    v_mov_b32 v156, s31
    s_nop 0
    v_cndmask_b32 v156, 1.0, v156, vcc
    v_mul_u32_u24 v166, 5120, v166
    v_add_u32 v166, s25, v166
    v_lshl_add_u32 v152, v165, 6, v166
    v_and_b32 v167, 1, v165
    v_lshlrev_b32 v167, 9, v167
    v_lshl_add_u32 v167, v163, 4, v167
    v_lshrrev_b32 v148, 1, v165
    v_lshl_add_u32 v167, v148, 3, v167
    v_lshlrev_b32 v148, 3, v163
    v_add_u32 v148, 2048, v148
    v_cmp_eq_u32 vcc, 4, v165
    s_nop 1
    v_cndmask_b32 v167, v167, v148, vcc
    v_add_u32 v144, v166, v167
    v_cndmask_b32 v167, 4, 1, vcc
    v_lshlrev_b32 v167, 8, v167
    v_add_u32 v148, v144, v167
    v_add_u32 v165, 2, v164
    v_mul_u32_u24 v166, 52, v165
    v_lshrrev_b32 v166, 8, v166
    v_mul_u32_u24 v167, 5, v166
    v_sub_u32 v165, v165, v167
    v_add_u32 v167, s30, v166
    v_cmp_gt_u32 vcc, 6, v166
    v_cmp_gt_u32 s[8:9], 64, v167
    s_nop 0
    s_andn2_b64 s[10:11], vcc, s[8:9]
    s_and_b64 s[8:9], vcc, s[8:9]
    v_cmp_gt_u32 vcc, 32, v167
    v_mov_b32 v157, s31
    s_nop 0
    v_cndmask_b32 v157, 1.0, v157, vcc
    v_mul_u32_u24 v166, 5120, v166
    v_add_u32 v166, s25, v166
    v_lshl_add_u32 v153, v165, 6, v166
    v_and_b32 v167, 1, v165
    v_lshlrev_b32 v167, 9, v167
    v_lshl_add_u32 v167, v163, 4, v167
    v_lshrrev_b32 v149, 1, v165
    v_lshl_add_u32 v167, v149, 3, v167
    v_lshlrev_b32 v149, 3, v163
    v_add_u32 v149, 2048, v149
    v_cmp_eq_u32 vcc, 4, v165
    s_nop 1
    v_cndmask_b32 v167, v167, v149, vcc
    v_add_u32 v145, v166, v167
    v_cndmask_b32 v167, 4, 1, vcc
    v_lshlrev_b32 v167, 8, v167
    v_add_u32 v149, v145, v167
    v_add_u32 v165, 4, v164
    v_mul_u32_u24 v166, 52, v165
    v_lshrrev_b32 v166, 8, v166
    v_mul_u32_u24 v167, 5, v166
    v_sub_u32 v165, v165, v167
    v_add_u32 v167, s30, v166
    v_cmp_gt_u32 vcc, 6, v166
    v_cmp_gt_u32 s[36:37], 64, v167
    s_nop 0
    s_andn2_b64 s[38:39], vcc, s[36:37]
    s_and_b64 s[36:37], vcc, s[36:37]
    v_cmp_gt_u32 vcc, 32, v167
    v_mov_b32 v158, s31
    s_nop 0
    v_cndmask_b32 v158, 1.0, v158, vcc
    v_mul_u32_u24 v166, 5120, v166
    v_add_u32 v166, s25, v166
    v_lshl_add_u32 v154, v165, 6, v166
    v_and_b32 v167, 1, v165
    v_lshlrev_b32 v167, 9, v167
    v_lshl_add_u32 v167, v163, 4, v167
    v_lshrrev_b32 v150, 1, v165
    v_lshl_add_u32 v167, v150, 3, v167
    v_lshlrev_b32 v150, 3, v163
    v_add_u32 v150, 2048, v150
    v_cmp_eq_u32 vcc, 4, v165
    s_nop 1
    v_cndmask_b32 v167, v167, v150, vcc
    v_add_u32 v146, v166, v167
    v_cndmask_b32 v167, 4, 1, vcc
    v_lshlrev_b32 v167, 8, v167
    v_add_u32 v150, v146, v167
    v_add_u32 v165, 6, v164
    v_mul_u32_u24 v166, 52, v165
    v_lshrrev_b32 v166, 8, v166
    v_mul_u32_u24 v167, 5, v166
    v_sub_u32 v165, v165, v167
    v_add_u32 v167, s30, v166
    v_cmp_gt_u32 vcc, 6, v166
    v_cmp_gt_u32 s[40:41], 64, v167
    s_nop 0
    s_andn2_b64 s[42:43], vcc, s[40:41]
    s_and_b64 s[40:41], vcc, s[40:41]
    v_cmp_gt_u32 vcc, 32, v167
    v_mov_b32 v159, s31
    s_nop 0
    v_cndmask_b32 v159, 1.0, v159, vcc
    v_mul_u32_u24 v166, 5120, v166
    v_add_u32 v166, s25, v166
    v_lshl_add_u32 v155, v165, 6, v166
    v_and_b32 v167, 1, v165
    v_lshlrev_b32 v167, 9, v167
    v_lshl_add_u32 v167, v163, 4, v167
    v_lshrrev_b32 v151, 1, v165
    v_lshl_add_u32 v167, v151, 3, v167
    v_lshlrev_b32 v151, 3, v163
    v_add_u32 v151, 2048, v151
    v_cmp_eq_u32 vcc, 4, v165
    s_nop 1
    v_cndmask_b32 v167, v167, v151, vcc
    v_add_u32 v147, v166, v167
    v_cndmask_b32 v167, 4, 1, vcc
    v_lshlrev_b32 v167, 8, v167
    v_add_u32 v151, v147, v167
    v_bfe_u32 v165, v0, 4, 1
    v_mul_u32_u24 v165, 640, v165
    v_bfe_u32 v166, v0, 2, 1
    v_mul_u32_u24 v166, 320, v166
    v_add_u32 v165, v165, v166
    v_bfe_u32 v166, v0, 3, 1
    v_lshl_add_u32 v165, v166, 3, v165
    v_and_b32 v166, 3, v0
    v_lshl_add_u32 v165, v166, 1, v165
    v_add_u32 v152, v152, v165
    v_add_u32 v153, v153, v165
    v_add_u32 v154, v154, v165
    v_add_u32 v155, v155, v165
    v_mfma_f32_32x32x16_bf16 v[16:31], v[92:95], v[72:75], v[16:31]
    v_mfma_f32_32x32x16_bf16 v[32:47], v[92:95], v[76:79], v[32:47]
    s_waitcnt vmcnt(4) lgkmcnt(0)
    s_barrier
    v_mfma_f32_32x32x16_bf16 v[16:31], v[128:131], v[96:99], v[16:31]
    ds_read_b128 v[48:51], v6 offset:0
    ds_read_b128 v[52:55], v6 offset:4096
    ds_read_b64_tr_b16 v[80:81], v14 offset:16384
    v_mfma_f32_32x32x16_bf16 v[32:47], v[128:131], v[100:103], v[32:47]
    ds_read_b64_tr_b16 v[82:83], v14 offset:17408
    ds_read_b128 v[56:59], v7 offset:0
    ds_read_b128 v[60:63], v7 offset:4096
    v_mfma_f32_32x32x16_bf16 v[16:31], v[132:135], v[104:107], v[16:31]
    ds_read_b64_tr_b16 v[84:85], v14 offset:20480
    ds_read_b64_tr_b16 v[86:87], v14 offset:21504
    ds_read_b128 v[64:67], v8 offset:0
    v_mfma_f32_32x32x16_bf16 v[32:47], v[132:135], v[108:111], v[32:47]
    ds_read_b128 v[68:71], v8 offset:4096
    ds_read_b64_tr_b16 v[88:89], v14 offset:24576
    ds_read_b64_tr_b16 v[90:91], v14 offset:25600
    v_mfma_f32_32x32x16_bf16 v[16:31], v[136:139], v[112:115], v[16:31]
    ds_read_b128 v[72:75], v9 offset:0
    ds_read_b128 v[76:79], v9 offset:4096
    v_mfma_f32_32x32x16_bf16 v[32:47], v[136:139], v[116:119], v[32:47]
    ds_read_b64_tr_b16 v[92:93], v14 offset:28672
    ds_read_b64_tr_b16 v[94:95], v14 offset:29696
    v_mfma_f32_32x32x16_bf16 v[16:31], v[140:143], v[120:123], v[16:31]
    v_mfma_f32_32x32x16_bf16 v[32:47], v[140:143], v[124:127], v[32:47]
    s_waitcnt vmcnt(0) lgkmcnt(0)
    s_barrier
    v_mfma_f32_32x32x16_bf16 v[16:31], v[80:83], v[48:51], v[16:31]
    ds_read_b128 v[96:99], v6 offset:32768
    ds_read_b128 v[100:103], v6 offset:36864
    ds_read_b64_tr_b16 v[128:129], v14 offset:49152
    v_mfma_f32_32x32x16_bf16 v[32:47], v[80:83], v[52:55], v[32:47]
    ds_read_b64_tr_b16 v[130:131], v14 offset:50176
    ds_read_b128 v[104:107], v7 offset:32768
    ds_read_b128 v[108:111], v7 offset:36864
    v_mfma_f32_32x32x16_bf16 v[16:31], v[84:87], v[56:59], v[16:31]
    ds_read_b64_tr_b16 v[132:133], v14 offset:53248
    ds_read_b64_tr_b16 v[134:135], v14 offset:54272
    ds_read_b128 v[112:115], v8 offset:32768
    v_mfma_f32_32x32x16_bf16 v[32:47], v[84:87], v[60:63], v[32:47]
    ds_read_b128 v[116:119], v8 offset:36864
    ds_read_b64_tr_b16 v[136:137], v14 offset:57344
    ds_read_b64_tr_b16 v[138:139], v14 offset:58368
    v_mfma_f32_32x32x16_bf16 v[16:31], v[88:91], v[64:67], v[16:31]
    ds_read_b128 v[120:123], v9 offset:32768
    ds_read_b128 v[124:127], v9 offset:36864
    v_mfma_f32_32x32x16_bf16 v[32:47], v[88:91], v[68:71], v[32:47]
    ds_read_b64_tr_b16 v[140:141], v14 offset:61440
    ds_read_b64_tr_b16 v[142:143], v14 offset:62464
    v_mfma_f32_32x32x16_bf16 v[16:31], v[92:95], v[72:75], v[16:31]
    v_mfma_f32_32x32x16_bf16 v[32:47], v[92:95], v[76:79], v[32:47]
    s_waitcnt lgkmcnt(0)
    v_mfma_f32_32x32x16_bf16 v[16:31], v[128:131], v[96:99], v[16:31]
    v_mfma_f32_32x32x16_bf16 v[32:47], v[128:131], v[100:103], v[32:47]
    v_mfma_f32_32x32x16_bf16 v[16:31], v[132:135], v[104:107], v[16:31]
    v_mfma_f32_32x32x16_bf16 v[32:47], v[132:135], v[108:111], v[32:47]
    v_mfma_f32_32x32x16_bf16 v[16:31], v[136:139], v[112:115], v[16:31]
    v_mfma_f32_32x32x16_bf16 v[32:47], v[136:139], v[116:119], v[32:47]
    v_mfma_f32_32x32x16_bf16 v[16:31], v[140:143], v[120:123], v[16:31]
    v_mfma_f32_32x32x16_bf16 v[32:47], v[140:143], v[124:127], v[32:47]
    s_nop 10
    v_mul_f32 v16, v156, v16
    v_mul_f32 v17, v156, v17
    v_mul_f32 v18, v156, v18
    v_mul_f32 v19, v156, v19
    v_cvt_pk_bf16_f32 v48, v16, v17
    v_cvt_pk_bf16_f32 v49, v18, v19
    v_mul_f32 v32, v156, v32
    v_mul_f32 v33, v156, v33
    v_mul_f32 v34, v156, v34
    v_mul_f32 v35, v156, v35
    v_cvt_pk_bf16_f32 v50, v32, v33
    v_cvt_pk_bf16_f32 v51, v34, v35
    s_mov_b64 exec, s[4:5]
    s_cbranch_execz G_EV0
    ds_write_b64 v144, v[48:49]
    ds_write_b64 v148, v[50:51]
G_EV0:
    s_mov_b64 exec, s[6:7]
    s_cbranch_execz G_EN0
    ds_write_b16 v152, v48 offset:0
    ds_write_b16_d16_hi v152, v48 offset:16
    ds_write_b16 v152, v49 offset:32
    ds_write_b16_d16_hi v152, v49 offset:48
    ds_write_b16 v152, v50 offset:1280
    ds_write_b16_d16_hi v152, v50 offset:1296
    ds_write_b16 v152, v51 offset:1312
    ds_write_b16_d16_hi v152, v51 offset:1328
G_EN0:
    s_mov_b64 exec, -1
    v_mul_f32 v20, v157, v20
    v_mul_f32 v21, v157, v21
    v_mul_f32 v22, v157, v22
    v_mul_f32 v23, v157, v23
    v_cvt_pk_bf16_f32 v52, v20, v21
    v_cvt_pk_bf16_f32 v53, v22, v23
    v_mul_f32 v36, v157, v36
    v_mul_f32 v37, v157, v37
    v_mul_f32 v38, v157, v38
    v_mul_f32 v39, v157, v39
    v_cvt_pk_bf16_f32 v54, v36, v37
    v_cvt_pk_bf16_f32 v55, v38, v39
    s_mov_b64 exec, s[8:9]
    s_cbranch_execz G_EV1
    ds_write_b64 v145, v[52:53]
    ds_write_b64 v149, v[54:55]
G_EV1:
    s_mov_b64 exec, s[10:11]
    s_cbranch_execz G_EN1
    ds_write_b16 v153, v52 offset:0
    ds_write_b16_d16_hi v153, v52 offset:16
    ds_write_b16 v153, v53 offset:32
    ds_write_b16_d16_hi v153, v53 offset:48
    ds_write_b16 v153, v54 offset:1280
    ds_write_b16_d16_hi v153, v54 offset:1296
    ds_write_b16 v153, v55 offset:1312
    ds_write_b16_d16_hi v153, v55 offset:1328
G_EN1:
    s_mov_b64 exec, -1
    v_mul_f32 v24, v158, v24
    v_mul_f32 v25, v158, v25
    v_mul_f32 v26, v158, v26
    v_mul_f32 v27, v158, v27
    v_cvt_pk_bf16_f32 v56, v24, v25
    v_cvt_pk_bf16_f32 v57, v26, v27
    v_mul_f32 v40, v158, v40
    v_mul_f32 v41, v158, v41
    v_mul_f32 v42, v158, v42
    v_mul_f32 v43, v158, v43
    v_cvt_pk_bf16_f32 v58, v40, v41
    v_cvt_pk_bf16_f32 v59, v42, v43
    s_mov_b64 exec, s[36:37]
    s_cbranch_execz G_EV2
    ds_write_b64 v146, v[56:57]
    ds_write_b64 v150, v[58:59]
G_EV2:
    s_mov_b64 exec, s[38:39]
    s_cbranch_execz G_EN2
    ds_write_b16 v154, v56 offset:0
    ds_write_b16_d16_hi v154, v56 offset:16
    ds_write_b16 v154, v57 offset:32
    ds_write_b16_d16_hi v154, v57 offset:48
    ds_write_b16 v154, v58 offset:1280
    ds_write_b16_d16_hi v154, v58 offset:1296
    ds_write_b16 v154, v59 offset:1312
    ds_write_b16_d16_hi v154, v59 offset:1328
G_EN2:
    s_mov_b64 exec, -1
    v_mul_f32 v28, v159, v28
    v_mul_f32 v29, v159, v29
    v_mul_f32 v30, v159, v30
    v_mul_f32 v31, v159, v31
    v_cvt_pk_bf16_f32 v60, v28, v29
    v_cvt_pk_bf16_f32 v61, v30, v31
    v_mul_f32 v44, v159, v44
    v_mul_f32 v45, v159, v45
    v_mul_f32 v46, v159, v46
    v_mul_f32 v47, v159, v47
    v_cvt_pk_bf16_f32 v62, v44, v45
    v_cvt_pk_bf16_f32 v63, v46, v47
    s_mov_b64 exec, s[40:41]
    s_cbranch_execz G_EV3
    ds_write_b64 v147, v[60:61]
    ds_write_b64 v151, v[62:63]
G_EV3:
    s_mov_b64 exec, s[42:43]
    s_cbranch_execz G_EN3
    ds_write_b16 v155, v60 offset:0
    ds_write_b16_d16_hi v155, v60 offset:16
    ds_write_b16 v155, v61 offset:32
    ds_write_b16_d16_hi v155, v61 offset:48
    ds_write_b16 v155, v62 offset:1280
    ds_write_b16_d16_hi v155, v62 offset:1296
    ds_write_b16 v155, v63 offset:1312
    ds_write_b16_d16_hi v155, v63 offset:1328
G_EN3:
    s_mov_b64 exec, -1
    s_mov_b64 exec, 1
    s_waitcnt vmcnt(0) lgkmcnt(0)
    ds_add_u32 v160, v162 offset:68
    s_mov_b64 exec, -1
K_ATT:
    s_mov_b32 s16, s44
    s_lshl_b32 s18, s45, 3
    s_add_u32 s18, s18, s3
    s_mul_i32 s21, s16, 81920
    s_add_u32 s20, s21, 2621440
    s_lshr_b32 s22, s18, 1
    s_mul_i32 s22, s22, 2560
    s_add_u32 s21, s21, s22
    s_and_b32 s22, s18, 1
    s_lshl_b32 s23, s22, 8
    s_add_u32 s23, s23, s21
    s_lshl_b32 s22, s22, 10
    s_add_u32 s21, s21, s22
    v_and_b32 v2, 31, v0
    v_lshrrev_b32 v3, 5, v0
    v_lshlrev_b32 v4, 4, v0
    v_lshlrev_b32 v5, 3, v0
    v_mul_u32_u24 v6, 320, v3
    v_lshl_add_u32 v6, v2, 4, v6
    v_lshlrev_b32 v10, 3, v2
    v_mov_b32 v7, 163584
    s_mov_b32 s30, 0x000fffff
    s_mov_b32 s31, 0x000fffff
    v_mov_b32 v9, 0x3f803f80
    v_cmp_eq_u32 vcc, 20, v2
    s_nop 1
    v_cndmask_b32 v9, 0, v9, vcc
    v_mov_b32 v144, v4
    v_mov_b32 v145, v5
    v_mov_b32 v146, v6
    s_lshl_b32 s24, s3, 2
    v_add_u32 v12, s24, v7
    v_mov_b32 v13, 1
    s_setprio 0
    v_mov_b32 v128, v9
    v_mov_b32 v129, v9
    v_mov_b32 v130, v9
    v_mov_b32 v131, v9
    v_mov_b32 v132, v9
    v_mov_b32 v133, v9
    v_mov_b32 v134, v9
    v_mov_b32 v135, v9
    v_mov_b32 v136, v9
    v_mov_b32 v137, v9
    v_mov_b32 v138, v9
    v_mov_b32 v139, v9
    v_mov_b32 v140, v9
    v_mov_b32 v141, v9
    v_mov_b32 v142, v9
    v_mov_b32 v143, v9
    v_mov_b32 v80, 0
    v_mov_b32 v81, 0
    v_mov_b32 v82, 0
    v_mov_b32 v83, 0
    v_mov_b32 v84, 0
    v_mov_b32 v85, 0
    v_mov_b32 v86, 0
    v_mov_b32 v87, 0
    v_mov_b32 v88, 0
    v_mov_b32 v89, 0
    v_mov_b32 v90, 0
    v_mov_b32 v91, 0
    v_mov_b32 v92, 0
    v_mov_b32 v93, 0
    v_mov_b32 v94, 0
    v_mov_b32 v95, 0
LW1:
    ds_read_b32 v11, v7 offset:72
    s_waitcnt lgkmcnt(0)
    v_readfirstlane_b32 s34, v11
    s_nop 0
    s_cmp_ge_u32 s34, 1
    s_cbranch_scc1 LD2
    s_sleep 1
    s_branch LW1
LD2:
    buffer_load_dwordx2 v[116:117], v10, s[12:15], s23 offen offset:2048 sc1
    buffer_load_dwordx4 v[112:115], v4, s[12:15], s21 offen offset:0 sc1
LW3:
    ds_read_b32 v11, v7 offset:12
    s_waitcnt lgkmcnt(0)
    v_readfirstlane_b32 s47, v11
    s_nop 0
    s_cmp_ge_u32 s47, 1
    s_cbranch_scc1 LD4
    s_sleep 1
    s_branch LW3
LD4:
    ds_read_b64 v[118:119], v5 offset:2048
    ds_read_b128 v[120:123], v4
    ds_read_b128 v[124:127], v4 offset:1024
    s_mov_b64 exec, s[30:31]
    ds_read_b128 v[128:131], v6 offset:5120
    ds_read_b128 v[132:135], v6 offset:5760
    ds_read_b128 v[136:139], v6 offset:6400
    ds_read_b128 v[140:143], v6 offset:7040
    s_mov_b64 exec, -1
    s_cmp_lt_u32 s3, 4
    s_cbranch_scc1 AT_P0
    s_setprio 1
AT_P0:
    s_waitcnt vmcnt(0) lgkmcnt(6)
    v_mfma_f32_32x32x4_2b_bf16 v[16:47], v[118:119], v[116:117], 0
    ds_read_b64 v[118:119], v5 offset:4608
    s_waitcnt lgkmcnt(5)
    s_nop 15
    v_mfma_f32_32x32x16_bf16 v[16:31], v[120:123], v[112:115], v[16:31]
    v_mfma_f32_32x32x16_bf16 v[32:47], v[124:127], v[112:115], v[32:47]
    ds_read_b128 v[120:123], v4 offset:2560
    ds_read_b128 v[124:127], v4 offset:3584
    s_waitcnt lgkmcnt(0)
    s_cmp_lt_u32 s47, 2
    s_cbranch_scc1 AT_WAIT0
AT_BACK0:
    v_mfma_f32_32x32x4_2b_bf16 v[48:79], v[118:119], v[116:117], 0
    ds_read_b64 v[118:119], v5 offset:12288
    s_nop 3
    v_exp_f32 v16, v16
    v_exp_f32 v17, v17
    v_exp_f32 v18, v18
    v_exp_f32 v19, v19
    v_exp_f32 v20, v20
    v_exp_f32 v21, v21
    v_exp_f32 v22, v22
    v_exp_f32 v23, v23
    v_cvt_pk_bf16_f32 v96, v16, v17
    v_cvt_pk_bf16_f32 v97, v18, v19
    v_cvt_pk_bf16_f32 v98, v20, v21
    v_cvt_pk_bf16_f32 v99, v22, v23
    v_exp_f32 v24, v24
    v_exp_f32 v25, v25
    v_exp_f32 v26, v26
    v_exp_f32 v27, v27
    v_exp_f32 v28, v28
    v_exp_f32 v29, v29
    v_exp_f32 v30, v30
    v_exp_f32 v31, v31
    v_mfma_f32_32x32x16_bf16 v[80:95], v[128:131], v[96:99], v[80:95]
    v_cvt_pk_bf16_f32 v100, v24, v25
    v_cvt_pk_bf16_f32 v101, v26, v27
    v_cvt_pk_bf16_f32 v102, v28, v29
    v_cvt_pk_bf16_f32 v103, v30, v31
    v_exp_f32 v32, v32
    v_exp_f32 v33, v33
    v_exp_f32 v34, v34
    v_exp_f32 v35, v35
    v_exp_f32 v36, v36
    v_exp_f32 v37, v37
    v_exp_f32 v38, v38
    v_exp_f32 v39, v39
    v_mfma_f32_32x32x16_bf16 v[80:95], v[132:135], v[100:103], v[80:95]
    s_mov_b64 exec, s[30:31]
    ds_read_b128 v[128:131], v6 offset:7680
    ds_read_b128 v[132:135], v6 offset:8320
    s_mov_b64 exec, -1
    v_mfma_f32_32x32x16_bf16 v[48:63], v[120:123], v[112:115], v[48:63]
    ds_read_b128 v[120:123], v4 offset:10240
    v_cvt_pk_bf16_f32 v104, v32, v33
    v_cvt_pk_bf16_f32 v105, v34, v35
    v_cvt_pk_bf16_f32 v106, v36, v37
    v_cvt_pk_bf16_f32 v107, v38, v39
    v_exp_f32 v40, v40
    v_exp_f32 v41, v41
    v_exp_f32 v42, v42
    v_exp_f32 v43, v43
    v_mfma_f32_32x32x16_bf16 v[64:79], v[124:127], v[112:115], v[64:79]
    ds_read_b128 v[124:127], v4 offset:11264
    s_waitcnt lgkmcnt(5)
    v_exp_f32 v44, v44
    v_exp_f32 v45, v45
    v_exp_f32 v46, v46
    v_exp_f32 v47, v47
    v_mfma_f32_32x32x16_bf16 v[80:95], v[136:139], v[104:107], v[80:95]
    v_cvt_pk_bf16_f32 v108, v40, v41
    v_cvt_pk_bf16_f32 v109, v42, v43
    v_cvt_pk_bf16_f32 v110, v44, v45
    v_cvt_pk_bf16_f32 v111, v46, v47
    s_nop 1
    v_mfma_f32_32x32x16_bf16 v[80:95], v[140:143], v[108:111], v[80:95]
    s_mov_b64 exec, s[30:31]
    ds_read_b128 v[136:139], v6 offset:8960
    ds_read_b128 v[140:143], v6 offset:9600
    s_mov_b64 exec, -1
    s_waitcnt lgkmcnt(2)
    v_mfma_f32_32x32x4_2b_bf16 v[16:47], v[118:119], v[116:117], 0
    ds_read_b64 v[118:119], v5 offset:14848
    v_exp_f32 v48, v48
    v_exp_f32 v49, v49
    v_exp_f32 v50, v50
    v_exp_f32 v51, v51
    v_exp_f32 v52, v52
    v_exp_f32 v53, v53
    v_exp_f32 v54, v54
    v_exp_f32 v55, v55
    v_cvt_pk_bf16_f32 v96, v48, v49
    v_cvt_pk_bf16_f32 v97, v50, v51
    v_cvt_pk_bf16_f32 v98, v52, v53
    v_cvt_pk_bf16_f32 v99, v54, v55
    v_exp_f32 v56, v56
    v_exp_f32 v57, v57
    v_exp_f32 v58, v58
    v_exp_f32 v59, v59
    v_exp_f32 v60, v60
    v_exp_f32 v61, v61
    v_exp_f32 v62, v62
    v_exp_f32 v63, v63
    v_mfma_f32_32x32x16_bf16 v[80:95], v[128:131], v[96:99], v[80:95]
    v_cvt_pk_bf16_f32 v100, v56, v57
    v_cvt_pk_bf16_f32 v101, v58, v59
    v_cvt_pk_bf16_f32 v102, v60, v61
    v_cvt_pk_bf16_f32 v103, v62, v63
    v_exp_f32 v64, v64
    v_exp_f32 v65, v65
    v_exp_f32 v66, v66
    v_exp_f32 v67, v67
    v_exp_f32 v68, v68
    v_exp_f32 v69, v69
    v_exp_f32 v70, v70
    v_exp_f32 v71, v71
    v_mfma_f32_32x32x16_bf16 v[80:95], v[132:135], v[100:103], v[80:95]
    s_mov_b64 exec, s[30:31]
    ds_read_b128 v[128:131], v6 offset:15360
    ds_read_b128 v[132:135], v6 offset:16000
    s_mov_b64 exec, -1
    v_mfma_f32_32x32x16_bf16 v[16:31], v[120:123], v[112:115], v[16:31]
    ds_read_b128 v[120:123], v4 offset:12800
    v_cvt_pk_bf16_f32 v104, v64, v65
    v_cvt_pk_bf16_f32 v105, v66, v67
    v_cvt_pk_bf16_f32 v106, v68, v69
    v_cvt_pk_bf16_f32 v107, v70, v71
    v_exp_f32 v72, v72
    v_exp_f32 v73, v73
    v_exp_f32 v74, v74
    v_exp_f32 v75, v75
    v_mfma_f32_32x32x16_bf16 v[32:47], v[124:127], v[112:115], v[32:47]
    ds_read_b128 v[124:127], v4 offset:13824
    s_waitcnt lgkmcnt(5)
    v_exp_f32 v76, v76
    v_exp_f32 v77, v77
    v_exp_f32 v78, v78
    v_exp_f32 v79, v79
    v_mfma_f32_32x32x16_bf16 v[80:95], v[136:139], v[104:107], v[80:95]
    v_cvt_pk_bf16_f32 v108, v72, v73
    v_cvt_pk_bf16_f32 v109, v74, v75
    v_cvt_pk_bf16_f32 v110, v76, v77
    v_cvt_pk_bf16_f32 v111, v78, v79
    s_nop 1
    v_mfma_f32_32x32x16_bf16 v[80:95], v[140:143], v[108:111], v[80:95]
    s_mov_b64 exec, s[30:31]
    ds_read_b128 v[136:139], v6 offset:16640
    ds_read_b128 v[140:143], v6 offset:17280
    s_mov_b64 exec, -1
    s_waitcnt lgkmcnt(2)
    s_cmp_lt_u32 s47, 3
    s_cbranch_scc1 AT_WAIT2
AT_BACK2:
    v_mfma_f32_32x32x4_2b_bf16 v[48:79], v[118:119], v[116:117], 0
    ds_read_b64 v[118:119], v5 offset:22528
    v_exp_f32 v16, v16
    v_exp_f32 v17, v17
    v_exp_f32 v18, v18
    v_exp_f32 v19, v19
    v_exp_f32 v20, v20
    v_exp_f32 v21, v21
    v_exp_f32 v22, v22
    v_exp_f32 v23, v23
    v_cvt_pk_bf16_f32 v96, v16, v17
    v_cvt_pk_bf16_f32 v97, v18, v19
    v_cvt_pk_bf16_f32 v98, v20, v21
    v_cvt_pk_bf16_f32 v99, v22, v23
    v_exp_f32 v24, v24
    v_exp_f32 v25, v25
    v_exp_f32 v26, v26
    v_exp_f32 v27, v27
    v_exp_f32 v28, v28
    v_exp_f32 v29, v29
    v_exp_f32 v30, v30
    v_exp_f32 v31, v31
    v_mfma_f32_32x32x16_bf16 v[80:95], v[128:131], v[96:99], v[80:95]
    v_cvt_pk_bf16_f32 v100, v24, v25
    v_cvt_pk_bf16_f32 v101, v26, v27
    v_cvt_pk_bf16_f32 v102, v28, v29
    v_cvt_pk_bf16_f32 v103, v30, v31
    v_exp_f32 v32, v32
    v_exp_f32 v33, v33
    v_exp_f32 v34, v34
    v_exp_f32 v35, v35
    v_exp_f32 v36, v36
    v_exp_f32 v37, v37
    v_exp_f32 v38, v38
    v_exp_f32 v39, v39
    v_mfma_f32_32x32x16_bf16 v[80:95], v[132:135], v[100:103], v[80:95]
    s_mov_b64 exec, s[30:31]
    ds_read_b128 v[128:131], v6 offset:17920
    ds_read_b128 v[132:135], v6 offset:18560
    s_mov_b64 exec, -1
    v_mfma_f32_32x32x16_bf16 v[48:63], v[120:123], v[112:115], v[48:63]
    ds_read_b128 v[120:123], v4 offset:20480
    v_cvt_pk_bf16_f32 v104, v32, v33
    v_cvt_pk_bf16_f32 v105, v34, v35
    v_cvt_pk_bf16_f32 v106, v36, v37
    v_cvt_pk_bf16_f32 v107, v38, v39
    v_exp_f32 v40, v40
    v_exp_f32 v41, v41
    v_exp_f32 v42, v42
    v_exp_f32 v43, v43
    v_mfma_f32_32x32x16_bf16 v[64:79], v[124:127], v[112:115], v[64:79]
    ds_read_b128 v[124:127], v4 offset:21504
    s_waitcnt lgkmcnt(5)
    v_exp_f32 v44, v44
    v_exp_f32 v45, v45
    v_exp_f32 v46, v46
    v_exp_f32 v47, v47
    v_mfma_f32_32x32x16_bf16 v[80:95], v[136:139], v[104:107], v[80:95]
    v_cvt_pk_bf16_f32 v108, v40, v41
    v_cvt_pk_bf16_f32 v109, v42, v43
    v_cvt_pk_bf16_f32 v110, v44, v45
    v_cvt_pk_bf16_f32 v111, v46, v47
    s_nop 1
    v_mfma_f32_32x32x16_bf16 v[80:95], v[140:143], v[108:111], v[80:95]
    s_mov_b64 exec, s[30:31]
    ds_read_b128 v[136:139], v6 offset:19200
    ds_read_b128 v[140:143], v6 offset:19840
    s_mov_b64 exec, -1
    s_waitcnt lgkmcnt(2)
    v_mfma_f32_32x32x4_2b_bf16 v[16:47], v[118:119], v[116:117], 0
    ds_read_b64 v[118:119], v5 offset:25088
    v_exp_f32 v48, v48
    v_exp_f32 v49, v49
    v_exp_f32 v50, v50
    v_exp_f32 v51, v51
    v_exp_f32 v52, v52
    v_exp_f32 v53, v53
    v_exp_f32 v54, v54
    v_exp_f32 v55, v55
    v_cvt_pk_bf16_f32 v96, v48, v49
    v_cvt_pk_bf16_f32 v97, v50, v51
    v_cvt_pk_bf16_f32 v98, v52, v53
    v_cvt_pk_bf16_f32 v99, v54, v55
    v_exp_f32 v56, v56
    v_exp_f32 v57, v57
    v_exp_f32 v58, v58
    v_exp_f32 v59, v59
    v_exp_f32 v60, v60
    v_exp_f32 v61, v61
    v_exp_f32 v62, v62
    v_exp_f32 v63, v63
    v_mfma_f32_32x32x16_bf16 v[80:95], v[128:131], v[96:99], v[80:95]
    v_cvt_pk_bf16_f32 v100, v56, v57
    v_cvt_pk_bf16_f32 v101, v58, v59
    v_cvt_pk_bf16_f32 v102, v60, v61
    v_cvt_pk_bf16_f32 v103, v62, v63
    v_exp_f32 v64, v64
    v_exp_f32 v65, v65
    v_exp_f32 v66, v66
    v_exp_f32 v67, v67
    v_exp_f32 v68, v68
    v_exp_f32 v69, v69
    v_exp_f32 v70, v70
    v_exp_f32 v71, v71
    v_mfma_f32_32x32x16_bf16 v[80:95], v[132:135], v[100:103], v[80:95]
    s_mov_b64 exec, s[30:31]
    ds_read_b128 v[128:131], v6 offset:25600
    ds_read_b128 v[132:135], v6 offset:26240
    s_mov_b64 exec, -1
    v_mfma_f32_32x32x16_bf16 v[16:31], v[120:123], v[112:115], v[16:31]
    ds_read_b128 v[120:123], v4 offset:23040
    v_cvt_pk_bf16_f32 v104, v64, v65
    v_cvt_pk_bf16_f32 v105, v66, v67
    v_cvt_pk_bf16_f32 v106, v68, v69
    v_cvt_pk_bf16_f32 v107, v70, v71
    v_exp_f32 v72, v72
    v_exp_f32 v73, v73
    v_exp_f32 v74, v74
    v_exp_f32 v75, v75
    v_mfma_f32_32x32x16_bf16 v[32:47], v[124:127], v[112:115], v[32:47]
    ds_read_b128 v[124:127], v4 offset:24064
    s_waitcnt lgkmcnt(5)
    v_exp_f32 v76, v76
    v_exp_f32 v77, v77
    v_exp_f32 v78, v78
    v_exp_f32 v79, v79
    v_mfma_f32_32x32x16_bf16 v[80:95], v[136:139], v[104:107], v[80:95]
    v_cvt_pk_bf16_f32 v108, v72, v73
    v_cvt_pk_bf16_f32 v109, v74, v75
    v_cvt_pk_bf16_f32 v110, v76, v77
    v_cvt_pk_bf16_f32 v111, v78, v79
    s_nop 1
    v_mfma_f32_32x32x16_bf16 v[80:95], v[140:143], v[108:111], v[80:95]
    s_mov_b64 exec, s[30:31]
    ds_read_b128 v[136:139], v6 offset:26880
    ds_read_b128 v[140:143], v6 offset:27520
    s_mov_b64 exec, -1
    s_waitcnt lgkmcnt(2)
    s_cmp_lt_u32 s47, 4
    s_cbranch_scc1 AT_WAIT4
AT_BACK4:
    v_mfma_f32_32x32x4_2b_bf16 v[48:79], v[118:119], v[116:117], 0
    ds_read_b64 v[118:119], v5 offset:32768
    v_exp_f32 v16, v16
    v_exp_f32 v17, v17
    v_exp_f32 v18, v18
    v_exp_f32 v19, v19
    v_exp_f32 v20, v20
    v_exp_f32 v21, v21
    v_exp_f32 v22, v22
    v_exp_f32 v23, v23
    v_cvt_pk_bf16_f32 v96, v16, v17
    v_cvt_pk_bf16_f32 v97, v18, v19
    v_cvt_pk_bf16_f32 v98, v20, v21
    v_cvt_pk_bf16_f32 v99, v22, v23
    v_exp_f32 v24, v24
    v_exp_f32 v25, v25
    v_exp_f32 v26, v26
    v_exp_f32 v27, v27
    v_exp_f32 v28, v28
    v_exp_f32 v29, v29
    v_exp_f32 v30, v30
    v_exp_f32 v31, v31
    v_mfma_f32_32x32x16_bf16 v[80:95], v[128:131], v[96:99], v[80:95]
    v_cvt_pk_bf16_f32 v100, v24, v25
    v_cvt_pk_bf16_f32 v101, v26, v27
    v_cvt_pk_bf16_f32 v102, v28, v29
    v_cvt_pk_bf16_f32 v103, v30, v31
    v_exp_f32 v32, v32
    v_exp_f32 v33, v33
    v_exp_f32 v34, v34
    v_exp_f32 v35, v35
    v_exp_f32 v36, v36
    v_exp_f32 v37, v37
    v_exp_f32 v38, v38
    v_exp_f32 v39, v39
    v_mfma_f32_32x32x16_bf16 v[80:95], v[132:135], v[100:103], v[80:95]
    s_mov_b64 exec, s[30:31]
    ds_read_b128 v[128:131], v6 offset:28160
    ds_read_b128 v[132:135], v6 offset:28800
    s_mov_b64 exec, -1
    v_mfma_f32_32x32x16_bf16 v[48:63], v[120:123], v[112:115], v[48:63]
    ds_read_b128 v[120:123], v4 offset:30720
    v_cvt_pk_bf16_f32 v104, v32, v33
    v_cvt_pk_bf16_f32 v105, v34, v35
    v_cvt_pk_bf16_f32 v106, v36, v37
    v_cvt_pk_bf16_f32 v107, v38, v39
    v_exp_f32 v40, v40
    v_exp_f32 v41, v41
    v_exp_f32 v42, v42
    v_exp_f32 v43, v43
    v_mfma_f32_32x32x16_bf16 v[64:79], v[124:127], v[112:115], v[64:79]
    ds_read_b128 v[124:127], v4 offset:31744
    s_waitcnt lgkmcnt(5)
    v_exp_f32 v44, v44
    v_exp_f32 v45, v45
    v_exp_f32 v46, v46
    v_exp_f32 v47, v47
    v_mfma_f32_32x32x16_bf16 v[80:95], v[136:139], v[104:107], v[80:95]
    v_cvt_pk_bf16_f32 v108, v40, v41
    v_cvt_pk_bf16_f32 v109, v42, v43
    v_cvt_pk_bf16_f32 v110, v44, v45
    v_cvt_pk_bf16_f32 v111, v46, v47
    s_nop 1
    v_mfma_f32_32x32x16_bf16 v[80:95], v[140:143], v[108:111], v[80:95]
    s_mov_b64 exec, s[30:31]
    ds_read_b128 v[136:139], v6 offset:29440
    ds_read_b128 v[140:143], v6 offset:30080
    s_mov_b64 exec, -1
    s_waitcnt lgkmcnt(2)
    v_mfma_f32_32x32x4_2b_bf16 v[16:47], v[118:119], v[116:117], 0
    ds_read_b64 v[118:119], v5 offset:35328
    v_exp_f32 v48, v48
    v_exp_f32 v49, v49
    v_exp_f32 v50, v50
    v_exp_f32 v51, v51
    v_exp_f32 v52, v52
    v_exp_f32 v53, v53
    v_exp_f32 v54, v54
    v_exp_f32 v55, v55
    v_cvt_pk_bf16_f32 v96, v48, v49
    v_cvt_pk_bf16_f32 v97, v50, v51
    v_cvt_pk_bf16_f32 v98, v52, v53
    v_cvt_pk_bf16_f32 v99, v54, v55
    v_exp_f32 v56, v56
    v_exp_f32 v57, v57
    v_exp_f32 v58, v58
    v_exp_f32 v59, v59
    v_exp_f32 v60, v60
    v_exp_f32 v61, v61
    v_exp_f32 v62, v62
    v_exp_f32 v63, v63
    v_mfma_f32_32x32x16_bf16 v[80:95], v[128:131], v[96:99], v[80:95]
    v_cvt_pk_bf16_f32 v100, v56, v57
    v_cvt_pk_bf16_f32 v101, v58, v59
    v_cvt_pk_bf16_f32 v102, v60, v61
    v_cvt_pk_bf16_f32 v103, v62, v63
    v_exp_f32 v64, v64
    v_exp_f32 v65, v65
    v_exp_f32 v66, v66
    v_exp_f32 v67, v67
    v_exp_f32 v68, v68
    v_exp_f32 v69, v69
    v_exp_f32 v70, v70
    v_exp_f32 v71, v71
    v_mfma_f32_32x32x16_bf16 v[80:95], v[132:135], v[100:103], v[80:95]
    s_mov_b64 exec, s[30:31]
    ds_read_b128 v[128:131], v6 offset:35840
    ds_read_b128 v[132:135], v6 offset:36480
    s_mov_b64 exec, -1
    v_mfma_f32_32x32x16_bf16 v[16:31], v[120:123], v[112:115], v[16:31]
    ds_read_b128 v[120:123], v4 offset:33280
    v_cvt_pk_bf16_f32 v104, v64, v65
    v_cvt_pk_bf16_f32 v105, v66, v67
    v_cvt_pk_bf16_f32 v106, v68, v69
    v_cvt_pk_bf16_f32 v107, v70, v71
    v_exp_f32 v72, v72
    v_exp_f32 v73, v73
    v_exp_f32 v74, v74
    v_exp_f32 v75, v75
    v_mfma_f32_32x32x16_bf16 v[32:47], v[124:127], v[112:115], v[32:47]
    ds_read_b128 v[124:127], v4 offset:34304
    s_waitcnt lgkmcnt(5)
    v_exp_f32 v76, v76
    v_exp_f32 v77, v77
    v_exp_f32 v78, v78
    v_exp_f32 v79, v79
    v_mfma_f32_32x32x16_bf16 v[80:95], v[136:139], v[104:107], v[80:95]
    v_cvt_pk_bf16_f32 v108, v72, v73
    v_cvt_pk_bf16_f32 v109, v74, v75
    v_cvt_pk_bf16_f32 v110, v76, v77
    v_cvt_pk_bf16_f32 v111, v78, v79
    s_nop 1
    v_mfma_f32_32x32x16_bf16 v[80:95], v[140:143], v[108:111], v[80:95]
    s_mov_b64 exec, s[30:31]
    ds_read_b128 v[136:139], v6 offset:37120
    ds_read_b128 v[140:143], v6 offset:37760
    s_mov_b64 exec, -1
    s_waitcnt lgkmcnt(2)
    s_cmp_lt_u32 s47, 5
    s_cbranch_scc1 AT_WAIT6
AT_BACK6:
    v_mfma_f32_32x32x4_2b_bf16 v[48:79], v[118:119], v[116:117], 0
    ds_read_b64 v[118:119], v5 offset:43008
    v_exp_f32 v16, v16
    v_exp_f32 v17, v17
    v_exp_f32 v18, v18
    v_exp_f32 v19, v19
    v_exp_f32 v20, v20
    v_exp_f32 v21, v21
    v_exp_f32 v22, v22
    v_exp_f32 v23, v23
    v_cvt_pk_bf16_f32 v96, v16, v17
    v_cvt_pk_bf16_f32 v97, v18, v19
    v_cvt_pk_bf16_f32 v98, v20, v21
    v_cvt_pk_bf16_f32 v99, v22, v23
    v_exp_f32 v24, v24
    v_exp_f32 v25, v25
    v_exp_f32 v26, v26
    v_exp_f32 v27, v27
    v_exp_f32 v28, v28
    v_exp_f32 v29, v29
    v_exp_f32 v30, v30
    v_exp_f32 v31, v31
    v_mfma_f32_32x32x16_bf16 v[80:95], v[128:131], v[96:99], v[80:95]
    v_cvt_pk_bf16_f32 v100, v24, v25
    v_cvt_pk_bf16_f32 v101, v26, v27
    v_cvt_pk_bf16_f32 v102, v28, v29
    v_cvt_pk_bf16_f32 v103, v30, v31
    v_exp_f32 v32, v32
    v_exp_f32 v33, v33
    v_exp_f32 v34, v34
    v_exp_f32 v35, v35
    v_exp_f32 v36, v36
    v_exp_f32 v37, v37
    v_exp_f32 v38, v38
    v_exp_f32 v39, v39
    v_mfma_f32_32x32x16_bf16 v[80:95], v[132:135], v[100:103], v[80:95]
    s_mov_b64 exec, s[30:31]
    ds_read_b128 v[128:131], v6 offset:38400
    ds_read_b128 v[132:135], v6 offset:39040
    s_mov_b64 exec, -1
    v_mfma_f32_32x32x16_bf16 v[48:63], v[120:123], v[112:115], v[48:63]
    ds_read_b128 v[120:123], v4 offset:40960
    v_cvt_pk_bf16_f32 v104, v32, v33
    v_cvt_pk_bf16_f32 v105, v34, v35
    v_cvt_pk_bf16_f32 v106, v36, v37
    v_cvt_pk_bf16_f32 v107, v38, v39
    v_exp_f32 v40, v40
    v_exp_f32 v41, v41
    v_exp_f32 v42, v42
    v_exp_f32 v43, v43
    v_mfma_f32_32x32x16_bf16 v[64:79], v[124:127], v[112:115], v[64:79]
    ds_read_b128 v[124:127], v4 offset:41984
    s_waitcnt lgkmcnt(5)
    v_exp_f32 v44, v44
    v_exp_f32 v45, v45
    v_exp_f32 v46, v46
    v_exp_f32 v47, v47
    v_mfma_f32_32x32x16_bf16 v[80:95], v[136:139], v[104:107], v[80:95]
    v_cvt_pk_bf16_f32 v108, v40, v41
    v_cvt_pk_bf16_f32 v109, v42, v43
    v_cvt_pk_bf16_f32 v110, v44, v45
    v_cvt_pk_bf16_f32 v111, v46, v47
    s_nop 1
    v_mfma_f32_32x32x16_bf16 v[80:95], v[140:143], v[108:111], v[80:95]
    s_mov_b64 exec, s[30:31]
    ds_read_b128 v[136:139], v6 offset:39680
    ds_read_b128 v[140:143], v6 offset:40320
    s_mov_b64 exec, -1
    s_waitcnt lgkmcnt(2)
    v_mfma_f32_32x32x4_2b_bf16 v[16:47], v[118:119], v[116:117], 0
    ds_read_b64 v[118:119], v5 offset:45568
    v_exp_f32 v48, v48
    v_exp_f32 v49, v49
    v_exp_f32 v50, v50
    v_exp_f32 v51, v51
    v_exp_f32 v52, v52
    v_exp_f32 v53, v53
    v_exp_f32 v54, v54
    v_exp_f32 v55, v55
    v_cvt_pk_bf16_f32 v96, v48, v49
    v_cvt_pk_bf16_f32 v97, v50, v51
    v_cvt_pk_bf16_f32 v98, v52, v53
    v_cvt_pk_bf16_f32 v99, v54, v55
    v_exp_f32 v56, v56
    v_exp_f32 v57, v57
    v_exp_f32 v58, v58
    v_exp_f32 v59, v59
    v_exp_f32 v60, v60
    v_exp_f32 v61, v61
    v_exp_f32 v62, v62
    v_exp_f32 v63, v63
    v_mfma_f32_32x32x16_bf16 v[80:95], v[128:131], v[96:99], v[80:95]
    v_cvt_pk_bf16_f32 v100, v56, v57
    v_cvt_pk_bf16_f32 v101, v58, v59
    v_cvt_pk_bf16_f32 v102, v60, v61
    v_cvt_pk_bf16_f32 v103, v62, v63
    v_exp_f32 v64, v64
    v_exp_f32 v65, v65
    v_exp_f32 v66, v66
    v_exp_f32 v67, v67
    v_exp_f32 v68, v68
    v_exp_f32 v69, v69
    v_exp_f32 v70, v70
    v_exp_f32 v71, v71
    v_mfma_f32_32x32x16_bf16 v[80:95], v[132:135], v[100:103], v[80:95]
    s_mov_b64 exec, s[30:31]
    ds_read_b128 v[128:131], v6 offset:46080
    ds_read_b128 v[132:135], v6 offset:46720
    s_mov_b64 exec, -1
    v_mfma_f32_32x32x16_bf16 v[16:31], v[120:123], v[112:115], v[16:31]
    ds_read_b128 v[120:123], v4 offset:43520
    v_cvt_pk_bf16_f32 v104, v64, v65
    v_cvt_pk_bf16_f32 v105, v66, v67
    v_cvt_pk_bf16_f32 v106, v68, v69
    v_cvt_pk_bf16_f32 v107, v70, v71
    v_exp_f32 v72, v72
    v_exp_f32 v73, v73
    v_exp_f32 v74, v74
    v_exp_f32 v75, v75
    v_mfma_f32_32x32x16_bf16 v[32:47], v[124:127], v[112:115], v[32:47]
    ds_read_b128 v[124:127], v4 offset:44544
    s_waitcnt lgkmcnt(5)
    v_exp_f32 v76, v76
    v_exp_f32 v77, v77
    v_exp_f32 v78, v78
    v_exp_f32 v79, v79
    v_mfma_f32_32x32x16_bf16 v[80:95], v[136:139], v[104:107], v[80:95]
    v_cvt_pk_bf16_f32 v108, v72, v73
    v_cvt_pk_bf16_f32 v109, v74, v75
    v_cvt_pk_bf16_f32 v110, v76, v77
    v_cvt_pk_bf16_f32 v111, v78, v79
    s_nop 1
    v_mfma_f32_32x32x16_bf16 v[80:95], v[140:143], v[108:111], v[80:95]
    s_mov_b64 exec, s[30:31]
    ds_read_b128 v[136:139], v6 offset:47360
    ds_read_b128 v[140:143], v6 offset:48000
    s_mov_b64 exec, -1
    s_waitcnt lgkmcnt(2)
    v_mov_b32 v13, 1
    ds_write_b32 v12, v13 offset:32
    s_cmp_lt_u32 s47, 6
    s_cbranch_scc1 AT_WAIT8
AT_BACK8:
    v_mfma_f32_32x32x4_2b_bf16 v[48:79], v[118:119], v[116:117], 0
    ds_read_b64 v[118:119], v5 offset:53248
    v_exp_f32 v16, v16
    v_exp_f32 v17, v17
    v_exp_f32 v18, v18
    v_exp_f32 v19, v19
    v_exp_f32 v20, v20
    v_exp_f32 v21, v21
    v_exp_f32 v22, v22
    v_exp_f32 v23, v23
    v_cvt_pk_bf16_f32 v96, v16, v17
    v_cvt_pk_bf16_f32 v97, v18, v19
    v_cvt_pk_bf16_f32 v98, v20, v21
    v_cvt_pk_bf16_f32 v99, v22, v23
    v_exp_f32 v24, v24
    v_exp_f32 v25, v25
    v_exp_f32 v26, v26
    v_exp_f32 v27, v27
    v_exp_f32 v28, v28
    v_exp_f32 v29, v29
    v_exp_f32 v30, v30
    v_exp_f32 v31, v31
    v_mfma_f32_32x32x16_bf16 v[80:95], v[128:131], v[96:99], v[80:95]
    v_cvt_pk_bf16_f32 v100, v24, v25
    v_cvt_pk_bf16_f32 v101, v26, v27
    v_cvt_pk_bf16_f32 v102, v28, v29
    v_cvt_pk_bf16_f32 v103, v30, v31
    v_exp_f32 v32, v32
    v_exp_f32 v33, v33
    v_exp_f32 v34, v34
    v_exp_f32 v35, v35
    v_exp_f32 v36, v36
    v_exp_f32 v37, v37
    v_exp_f32 v38, v38
    v_exp_f32 v39, v39
    v_mfma_f32_32x32x16_bf16 v[80:95], v[132:135], v[100:103], v[80:95]
    s_mov_b64 exec, s[30:31]
    ds_read_b128 v[128:131], v6 offset:48640
    ds_read_b128 v[132:135], v6 offset:49280
    s_mov_b64 exec, -1
    v_mfma_f32_32x32x16_bf16 v[48:63], v[120:123], v[112:115], v[48:63]
    ds_read_b128 v[120:123], v4 offset:51200
    v_cvt_pk_bf16_f32 v104, v32, v33
    v_cvt_pk_bf16_f32 v105, v34, v35
    v_cvt_pk_bf16_f32 v106, v36, v37
    v_cvt_pk_bf16_f32 v107, v38, v39
    v_exp_f32 v40, v40
    v_exp_f32 v41, v41
    v_exp_f32 v42, v42
    v_exp_f32 v43, v43
    v_mfma_f32_32x32x16_bf16 v[64:79], v[124:127], v[112:115], v[64:79]
    ds_read_b128 v[124:127], v4 offset:52224
    s_waitcnt lgkmcnt(5)
    v_exp_f32 v44, v44
    v_exp_f32 v45, v45
    v_exp_f32 v46, v46
    v_exp_f32 v47, v47
    v_mfma_f32_32x32x16_bf16 v[80:95], v[136:139], v[104:107], v[80:95]
    v_cvt_pk_bf16_f32 v108, v40, v41
    v_cvt_pk_bf16_f32 v109, v42, v43
    v_cvt_pk_bf16_f32 v110, v44, v45
    v_cvt_pk_bf16_f32 v111, v46, v47
    s_nop 1
    v_mfma_f32_32x32x16_bf16 v[80:95], v[140:143], v[108:111], v[80:95]
    s_mov_b64 exec, s[30:31]
    ds_read_b128 v[136:139], v6 offset:49920
    ds_read_b128 v[140:143], v6 offset:50560
    s_mov_b64 exec, -1
    s_waitcnt lgkmcnt(2)
    v_mfma_f32_32x32x4_2b_bf16 v[16:47], v[118:119], v[116:117], 0
    ds_read_b64 v[118:119], v5 offset:55808
    v_exp_f32 v48, v48
    v_exp_f32 v49, v49
    v_exp_f32 v50, v50
    v_exp_f32 v51, v51
    v_exp_f32 v52, v52
    v_exp_f32 v53, v53
    v_exp_f32 v54, v54
    v_exp_f32 v55, v55
    v_cvt_pk_bf16_f32 v96, v48, v49
    v_cvt_pk_bf16_f32 v97, v50, v51
    v_cvt_pk_bf16_f32 v98, v52, v53
    v_cvt_pk_bf16_f32 v99, v54, v55
    v_exp_f32 v56, v56
    v_exp_f32 v57, v57
    v_exp_f32 v58, v58
    v_exp_f32 v59, v59
    v_exp_f32 v60, v60
    v_exp_f32 v61, v61
    v_exp_f32 v62, v62
    v_exp_f32 v63, v63
    v_mfma_f32_32x32x16_bf16 v[80:95], v[128:131], v[96:99], v[80:95]
    v_cvt_pk_bf16_f32 v100, v56, v57
    v_cvt_pk_bf16_f32 v101, v58, v59
    v_cvt_pk_bf16_f32 v102, v60, v61
    v_cvt_pk_bf16_f32 v103, v62, v63
    v_exp_f32 v64, v64
    v_exp_f32 v65, v65
    v_exp_f32 v66, v66
    v_exp_f32 v67, v67
    v_exp_f32 v68, v68
    v_exp_f32 v69, v69
    v_exp_f32 v70, v70
    v_exp_f32 v71, v71
    v_mfma_f32_32x32x16_bf16 v[80:95], v[132:135], v[100:103], v[80:95]
    s_mov_b64 exec, s[30:31]
    ds_read_b128 v[128:131], v6 offset:56320
    ds_read_b128 v[132:135], v6 offset:56960
    s_mov_b64 exec, -1
    v_mfma_f32_32x32x16_bf16 v[16:31], v[120:123], v[112:115], v[16:31]
    ds_read_b128 v[120:123], v4 offset:53760
    v_cvt_pk_bf16_f32 v104, v64, v65
    v_cvt_pk_bf16_f32 v105, v66, v67
    v_cvt_pk_bf16_f32 v106, v68, v69
    v_cvt_pk_bf16_f32 v107, v70, v71
    v_exp_f32 v72, v72
    v_exp_f32 v73, v73
    v_exp_f32 v74, v74
    v_exp_f32 v75, v75
    v_mfma_f32_32x32x16_bf16 v[32:47], v[124:127], v[112:115], v[32:47]
    ds_read_b128 v[124:127], v4 offset:54784
    s_waitcnt lgkmcnt(5)
    v_exp_f32 v76, v76
    v_exp_f32 v77, v77
    v_exp_f32 v78, v78
    v_exp_f32 v79, v79
    v_mfma_f32_32x32x16_bf16 v[80:95], v[136:139], v[104:107], v[80:95]
    v_cvt_pk_bf16_f32 v108, v72, v73
    v_cvt_pk_bf16_f32 v109, v74, v75
    v_cvt_pk_bf16_f32 v110, v76, v77
    v_cvt_pk_bf16_f32 v111, v78, v79
    s_nop 1
    v_mfma_f32_32x32x16_bf16 v[80:95], v[140:143], v[108:111], v[80:95]
    s_mov_b64 exec, s[30:31]
    ds_read_b128 v[136:139], v6 offset:57600
    ds_read_b128 v[140:143], v6 offset:58240
    s_mov_b64 exec, -1
    s_waitcnt lgkmcnt(2)
    s_cmp_lt_u32 s47, 7
    s_cbranch_scc1 AT_WAIT10
AT_BACK10:
    v_mfma_f32_32x32x4_2b_bf16 v[48:79], v[118:119], v[116:117], 0
    ds_read_b64 v[118:119], v5 offset:63488
    v_exp_f32 v16, v16
    v_exp_f32 v17, v17
    v_exp_f32 v18, v18
    v_exp_f32 v19, v19
    v_exp_f32 v20, v20
    v_exp_f32 v21, v21
    v_exp_f32 v22, v22
    v_exp_f32 v23, v23
    v_cvt_pk_bf16_f32 v96, v16, v17
    v_cvt_pk_bf16_f32 v97, v18, v19
    v_cvt_pk_bf16_f32 v98, v20, v21
    v_cvt_pk_bf16_f32 v99, v22, v23
    v_exp_f32 v24, v24
    v_exp_f32 v25, v25
    v_exp_f32 v26, v26
    v_exp_f32 v27, v27
    v_exp_f32 v28, v28
    v_exp_f32 v29, v29
    v_exp_f32 v30, v30
    v_exp_f32 v31, v31
    v_mfma_f32_32x32x16_bf16 v[80:95], v[128:131], v[96:99], v[80:95]
    v_cvt_pk_bf16_f32 v100, v24, v25
    v_cvt_pk_bf16_f32 v101, v26, v27
    v_cvt_pk_bf16_f32 v102, v28, v29
    v_cvt_pk_bf16_f32 v103, v30, v31
    v_exp_f32 v32, v32
    v_exp_f32 v33, v33
    v_exp_f32 v34, v34
    v_exp_f32 v35, v35
    v_exp_f32 v36, v36
    v_exp_f32 v37, v37
    v_exp_f32 v38, v38
    v_exp_f32 v39, v39
    v_mfma_f32_32x32x16_bf16 v[80:95], v[132:135], v[100:103], v[80:95]
    s_mov_b64 exec, s[30:31]
    ds_read_b128 v[128:131], v6 offset:58880
    ds_read_b128 v[132:135], v6 offset:59520
    s_mov_b64 exec, -1
    v_mfma_f32_32x32x16_bf16 v[48:63], v[120:123], v[112:115], v[48:63]
    ds_read_b128 v[120:123], v4 offset:61440
    v_cvt_pk_bf16_f32 v104, v32, v33
    v_cvt_pk_bf16_f32 v105, v34, v35
    v_cvt_pk_bf16_f32 v106, v36, v37
    v_cvt_pk_bf16_f32 v107, v38, v39
    v_exp_f32 v40, v40
    v_exp_f32 v41, v41
    v_exp_f32 v42, v42
    v_exp_f32 v43, v43
    v_mfma_f32_32x32x16_bf16 v[64:79], v[124:127], v[112:115], v[64:79]
    ds_read_b128 v[124:127], v4 offset:62464
    s_waitcnt lgkmcnt(5)
    v_exp_f32 v44, v44
    v_exp_f32 v45, v45
    v_exp_f32 v46, v46
    v_exp_f32 v47, v47
    v_mfma_f32_32x32x16_bf16 v[80:95], v[136:139], v[104:107], v[80:95]
    v_cvt_pk_bf16_f32 v108, v40, v41
    v_cvt_pk_bf16_f32 v109, v42, v43
    v_cvt_pk_bf16_f32 v110, v44, v45
    v_cvt_pk_bf16_f32 v111, v46, v47
    s_nop 1
    v_mfma_f32_32x32x16_bf16 v[80:95], v[140:143], v[108:111], v[80:95]
    s_mov_b64 exec, s[30:31]
    ds_read_b128 v[136:139], v6 offset:60160
    ds_read_b128 v[140:143], v6 offset:60800
    s_mov_b64 exec, -1
    v_add_u32 v4, 61440, v4
    v_add_u32 v5, 61440, v5
    v_add_u32 v6, 61440, v6
    s_waitcnt lgkmcnt(2)
    v_mfma_f32_32x32x4_2b_bf16 v[16:47], v[118:119], v[116:117], 0
    ds_read_b64 v[118:119], v5 offset:4608
    v_exp_f32 v48, v48
    v_exp_f32 v49, v49
    v_exp_f32 v50, v50
    v_exp_f32 v51, v51
    v_exp_f32 v52, v52
    v_exp_f32 v53, v53
    v_exp_f32 v54, v54
    v_exp_f32 v55, v55
    v_cvt_pk_bf16_f32 v96, v48, v49
    v_cvt_pk_bf16_f32 v97, v50, v51
    v_cvt_pk_bf16_f32 v98, v52, v53
    v_cvt_pk_bf16_f32 v99, v54, v55
    v_exp_f32 v56, v56
    v_exp_f32 v57, v57
    v_exp_f32 v58, v58
    v_exp_f32 v59, v59
    v_exp_f32 v60, v60
    v_exp_f32 v61, v61
    v_exp_f32 v62, v62
    v_exp_f32 v63, v63
    v_mfma_f32_32x32x16_bf16 v[80:95], v[128:131], v[96:99], v[80:95]
    v_cvt_pk_bf16_f32 v100, v56, v57
    v_cvt_pk_bf16_f32 v101, v58, v59
    v_cvt_pk_bf16_f32 v102, v60, v61
    v_cvt_pk_bf16_f32 v103, v62, v63
    v_exp_f32 v64, v64
    v_exp_f32 v65, v65
    v_exp_f32 v66, v66
    v_exp_f32 v67, v67
    v_exp_f32 v68, v68
    v_exp_f32 v69, v69
    v_exp_f32 v70, v70
    v_exp_f32 v71, v71
    v_mfma_f32_32x32x16_bf16 v[80:95], v[132:135], v[100:103], v[80:95]
    s_mov_b64 exec, s[30:31]
    ds_read_b128 v[128:131], v6 offset:5120
    ds_read_b128 v[132:135], v6 offset:5760
    s_mov_b64 exec, -1
    v_mfma_f32_32x32x16_bf16 v[16:31], v[120:123], v[112:115], v[16:31]
    ds_read_b128 v[120:123], v4 offset:2560
    v_cvt_pk_bf16_f32 v104, v64, v65
    v_cvt_pk_bf16_f32 v105, v66, v67
    v_cvt_pk_bf16_f32 v106, v68, v69
    v_cvt_pk_bf16_f32 v107, v70, v71
    v_exp_f32 v72, v72
    v_exp_f32 v73, v73
    v_exp_f32 v74, v74
    v_exp_f32 v75, v75
    v_mfma_f32_32x32x16_bf16 v[32:47], v[124:127], v[112:115], v[32:47]
    ds_read_b128 v[124:127], v4 offset:3584
    s_waitcnt lgkmcnt(5)
    v_exp_f32 v76, v76
    v_exp_f32 v77, v77
    v_exp_f32 v78, v78
    v_exp_f32 v79, v79
    v_mfma_f32_32x32x16_bf16 v[80:95], v[136:139], v[104:107], v[80:95]
    v_cvt_pk_bf16_f32 v108, v72, v73
    v_cvt_pk_bf16_f32 v109, v74, v75
    v_cvt_pk_bf16_f32 v110, v76, v77
    v_cvt_pk_bf16_f32 v111, v78, v79
    s_nop 1
    v_mfma_f32_32x32x16_bf16 v[80:95], v[140:143], v[108:111], v[80:95]
    s_mov_b64 exec, s[30:31]
    ds_read_b128 v[136:139], v6 offset:6400
    ds_read_b128 v[140:143], v6 offset:7040
    s_mov_b64 exec, -1
    s_waitcnt lgkmcnt(2)
    s_cmp_lt_u32 s47, 8
    s_cbranch_scc1 AT_WAIT12
AT_BACK12:
    v_mfma_f32_32x32x4_2b_bf16 v[48:79], v[118:119], v[116:117], 0
    ds_read_b64 v[118:119], v5 offset:12288
    v_exp_f32 v16, v16
    v_exp_f32 v17, v17
    v_exp_f32 v18, v18
    v_exp_f32 v19, v19
    v_exp_f32 v20, v20
    v_exp_f32 v21, v21
    v_exp_f32 v22, v22
    v_exp_f32 v23, v23
    v_cvt_pk_bf16_f32 v96, v16, v17
    v_cvt_pk_bf16_f32 v97, v18, v19
    v_cvt_pk_bf16_f32 v98, v20, v21
    v_cvt_pk_bf16_f32 v99, v22, v23
    v_exp_f32 v24, v24
    v_exp_f32 v25, v25
    v_exp_f32 v26, v26
    v_exp_f32 v27, v27
    v_exp_f32 v28, v28
    v_exp_f32 v29, v29
    v_exp_f32 v30, v30
    v_exp_f32 v31, v31
    v_mfma_f32_32x32x16_bf16 v[80:95], v[128:131], v[96:99], v[80:95]
    v_cvt_pk_bf16_f32 v100, v24, v25
    v_cvt_pk_bf16_f32 v101, v26, v27
    v_cvt_pk_bf16_f32 v102, v28, v29
    v_cvt_pk_bf16_f32 v103, v30, v31
    v_exp_f32 v32, v32
    v_exp_f32 v33, v33
    v_exp_f32 v34, v34
    v_exp_f32 v35, v35
    v_exp_f32 v36, v36
    v_exp_f32 v37, v37
    v_exp_f32 v38, v38
    v_exp_f32 v39, v39
    v_mfma_f32_32x32x16_bf16 v[80:95], v[132:135], v[100:103], v[80:95]
    s_mov_b64 exec, s[30:31]
    ds_read_b128 v[128:131], v6 offset:7680
    ds_read_b128 v[132:135], v6 offset:8320
    s_mov_b64 exec, -1
    v_mfma_f32_32x32x16_bf16 v[48:63], v[120:123], v[112:115], v[48:63]
    ds_read_b128 v[120:123], v4 offset:10240
    v_cvt_pk_bf16_f32 v104, v32, v33
    v_cvt_pk_bf16_f32 v105, v34, v35
    v_cvt_pk_bf16_f32 v106, v36, v37
    v_cvt_pk_bf16_f32 v107, v38, v39
    v_exp_f32 v40, v40
    v_exp_f32 v41, v41
    v_exp_f32 v42, v42
    v_exp_f32 v43, v43
    v_mfma_f32_32x32x16_bf16 v[64:79], v[124:127], v[112:115], v[64:79]
    ds_read_b128 v[124:127], v4 offset:11264
    s_waitcnt lgkmcnt(5)
    v_exp_f32 v44, v44
    v_exp_f32 v45, v45
    v_exp_f32 v46, v46
    v_exp_f32 v47, v47
    v_mfma_f32_32x32x16_bf16 v[80:95], v[136:139], v[104:107], v[80:95]
    v_cvt_pk_bf16_f32 v108, v40, v41
    v_cvt_pk_bf16_f32 v109, v42, v43
    v_cvt_pk_bf16_f32 v110, v44, v45
    v_cvt_pk_bf16_f32 v111, v46, v47
    s_nop 1
    v_mfma_f32_32x32x16_bf16 v[80:95], v[140:143], v[108:111], v[80:95]
    s_mov_b64 exec, s[30:31]
    ds_read_b128 v[136:139], v6 offset:8960
    ds_read_b128 v[140:143], v6 offset:9600
    s_mov_b64 exec, -1
    s_waitcnt lgkmcnt(2)
    v_mfma_f32_32x32x4_2b_bf16 v[16:47], v[118:119], v[116:117], 0
    ds_read_b64 v[118:119], v5 offset:14848
    v_exp_f32 v48, v48
    v_exp_f32 v49, v49
    v_exp_f32 v50, v50
    v_exp_f32 v51, v51
    v_exp_f32 v52, v52
    v_exp_f32 v53, v53
    v_exp_f32 v54, v54
    v_exp_f32 v55, v55
    v_cvt_pk_bf16_f32 v96, v48, v49
    v_cvt_pk_bf16_f32 v97, v50, v51
    v_cvt_pk_bf16_f32 v98, v52, v53
    v_cvt_pk_bf16_f32 v99, v54, v55
    v_exp_f32 v56, v56
    v_exp_f32 v57, v57
    v_exp_f32 v58, v58
    v_exp_f32 v59, v59
    v_exp_f32 v60, v60
    v_exp_f32 v61, v61
    v_exp_f32 v62, v62
    v_exp_f32 v63, v63
    v_mfma_f32_32x32x16_bf16 v[80:95], v[128:131], v[96:99], v[80:95]
    v_cvt_pk_bf16_f32 v100, v56, v57
    v_cvt_pk_bf16_f32 v101, v58, v59
    v_cvt_pk_bf16_f32 v102, v60, v61
    v_cvt_pk_bf16_f32 v103, v62, v63
    v_exp_f32 v64, v64
    v_exp_f32 v65, v65
    v_exp_f32 v66, v66
    v_exp_f32 v67, v67
    v_exp_f32 v68, v68
    v_exp_f32 v69, v69
    v_exp_f32 v70, v70
    v_exp_f32 v71, v71
    v_mfma_f32_32x32x16_bf16 v[80:95], v[132:135], v[100:103], v[80:95]
    s_mov_b64 exec, s[30:31]
    ds_read_b128 v[128:131], v6 offset:15360
    ds_read_b128 v[132:135], v6 offset:16000
    s_mov_b64 exec, -1
    v_mfma_f32_32x32x16_bf16 v[16:31], v[120:123], v[112:115], v[16:31]
    ds_read_b128 v[120:123], v4 offset:12800
    v_cvt_pk_bf16_f32 v104, v64, v65
    v_cvt_pk_bf16_f32 v105, v66, v67
    v_cvt_pk_bf16_f32 v106, v68, v69
    v_cvt_pk_bf16_f32 v107, v70, v71
    v_exp_f32 v72, v72
    v_exp_f32 v73, v73
    v_exp_f32 v74, v74
    v_exp_f32 v75, v75
    v_mfma_f32_32x32x16_bf16 v[32:47], v[124:127], v[112:115], v[32:47]
    ds_read_b128 v[124:127], v4 offset:13824
    s_waitcnt lgkmcnt(5)
    v_exp_f32 v76, v76
    v_exp_f32 v77, v77
    v_exp_f32 v78, v78
    v_exp_f32 v79, v79
    v_mfma_f32_32x32x16_bf16 v[80:95], v[136:139], v[104:107], v[80:95]
    v_cvt_pk_bf16_f32 v108, v72, v73
    v_cvt_pk_bf16_f32 v109, v74, v75
    v_cvt_pk_bf16_f32 v110, v76, v77
    v_cvt_pk_bf16_f32 v111, v78, v79
    s_nop 1
    v_mfma_f32_32x32x16_bf16 v[80:95], v[140:143], v[108:111], v[80:95]
    s_mov_b64 exec, s[30:31]
    ds_read_b128 v[136:139], v6 offset:16640
    ds_read_b128 v[140:143], v6 offset:17280
    s_mov_b64 exec, -1
    s_waitcnt lgkmcnt(2)
    s_cmp_lt_u32 s47, 9
    s_cbranch_scc1 AT_WAIT14
AT_BACK14:
    v_mfma_f32_32x32x4_2b_bf16 v[48:79], v[118:119], v[116:117], 0
    ds_read_b64 v[118:119], v5 offset:22528
    v_exp_f32 v16, v16
    v_exp_f32 v17, v17
    v_exp_f32 v18, v18
    v_exp_f32 v19, v19
    v_exp_f32 v20, v20
    v_exp_f32 v21, v21
    v_exp_f32 v22, v22
    v_exp_f32 v23, v23
    v_cvt_pk_bf16_f32 v96, v16, v17
    v_cvt_pk_bf16_f32 v97, v18, v19
    v_cvt_pk_bf16_f32 v98, v20, v21
    v_cvt_pk_bf16_f32 v99, v22, v23
    v_exp_f32 v24, v24
    v_exp_f32 v25, v25
    v_exp_f32 v26, v26
    v_exp_f32 v27, v27
    v_exp_f32 v28, v28
    v_exp_f32 v29, v29
    v_exp_f32 v30, v30
    v_exp_f32 v31, v31
    v_mfma_f32_32x32x16_bf16 v[80:95], v[128:131], v[96:99], v[80:95]
    v_cvt_pk_bf16_f32 v100, v24, v25
    v_cvt_pk_bf16_f32 v101, v26, v27
    v_cvt_pk_bf16_f32 v102, v28, v29
    v_cvt_pk_bf16_f32 v103, v30, v31
    v_exp_f32 v32, v32
    v_exp_f32 v33, v33
    v_exp_f32 v34, v34
    v_exp_f32 v35, v35
    v_exp_f32 v36, v36
    v_exp_f32 v37, v37
    v_exp_f32 v38, v38
    v_exp_f32 v39, v39
    v_mfma_f32_32x32x16_bf16 v[80:95], v[132:135], v[100:103], v[80:95]
    s_mov_b64 exec, s[30:31]
    ds_read_b128 v[128:131], v6 offset:17920
    ds_read_b128 v[132:135], v6 offset:18560
    s_mov_b64 exec, -1
    v_mfma_f32_32x32x16_bf16 v[48:63], v[120:123], v[112:115], v[48:63]
    ds_read_b128 v[120:123], v4 offset:20480
    v_cvt_pk_bf16_f32 v104, v32, v33
    v_cvt_pk_bf16_f32 v105, v34, v35
    v_cvt_pk_bf16_f32 v106, v36, v37
    v_cvt_pk_bf16_f32 v107, v38, v39
    v_exp_f32 v40, v40
    v_exp_f32 v41, v41
    v_exp_f32 v42, v42
    v_exp_f32 v43, v43
    v_mfma_f32_32x32x16_bf16 v[64:79], v[124:127], v[112:115], v[64:79]
    ds_read_b128 v[124:127], v4 offset:21504
    s_waitcnt lgkmcnt(5)
    v_exp_f32 v44, v44
    v_exp_f32 v45, v45
    v_exp_f32 v46, v46
    v_exp_f32 v47, v47
    v_mfma_f32_32x32x16_bf16 v[80:95], v[136:139], v[104:107], v[80:95]
    v_cvt_pk_bf16_f32 v108, v40, v41
    v_cvt_pk_bf16_f32 v109, v42, v43
    v_cvt_pk_bf16_f32 v110, v44, v45
    v_cvt_pk_bf16_f32 v111, v46, v47
    s_nop 1
    v_mfma_f32_32x32x16_bf16 v[80:95], v[140:143], v[108:111], v[80:95]
    s_mov_b64 exec, s[30:31]
    ds_read_b128 v[136:139], v6 offset:19200
    ds_read_b128 v[140:143], v6 offset:19840
    s_mov_b64 exec, -1
    s_waitcnt lgkmcnt(2)
    v_mfma_f32_32x32x4_2b_bf16 v[16:47], v[118:119], v[116:117], 0
    ds_read_b64 v[118:119], v5 offset:25088
    v_exp_f32 v48, v48
    v_exp_f32 v49, v49
    v_exp_f32 v50, v50
    v_exp_f32 v51, v51
    v_exp_f32 v52, v52
    v_exp_f32 v53, v53
    v_exp_f32 v54, v54
    v_exp_f32 v55, v55
    v_cvt_pk_bf16_f32 v96, v48, v49
    v_cvt_pk_bf16_f32 v97, v50, v51
    v_cvt_pk_bf16_f32 v98, v52, v53
    v_cvt_pk_bf16_f32 v99, v54, v55
    v_exp_f32 v56, v56
    v_exp_f32 v57, v57
    v_exp_f32 v58, v58
    v_exp_f32 v59, v59
    v_exp_f32 v60, v60
    v_exp_f32 v61, v61
    v_exp_f32 v62, v62
    v_exp_f32 v63, v63
    v_mfma_f32_32x32x16_bf16 v[80:95], v[128:131], v[96:99], v[80:95]
    v_cvt_pk_bf16_f32 v100, v56, v57
    v_cvt_pk_bf16_f32 v101, v58, v59
    v_cvt_pk_bf16_f32 v102, v60, v61
    v_cvt_pk_bf16_f32 v103, v62, v63
    v_exp_f32 v64, v64
    v_exp_f32 v65, v65
    v_exp_f32 v66, v66
    v_exp_f32 v67, v67
    v_exp_f32 v68, v68
    v_exp_f32 v69, v69
    v_exp_f32 v70, v70
    v_exp_f32 v71, v71
    v_mfma_f32_32x32x16_bf16 v[80:95], v[132:135], v[100:103], v[80:95]
    s_mov_b64 exec, s[30:31]
    ds_read_b128 v[128:131], v6 offset:25600
    ds_read_b128 v[132:135], v6 offset:26240
    s_mov_b64 exec, -1
    v_mfma_f32_32x32x16_bf16 v[16:31], v[120:123], v[112:115], v[16:31]
    ds_read_b128 v[120:123], v4 offset:23040
    v_cvt_pk_bf16_f32 v104, v64, v65
    v_cvt_pk_bf16_f32 v105, v66, v67
    v_cvt_pk_bf16_f32 v106, v68, v69
    v_cvt_pk_bf16_f32 v107, v70, v71
    v_exp_f32 v72, v72
    v_exp_f32 v73, v73
    v_exp_f32 v74, v74
    v_exp_f32 v75, v75
    v_mfma_f32_32x32x16_bf16 v[32:47], v[124:127], v[112:115], v[32:47]
    ds_read_b128 v[124:127], v4 offset:24064
    s_waitcnt lgkmcnt(5)
    v_exp_f32 v76, v76
    v_exp_f32 v77, v77
    v_exp_f32 v78, v78
    v_exp_f32 v79, v79
    v_mfma_f32_32x32x16_bf16 v[80:95], v[136:139], v[104:107], v[80:95]
    v_cvt_pk_bf16_f32 v108, v72, v73
    v_cvt_pk_bf16_f32 v109, v74, v75
    v_cvt_pk_bf16_f32 v110, v76, v77
    v_cvt_pk_bf16_f32 v111, v78, v79
    s_nop 1
    v_mfma_f32_32x32x16_bf16 v[80:95], v[140:143], v[108:111], v[80:95]
    s_mov_b64 exec, s[30:31]
    ds_read_b128 v[136:139], v6 offset:26880
    ds_read_b128 v[140:143], v6 offset:27520
    s_mov_b64 exec, -1
    s_waitcnt lgkmcnt(2)
    v_mov_b32 v13, 2
    ds_write_b32 v12, v13 offset:32
    s_cmp_lt_u32 s47, 10
    s_cbranch_scc1 AT_WAIT16
AT_BACK16:
    v_mfma_f32_32x32x4_2b_bf16 v[48:79], v[118:119], v[116:117], 0
    ds_read_b64 v[118:119], v5 offset:32768
    v_exp_f32 v16, v16
    v_exp_f32 v17, v17
    v_exp_f32 v18, v18
    v_exp_f32 v19, v19
    v_exp_f32 v20, v20
    v_exp_f32 v21, v21
    v_exp_f32 v22, v22
    v_exp_f32 v23, v23
    v_cvt_pk_bf16_f32 v96, v16, v17
    v_cvt_pk_bf16_f32 v97, v18, v19
    v_cvt_pk_bf16_f32 v98, v20, v21
    v_cvt_pk_bf16_f32 v99, v22, v23
    v_exp_f32 v24, v24
    v_exp_f32 v25, v25
    v_exp_f32 v26, v26
    v_exp_f32 v27, v27
    v_exp_f32 v28, v28
    v_exp_f32 v29, v29
    v_exp_f32 v30, v30
    v_exp_f32 v31, v31
    v_mfma_f32_32x32x16_bf16 v[80:95], v[128:131], v[96:99], v[80:95]
    v_cvt_pk_bf16_f32 v100, v24, v25
    v_cvt_pk_bf16_f32 v101, v26, v27
    v_cvt_pk_bf16_f32 v102, v28, v29
    v_cvt_pk_bf16_f32 v103, v30, v31
    v_exp_f32 v32, v32
    v_exp_f32 v33, v33
    v_exp_f32 v34, v34
    v_exp_f32 v35, v35
    v_exp_f32 v36, v36
    v_exp_f32 v37, v37
    v_exp_f32 v38, v38
    v_exp_f32 v39, v39
    v_mfma_f32_32x32x16_bf16 v[80:95], v[132:135], v[100:103], v[80:95]
    s_mov_b64 exec, s[30:31]
    ds_read_b128 v[128:131], v6 offset:28160
    ds_read_b128 v[132:135], v6 offset:28800
    s_mov_b64 exec, -1
    v_mfma_f32_32x32x16_bf16 v[48:63], v[120:123], v[112:115], v[48:63]
    ds_read_b128 v[120:123], v4 offset:30720
    v_cvt_pk_bf16_f32 v104, v32, v33
    v_cvt_pk_bf16_f32 v105, v34, v35
    v_cvt_pk_bf16_f32 v106, v36, v37
    v_cvt_pk_bf16_f32 v107, v38, v39
    v_exp_f32 v40, v40
    v_exp_f32 v41, v41
    v_exp_f32 v42, v42
    v_exp_f32 v43, v43
    v_mfma_f32_32x32x16_bf16 v[64:79], v[124:127], v[112:115], v[64:79]
    ds_read_b128 v[124:127], v4 offset:31744
    s_waitcnt lgkmcnt(5)
    v_exp_f32 v44, v44
    v_exp_f32 v45, v45
    v_exp_f32 v46, v46
    v_exp_f32 v47, v47
    v_mfma_f32_32x32x16_bf16 v[80:95], v[136:139], v[104:107], v[80:95]
    v_cvt_pk_bf16_f32 v108, v40, v41
    v_cvt_pk_bf16_f32 v109, v42, v43
    v_cvt_pk_bf16_f32 v110, v44, v45
    v_cvt_pk_bf16_f32 v111, v46, v47
    s_nop 1
    v_mfma_f32_32x32x16_bf16 v[80:95], v[140:143], v[108:111], v[80:95]
    s_mov_b64 exec, s[30:31]
    ds_read_b128 v[136:139], v6 offset:29440
    ds_read_b128 v[140:143], v6 offset:30080
    s_mov_b64 exec, -1
    s_waitcnt lgkmcnt(2)
    v_mfma_f32_32x32x4_2b_bf16 v[16:47], v[118:119], v[116:117], 0
    ds_read_b64 v[118:119], v5 offset:35328
    v_exp_f32 v48, v48
    v_exp_f32 v49, v49
    v_exp_f32 v50, v50
    v_exp_f32 v51, v51
    v_exp_f32 v52, v52
    v_exp_f32 v53, v53
    v_exp_f32 v54, v54
    v_exp_f32 v55, v55
    v_cvt_pk_bf16_f32 v96, v48, v49
    v_cvt_pk_bf16_f32 v97, v50, v51
    v_cvt_pk_bf16_f32 v98, v52, v53
    v_cvt_pk_bf16_f32 v99, v54, v55
    v_exp_f32 v56, v56
    v_exp_f32 v57, v57
    v_exp_f32 v58, v58
    v_exp_f32 v59, v59
    v_exp_f32 v60, v60
    v_exp_f32 v61, v61
    v_exp_f32 v62, v62
    v_exp_f32 v63, v63
    v_mfma_f32_32x32x16_bf16 v[80:95], v[128:131], v[96:99], v[80:95]
    v_cvt_pk_bf16_f32 v100, v56, v57
    v_cvt_pk_bf16_f32 v101, v58, v59
    v_cvt_pk_bf16_f32 v102, v60, v61
    v_cvt_pk_bf16_f32 v103, v62, v63
    v_exp_f32 v64, v64
    v_exp_f32 v65, v65
    v_exp_f32 v66, v66
    v_exp_f32 v67, v67
    v_exp_f32 v68, v68
    v_exp_f32 v69, v69
    v_exp_f32 v70, v70
    v_exp_f32 v71, v71
    v_mfma_f32_32x32x16_bf16 v[80:95], v[132:135], v[100:103], v[80:95]
    s_mov_b64 exec, s[30:31]
    ds_read_b128 v[128:131], v6 offset:35840
    ds_read_b128 v[132:135], v6 offset:36480
    s_mov_b64 exec, -1
    v_mfma_f32_32x32x16_bf16 v[16:31], v[120:123], v[112:115], v[16:31]
    ds_read_b128 v[120:123], v4 offset:33280
    v_cvt_pk_bf16_f32 v104, v64, v65
    v_cvt_pk_bf16_f32 v105, v66, v67
    v_cvt_pk_bf16_f32 v106, v68, v69
    v_cvt_pk_bf16_f32 v107, v70, v71
    v_exp_f32 v72, v72
    v_exp_f32 v73, v73
    v_exp_f32 v74, v74
    v_exp_f32 v75, v75
    v_mfma_f32_32x32x16_bf16 v[32:47], v[124:127], v[112:115], v[32:47]
    ds_read_b128 v[124:127], v4 offset:34304
    s_waitcnt lgkmcnt(5)
    v_exp_f32 v76, v76
    v_exp_f32 v77, v77
    v_exp_f32 v78, v78
    v_exp_f32 v79, v79
    v_mfma_f32_32x32x16_bf16 v[80:95], v[136:139], v[104:107], v[80:95]
    v_cvt_pk_bf16_f32 v108, v72, v73
    v_cvt_pk_bf16_f32 v109, v74, v75
    v_cvt_pk_bf16_f32 v110, v76, v77
    v_cvt_pk_bf16_f32 v111, v78, v79
    s_nop 1
    v_mfma_f32_32x32x16_bf16 v[80:95], v[140:143], v[108:111], v[80:95]
    s_mov_b64 exec, s[30:31]
    ds_read_b128 v[136:139], v6 offset:37120
    ds_read_b128 v[140:143], v6 offset:37760
    s_mov_b64 exec, -1
    s_waitcnt lgkmcnt(2)
    s_cmp_lt_u32 s47, 11
    s_cbranch_scc1 AT_WAIT18
AT_BACK18:
    v_mfma_f32_32x32x4_2b_bf16 v[48:79], v[118:119], v[116:117], 0
    ds_read_b64 v[118:119], v5 offset:43008
    v_exp_f32 v16, v16
    v_exp_f32 v17, v17
    v_exp_f32 v18, v18
    v_exp_f32 v19, v19
    v_exp_f32 v20, v20
    v_exp_f32 v21, v21
    v_exp_f32 v22, v22
    v_exp_f32 v23, v23
    v_cvt_pk_bf16_f32 v96, v16, v17
    v_cvt_pk_bf16_f32 v97, v18, v19
    v_cvt_pk_bf16_f32 v98, v20, v21
    v_cvt_pk_bf16_f32 v99, v22, v23
    v_exp_f32 v24, v24
    v_exp_f32 v25, v25
    v_exp_f32 v26, v26
    v_exp_f32 v27, v27
    v_exp_f32 v28, v28
    v_exp_f32 v29, v29
    v_exp_f32 v30, v30
    v_exp_f32 v31, v31
    v_mfma_f32_32x32x16_bf16 v[80:95], v[128:131], v[96:99], v[80:95]
    v_cvt_pk_bf16_f32 v100, v24, v25
    v_cvt_pk_bf16_f32 v101, v26, v27
    v_cvt_pk_bf16_f32 v102, v28, v29
    v_cvt_pk_bf16_f32 v103, v30, v31
    v_exp_f32 v32, v32
    v_exp_f32 v33, v33
    v_exp_f32 v34, v34
    v_exp_f32 v35, v35
    v_exp_f32 v36, v36
    v_exp_f32 v37, v37
    v_exp_f32 v38, v38
    v_exp_f32 v39, v39
    v_mfma_f32_32x32x16_bf16 v[80:95], v[132:135], v[100:103], v[80:95]
    s_mov_b64 exec, s[30:31]
    ds_read_b128 v[128:131], v6 offset:38400
    ds_read_b128 v[132:135], v6 offset:39040
    s_mov_b64 exec, -1
    v_mfma_f32_32x32x16_bf16 v[48:63], v[120:123], v[112:115], v[48:63]
    ds_read_b128 v[120:123], v4 offset:40960
    v_cvt_pk_bf16_f32 v104, v32, v33
    v_cvt_pk_bf16_f32 v105, v34, v35
    v_cvt_pk_bf16_f32 v106, v36, v37
    v_cvt_pk_bf16_f32 v107, v38, v39
    v_exp_f32 v40, v40
    v_exp_f32 v41, v41
    v_exp_f32 v42, v42
    v_exp_f32 v43, v43
    v_mfma_f32_32x32x16_bf16 v[64:79], v[124:127], v[112:115], v[64:79]
    ds_read_b128 v[124:127], v4 offset:41984
    s_waitcnt lgkmcnt(5)
    v_exp_f32 v44, v44
    v_exp_f32 v45, v45
    v_exp_f32 v46, v46
    v_exp_f32 v47, v47
    v_mfma_f32_32x32x16_bf16 v[80:95], v[136:139], v[104:107], v[80:95]
    v_cvt_pk_bf16_f32 v108, v40, v41
    v_cvt_pk_bf16_f32 v109, v42, v43
    v_cvt_pk_bf16_f32 v110, v44, v45
    v_cvt_pk_bf16_f32 v111, v46, v47
    s_nop 1
    v_mfma_f32_32x32x16_bf16 v[80:95], v[140:143], v[108:111], v[80:95]
    s_mov_b64 exec, s[30:31]
    ds_read_b128 v[136:139], v6 offset:39680
    ds_read_b128 v[140:143], v6 offset:40320
    s_mov_b64 exec, -1
    s_waitcnt lgkmcnt(2)
    v_mfma_f32_32x32x4_2b_bf16 v[16:47], v[118:119], v[116:117], 0
    ds_read_b64 v[118:119], v5 offset:45568
    v_exp_f32 v48, v48
    v_exp_f32 v49, v49
    v_exp_f32 v50, v50
    v_exp_f32 v51, v51
    v_exp_f32 v52, v52
    v_exp_f32 v53, v53
    v_exp_f32 v54, v54
    v_exp_f32 v55, v55
    v_cvt_pk_bf16_f32 v96, v48, v49
    v_cvt_pk_bf16_f32 v97, v50, v51
    v_cvt_pk_bf16_f32 v98, v52, v53
    v_cvt_pk_bf16_f32 v99, v54, v55
    v_exp_f32 v56, v56
    v_exp_f32 v57, v57
    v_exp_f32 v58, v58
    v_exp_f32 v59, v59
    v_exp_f32 v60, v60
    v_exp_f32 v61, v61
    v_exp_f32 v62, v62
    v_exp_f32 v63, v63
    v_mfma_f32_32x32x16_bf16 v[80:95], v[128:131], v[96:99], v[80:95]
    v_cvt_pk_bf16_f32 v100, v56, v57
    v_cvt_pk_bf16_f32 v101, v58, v59
    v_cvt_pk_bf16_f32 v102, v60, v61
    v_cvt_pk_bf16_f32 v103, v62, v63
    v_exp_f32 v64, v64
    v_exp_f32 v65, v65
    v_exp_f32 v66, v66
    v_exp_f32 v67, v67
    v_exp_f32 v68, v68
    v_exp_f32 v69, v69
    v_exp_f32 v70, v70
    v_exp_f32 v71, v71
    v_mfma_f32_32x32x16_bf16 v[80:95], v[132:135], v[100:103], v[80:95]
    s_mov_b64 exec, s[30:31]
    ds_read_b128 v[128:131], v6 offset:46080
    ds_read_b128 v[132:135], v6 offset:46720
    s_mov_b64 exec, -1
    v_mfma_f32_32x32x16_bf16 v[16:31], v[120:123], v[112:115], v[16:31]
    ds_read_b128 v[120:123], v4 offset:43520
    v_cvt_pk_bf16_f32 v104, v64, v65
    v_cvt_pk_bf16_f32 v105, v66, v67
    v_cvt_pk_bf16_f32 v106, v68, v69
    v_cvt_pk_bf16_f32 v107, v70, v71
    v_exp_f32 v72, v72
    v_exp_f32 v73, v73
    v_exp_f32 v74, v74
    v_exp_f32 v75, v75
    v_mfma_f32_32x32x16_bf16 v[32:47], v[124:127], v[112:115], v[32:47]
    ds_read_b128 v[124:127], v4 offset:44544
    s_waitcnt lgkmcnt(5)
    v_exp_f32 v76, v76
    v_exp_f32 v77, v77
    v_exp_f32 v78, v78
    v_exp_f32 v79, v79
    v_mfma_f32_32x32x16_bf16 v[80:95], v[136:139], v[104:107], v[80:95]
    v_cvt_pk_bf16_f32 v108, v72, v73
    v_cvt_pk_bf16_f32 v109, v74, v75
    v_cvt_pk_bf16_f32 v110, v76, v77
    v_cvt_pk_bf16_f32 v111, v78, v79
    s_nop 1
    v_mfma_f32_32x32x16_bf16 v[80:95], v[140:143], v[108:111], v[80:95]
    s_mov_b64 exec, s[30:31]
    ds_read_b128 v[136:139], v6 offset:47360
    ds_read_b128 v[140:143], v6 offset:48000
    s_mov_b64 exec, -1
    s_waitcnt lgkmcnt(2)
    s_cmp_lt_u32 s47, 12
    s_cbranch_scc1 AT_WAIT20
AT_BACK20:
    v_mfma_f32_32x32x4_2b_bf16 v[48:79], v[118:119], v[116:117], 0
    ds_read_b64 v[118:119], v5 offset:53248
    v_exp_f32 v16, v16
    v_exp_f32 v17, v17
    v_exp_f32 v18, v18
    v_exp_f32 v19, v19
    v_exp_f32 v20, v20
    v_exp_f32 v21, v21
    v_exp_f32 v22, v22
    v_exp_f32 v23, v23
    v_cvt_pk_bf16_f32 v96, v16, v17
    v_cvt_pk_bf16_f32 v97, v18, v19
    v_cvt_pk_bf16_f32 v98, v20, v21
    v_cvt_pk_bf16_f32 v99, v22, v23
    v_exp_f32 v24, v24
    v_exp_f32 v25, v25
    v_exp_f32 v26, v26
    v_exp_f32 v27, v27
    v_exp_f32 v28, v28
    v_exp_f32 v29, v29
    v_exp_f32 v30, v30
    v_exp_f32 v31, v31
    v_mfma_f32_32x32x16_bf16 v[80:95], v[128:131], v[96:99], v[80:95]
    v_cvt_pk_bf16_f32 v100, v24, v25
    v_cvt_pk_bf16_f32 v101, v26, v27
    v_cvt_pk_bf16_f32 v102, v28, v29
    v_cvt_pk_bf16_f32 v103, v30, v31
    v_exp_f32 v32, v32
    v_exp_f32 v33, v33
    v_exp_f32 v34, v34
    v_exp_f32 v35, v35
    v_exp_f32 v36, v36
    v_exp_f32 v37, v37
    v_exp_f32 v38, v38
    v_exp_f32 v39, v39
    v_mfma_f32_32x32x16_bf16 v[80:95], v[132:135], v[100:103], v[80:95]
    s_mov_b64 exec, s[30:31]
    ds_read_b128 v[128:131], v6 offset:48640
    ds_read_b128 v[132:135], v6 offset:49280
    s_mov_b64 exec, -1
    v_mfma_f32_32x32x16_bf16 v[48:63], v[120:123], v[112:115], v[48:63]
    ds_read_b128 v[120:123], v4 offset:51200
    v_cvt_pk_bf16_f32 v104, v32, v33
    v_cvt_pk_bf16_f32 v105, v34, v35
    v_cvt_pk_bf16_f32 v106, v36, v37
    v_cvt_pk_bf16_f32 v107, v38, v39
    v_exp_f32 v40, v40
    v_exp_f32 v41, v41
    v_exp_f32 v42, v42
    v_exp_f32 v43, v43
    v_mfma_f32_32x32x16_bf16 v[64:79], v[124:127], v[112:115], v[64:79]
    ds_read_b128 v[124:127], v4 offset:52224
    s_waitcnt lgkmcnt(5)
    v_exp_f32 v44, v44
    v_exp_f32 v45, v45
    v_exp_f32 v46, v46
    v_exp_f32 v47, v47
    v_mfma_f32_32x32x16_bf16 v[80:95], v[136:139], v[104:107], v[80:95]
    v_cvt_pk_bf16_f32 v108, v40, v41
    v_cvt_pk_bf16_f32 v109, v42, v43
    v_cvt_pk_bf16_f32 v110, v44, v45
    v_cvt_pk_bf16_f32 v111, v46, v47
    s_nop 1
    v_mfma_f32_32x32x16_bf16 v[80:95], v[140:143], v[108:111], v[80:95]
    s_mov_b64 exec, s[30:31]
    ds_read_b128 v[136:139], v6 offset:49920
    ds_read_b128 v[140:143], v6 offset:50560
    s_mov_b64 exec, -1
    s_waitcnt lgkmcnt(2)
    v_mfma_f32_32x32x4_2b_bf16 v[16:47], v[118:119], v[116:117], 0
    ds_read_b64 v[118:119], v5 offset:55808
    v_exp_f32 v48, v48
    v_exp_f32 v49, v49
    v_exp_f32 v50, v50
    v_exp_f32 v51, v51
    v_exp_f32 v52, v52
    v_exp_f32 v53, v53
    v_exp_f32 v54, v54
    v_exp_f32 v55, v55
    v_cvt_pk_bf16_f32 v96, v48, v49
    v_cvt_pk_bf16_f32 v97, v50, v51
    v_cvt_pk_bf16_f32 v98, v52, v53
    v_cvt_pk_bf16_f32 v99, v54, v55
    v_exp_f32 v56, v56
    v_exp_f32 v57, v57
    v_exp_f32 v58, v58
    v_exp_f32 v59, v59
    v_exp_f32 v60, v60
    v_exp_f32 v61, v61
    v_exp_f32 v62, v62
    v_exp_f32 v63, v63
    v_mfma_f32_32x32x16_bf16 v[80:95], v[128:131], v[96:99], v[80:95]
    v_cvt_pk_bf16_f32 v100, v56, v57
    v_cvt_pk_bf16_f32 v101, v58, v59
    v_cvt_pk_bf16_f32 v102, v60, v61
    v_cvt_pk_bf16_f32 v103, v62, v63
    v_exp_f32 v64, v64
    v_exp_f32 v65, v65
    v_exp_f32 v66, v66
    v_exp_f32 v67, v67
    v_exp_f32 v68, v68
    v_exp_f32 v69, v69
    v_exp_f32 v70, v70
    v_exp_f32 v71, v71
    v_mfma_f32_32x32x16_bf16 v[80:95], v[132:135], v[100:103], v[80:95]
    s_mov_b64 exec, s[30:31]
    ds_read_b128 v[128:131], v6 offset:56320
    ds_read_b128 v[132:135], v6 offset:56960
    s_mov_b64 exec, -1
    v_mfma_f32_32x32x16_bf16 v[16:31], v[120:123], v[112:115], v[16:31]
    ds_read_b128 v[120:123], v4 offset:53760
    v_cvt_pk_bf16_f32 v104, v64, v65
    v_cvt_pk_bf16_f32 v105, v66, v67
    v_cvt_pk_bf16_f32 v106, v68, v69
    v_cvt_pk_bf16_f32 v107, v70, v71
    v_exp_f32 v72, v72
    v_exp_f32 v73, v73
    v_exp_f32 v74, v74
    v_exp_f32 v75, v75
    v_mfma_f32_32x32x16_bf16 v[32:47], v[124:127], v[112:115], v[32:47]
    ds_read_b128 v[124:127], v4 offset:54784
    s_waitcnt lgkmcnt(5)
    v_exp_f32 v76, v76
    v_exp_f32 v77, v77
    v_exp_f32 v78, v78
    v_exp_f32 v79, v79
    v_mfma_f32_32x32x16_bf16 v[80:95], v[136:139], v[104:107], v[80:95]
    v_cvt_pk_bf16_f32 v108, v72, v73
    v_cvt_pk_bf16_f32 v109, v74, v75
    v_cvt_pk_bf16_f32 v110, v76, v77
    v_cvt_pk_bf16_f32 v111, v78, v79
    s_nop 1
    v_mfma_f32_32x32x16_bf16 v[80:95], v[140:143], v[108:111], v[80:95]
    s_mov_b64 exec, s[30:31]
    ds_read_b128 v[136:139], v6 offset:57600
    ds_read_b128 v[140:143], v6 offset:58240
    s_mov_b64 exec, -1
    s_waitcnt lgkmcnt(2)
    v_mov_b32 v13, 3
    ds_write_b32 v12, v13 offset:32
    s_setprio 0
    s_cmp_lt_u32 s47, 13
    s_cbranch_scc1 AT_WAIT22
AT_BACK22:
    v_mfma_f32_32x32x4_2b_bf16 v[48:79], v[118:119], v[116:117], 0
    ds_read_b64 v[118:119], v5 offset:63488
    v_exp_f32 v16, v16
    v_exp_f32 v17, v17
    v_exp_f32 v18, v18
    v_exp_f32 v19, v19
    v_exp_f32 v20, v20
    v_exp_f32 v21, v21
    v_exp_f32 v22, v22
    v_exp_f32 v23, v23
    v_cvt_pk_bf16_f32 v96, v16, v17
    v_cvt_pk_bf16_f32 v97, v18, v19
    v_cvt_pk_bf16_f32 v98, v20, v21
    v_cvt_pk_bf16_f32 v99, v22, v23
    v_exp_f32 v24, v24
    v_exp_f32 v25, v25
    v_exp_f32 v26, v26
    v_exp_f32 v27, v27
    v_exp_f32 v28, v28
    v_exp_f32 v29, v29
    v_exp_f32 v30, v30
    v_exp_f32 v31, v31
    v_mfma_f32_32x32x16_bf16 v[80:95], v[128:131], v[96:99], v[80:95]
    v_cvt_pk_bf16_f32 v100, v24, v25
    v_cvt_pk_bf16_f32 v101, v26, v27
    v_cvt_pk_bf16_f32 v102, v28, v29
    v_cvt_pk_bf16_f32 v103, v30, v31
    v_exp_f32 v32, v32
    v_exp_f32 v33, v33
    v_exp_f32 v34, v34
    v_exp_f32 v35, v35
    v_exp_f32 v36, v36
    v_exp_f32 v37, v37
    v_exp_f32 v38, v38
    v_exp_f32 v39, v39
    v_mfma_f32_32x32x16_bf16 v[80:95], v[132:135], v[100:103], v[80:95]
    s_mov_b64 exec, s[30:31]
    ds_read_b128 v[128:131], v6 offset:58880
    ds_read_b128 v[132:135], v6 offset:59520
    s_mov_b64 exec, -1
    v_mfma_f32_32x32x16_bf16 v[48:63], v[120:123], v[112:115], v[48:63]
    ds_read_b128 v[120:123], v4 offset:61440
    v_cvt_pk_bf16_f32 v104, v32, v33
    v_cvt_pk_bf16_f32 v105, v34, v35
    v_cvt_pk_bf16_f32 v106, v36, v37
    v_cvt_pk_bf16_f32 v107, v38, v39
    v_exp_f32 v40, v40
    v_exp_f32 v41, v41
    v_exp_f32 v42, v42
    v_exp_f32 v43, v43
    v_mfma_f32_32x32x16_bf16 v[64:79], v[124:127], v[112:115], v[64:79]
    ds_read_b128 v[124:127], v4 offset:62464
    s_waitcnt lgkmcnt(5)
    v_exp_f32 v44, v44
    v_exp_f32 v45, v45
    v_exp_f32 v46, v46
    v_exp_f32 v47, v47
    v_mfma_f32_32x32x16_bf16 v[80:95], v[136:139], v[104:107], v[80:95]
    v_cvt_pk_bf16_f32 v108, v40, v41
    v_cvt_pk_bf16_f32 v109, v42, v43
    v_cvt_pk_bf16_f32 v110, v44, v45
    v_cvt_pk_bf16_f32 v111, v46, v47
    s_nop 1
    v_mfma_f32_32x32x16_bf16 v[80:95], v[140:143], v[108:111], v[80:95]
    s_mov_b64 exec, s[30:31]
    ds_read_b128 v[136:139], v6 offset:60160
    ds_read_b128 v[140:143], v6 offset:60800
    s_mov_b64 exec, -1
    v_add_u32 v4, 61440, v4
    v_add_u32 v5, 61440, v5
    v_add_u32 v6, 61440, v6
    s_waitcnt lgkmcnt(2)
    v_mfma_f32_32x32x4_2b_bf16 v[16:47], v[118:119], v[116:117], 0
    ds_read_b64 v[118:119], v5 offset:4608
    v_exp_f32 v48, v48
    v_exp_f32 v49, v49
    v_exp_f32 v50, v50
    v_exp_f32 v51, v51
    v_exp_f32 v52, v52
    v_exp_f32 v53, v53
    v_exp_f32 v54, v54
    v_exp_f32 v55, v55
    v_cvt_pk_bf16_f32 v96, v48, v49
    v_cvt_pk_bf16_f32 v97, v50, v51
    v_cvt_pk_bf16_f32 v98, v52, v53
    v_cvt_pk_bf16_f32 v99, v54, v55
    v_exp_f32 v56, v56
    v_exp_f32 v57, v57
    v_exp_f32 v58, v58
    v_exp_f32 v59, v59
    v_exp_f32 v60, v60
    v_exp_f32 v61, v61
    v_exp_f32 v62, v62
    v_exp_f32 v63, v63
    v_mfma_f32_32x32x16_bf16 v[80:95], v[128:131], v[96:99], v[80:95]
    v_cvt_pk_bf16_f32 v100, v56, v57
    v_cvt_pk_bf16_f32 v101, v58, v59
    v_cvt_pk_bf16_f32 v102, v60, v61
    v_cvt_pk_bf16_f32 v103, v62, v63
    v_exp_f32 v64, v64
    v_exp_f32 v65, v65
    v_exp_f32 v66, v66
    v_exp_f32 v67, v67
    v_exp_f32 v68, v68
    v_exp_f32 v69, v69
    v_exp_f32 v70, v70
    v_exp_f32 v71, v71
    v_mfma_f32_32x32x16_bf16 v[80:95], v[132:135], v[100:103], v[80:95]
    s_mov_b64 exec, s[30:31]
    ds_read_b128 v[128:131], v6 offset:5120
    ds_read_b128 v[132:135], v6 offset:5760
    s_mov_b64 exec, -1
    v_mfma_f32_32x32x16_bf16 v[16:31], v[120:123], v[112:115], v[16:31]
    ds_read_b128 v[120:123], v4 offset:2560
    v_cvt_pk_bf16_f32 v104, v64, v65
    v_cvt_pk_bf16_f32 v105, v66, v67
    v_cvt_pk_bf16_f32 v106, v68, v69
    v_cvt_pk_bf16_f32 v107, v70, v71
    v_exp_f32 v72, v72
    v_exp_f32 v73, v73
    v_exp_f32 v74, v74
    v_exp_f32 v75, v75
    v_mfma_f32_32x32x16_bf16 v[32:47], v[124:127], v[112:115], v[32:47]
    ds_read_b128 v[124:127], v4 offset:3584
    s_waitcnt lgkmcnt(5)
    v_exp_f32 v76, v76
    v_exp_f32 v77, v77
    v_exp_f32 v78, v78
    v_exp_f32 v79, v79
    v_mfma_f32_32x32x16_bf16 v[80:95], v[136:139], v[104:107], v[80:95]
    v_cvt_pk_bf16_f32 v108, v72, v73
    v_cvt_pk_bf16_f32 v109, v74, v75
    v_cvt_pk_bf16_f32 v110, v76, v77
    v_cvt_pk_bf16_f32 v111, v78, v79
    s_nop 1
    v_mfma_f32_32x32x16_bf16 v[80:95], v[140:143], v[108:111], v[80:95]
    s_mov_b64 exec, s[30:31]
    ds_read_b128 v[136:139], v6 offset:6400
    ds_read_b128 v[140:143], v6 offset:7040
    s_mov_b64 exec, -1
    s_waitcnt lgkmcnt(2)
    s_cmp_lt_u32 s47, 14
    s_cbranch_scc1 AT_WAIT24
AT_BACK24:
    v_mfma_f32_32x32x4_2b_bf16 v[48:79], v[118:119], v[116:117], 0
    ds_read_b64 v[118:119], v5 offset:12288
    v_exp_f32 v16, v16
    v_exp_f32 v17, v17
    v_exp_f32 v18, v18
    v_exp_f32 v19, v19
    v_exp_f32 v20, v20
    v_exp_f32 v21, v21
    v_exp_f32 v22, v22
    v_exp_f32 v23, v23
    v_cvt_pk_bf16_f32 v96, v16, v17
    v_cvt_pk_bf16_f32 v97, v18, v19
    v_cvt_pk_bf16_f32 v98, v20, v21
    v_cvt_pk_bf16_f32 v99, v22, v23
    v_exp_f32 v24, v24
    v_exp_f32 v25, v25
    v_exp_f32 v26, v26
    v_exp_f32 v27, v27
    v_exp_f32 v28, v28
    v_exp_f32 v29, v29
    v_exp_f32 v30, v30
    v_exp_f32 v31, v31
    v_mfma_f32_32x32x16_bf16 v[80:95], v[128:131], v[96:99], v[80:95]
    v_cvt_pk_bf16_f32 v100, v24, v25
    v_cvt_pk_bf16_f32 v101, v26, v27
    v_cvt_pk_bf16_f32 v102, v28, v29
    v_cvt_pk_bf16_f32 v103, v30, v31
    v_exp_f32 v32, v32
    v_exp_f32 v33, v33
    v_exp_f32 v34, v34
    v_exp_f32 v35, v35
    v_exp_f32 v36, v36
    v_exp_f32 v37, v37
    v_exp_f32 v38, v38
    v_exp_f32 v39, v39
    v_mfma_f32_32x32x16_bf16 v[80:95], v[132:135], v[100:103], v[80:95]
    s_mov_b64 exec, s[30:31]
    ds_read_b128 v[128:131], v6 offset:7680
    ds_read_b128 v[132:135], v6 offset:8320
    s_mov_b64 exec, -1
    v_mfma_f32_32x32x16_bf16 v[48:63], v[120:123], v[112:115], v[48:63]
    ds_read_b128 v[120:123], v4 offset:10240
    v_cvt_pk_bf16_f32 v104, v32, v33
    v_cvt_pk_bf16_f32 v105, v34, v35
    v_cvt_pk_bf16_f32 v106, v36, v37
    v_cvt_pk_bf16_f32 v107, v38, v39
    v_exp_f32 v40, v40
    v_exp_f32 v41, v41
    v_exp_f32 v42, v42
    v_exp_f32 v43, v43
    v_mfma_f32_32x32x16_bf16 v[64:79], v[124:127], v[112:115], v[64:79]
    ds_read_b128 v[124:127], v4 offset:11264
    s_waitcnt lgkmcnt(5)
    v_exp_f32 v44, v44
    v_exp_f32 v45, v45
    v_exp_f32 v46, v46
    v_exp_f32 v47, v47
    v_mfma_f32_32x32x16_bf16 v[80:95], v[136:139], v[104:107], v[80:95]
    v_cvt_pk_bf16_f32 v108, v40, v41
    v_cvt_pk_bf16_f32 v109, v42, v43
    v_cvt_pk_bf16_f32 v110, v44, v45
    v_cvt_pk_bf16_f32 v111, v46, v47
    s_nop 1
    v_mfma_f32_32x32x16_bf16 v[80:95], v[140:143], v[108:111], v[80:95]
    s_mov_b64 exec, s[30:31]
    ds_read_b128 v[136:139], v6 offset:8960
    ds_read_b128 v[140:143], v6 offset:9600
    s_mov_b64 exec, -1
    s_waitcnt lgkmcnt(2)
    v_mfma_f32_32x32x4_2b_bf16 v[16:47], v[118:119], v[116:117], 0
    ds_read_b64 v[118:119], v5 offset:14848
    v_exp_f32 v48, v48
    v_exp_f32 v49, v49
    v_exp_f32 v50, v50
    v_exp_f32 v51, v51
    v_exp_f32 v52, v52
    v_exp_f32 v53, v53
    v_exp_f32 v54, v54
    v_exp_f32 v55, v55
    v_cvt_pk_bf16_f32 v96, v48, v49
    v_cvt_pk_bf16_f32 v97, v50, v51
    v_cvt_pk_bf16_f32 v98, v52, v53
    v_cvt_pk_bf16_f32 v99, v54, v55
    v_exp_f32 v56, v56
    v_exp_f32 v57, v57
    v_exp_f32 v58, v58
    v_exp_f32 v59, v59
    v_exp_f32 v60, v60
    v_exp_f32 v61, v61
    v_exp_f32 v62, v62
    v_exp_f32 v63, v63
    v_mfma_f32_32x32x16_bf16 v[80:95], v[128:131], v[96:99], v[80:95]
    v_cvt_pk_bf16_f32 v100, v56, v57
    v_cvt_pk_bf16_f32 v101, v58, v59
    v_cvt_pk_bf16_f32 v102, v60, v61
    v_cvt_pk_bf16_f32 v103, v62, v63
    v_exp_f32 v64, v64
    v_exp_f32 v65, v65
    v_exp_f32 v66, v66
    v_exp_f32 v67, v67
    v_exp_f32 v68, v68
    v_exp_f32 v69, v69
    v_exp_f32 v70, v70
    v_exp_f32 v71, v71
    v_mfma_f32_32x32x16_bf16 v[80:95], v[132:135], v[100:103], v[80:95]
    s_mov_b64 exec, s[30:31]
    ds_read_b128 v[128:131], v6 offset:15360
    ds_read_b128 v[132:135], v6 offset:16000
    s_mov_b64 exec, -1
    v_mfma_f32_32x32x16_bf16 v[16:31], v[120:123], v[112:115], v[16:31]
    ds_read_b128 v[120:123], v4 offset:12800
    v_cvt_pk_bf16_f32 v104, v64, v65
    v_cvt_pk_bf16_f32 v105, v66, v67
    v_cvt_pk_bf16_f32 v106, v68, v69
    v_cvt_pk_bf16_f32 v107, v70, v71
    v_exp_f32 v72, v72
    v_exp_f32 v73, v73
    v_exp_f32 v74, v74
    v_exp_f32 v75, v75
    v_mfma_f32_32x32x16_bf16 v[32:47], v[124:127], v[112:115], v[32:47]
    ds_read_b128 v[124:127], v4 offset:13824
    s_waitcnt lgkmcnt(5)
    v_exp_f32 v76, v76
    v_exp_f32 v77, v77
    v_exp_f32 v78, v78
    v_exp_f32 v79, v79
    v_mfma_f32_32x32x16_bf16 v[80:95], v[136:139], v[104:107], v[80:95]
    v_cvt_pk_bf16_f32 v108, v72, v73
    v_cvt_pk_bf16_f32 v109, v74, v75
    v_cvt_pk_bf16_f32 v110, v76, v77
    v_cvt_pk_bf16_f32 v111, v78, v79
    s_nop 1
    v_mfma_f32_32x32x16_bf16 v[80:95], v[140:143], v[108:111], v[80:95]
    s_mov_b64 exec, s[30:31]
    ds_read_b128 v[136:139], v6 offset:16640
    ds_read_b128 v[140:143], v6 offset:17280
    s_mov_b64 exec, -1
    s_waitcnt lgkmcnt(2)
    s_cmp_lt_u32 s47, 15
    s_cbranch_scc1 AT_WAIT26
AT_BACK26:
    v_mfma_f32_32x32x4_2b_bf16 v[48:79], v[118:119], v[116:117], 0
    ds_read_b64 v[118:119], v5 offset:22528
    v_exp_f32 v16, v16
    v_exp_f32 v17, v17
    v_exp_f32 v18, v18
    v_exp_f32 v19, v19
    v_exp_f32 v20, v20
    v_exp_f32 v21, v21
    v_exp_f32 v22, v22
    v_exp_f32 v23, v23
    v_cvt_pk_bf16_f32 v96, v16, v17
    v_cvt_pk_bf16_f32 v97, v18, v19
    v_cvt_pk_bf16_f32 v98, v20, v21
    v_cvt_pk_bf16_f32 v99, v22, v23
    v_exp_f32 v24, v24
    v_exp_f32 v25, v25
    v_exp_f32 v26, v26
    v_exp_f32 v27, v27
    v_exp_f32 v28, v28
    v_exp_f32 v29, v29
    v_exp_f32 v30, v30
    v_exp_f32 v31, v31
    v_mfma_f32_32x32x16_bf16 v[80:95], v[128:131], v[96:99], v[80:95]
    v_cvt_pk_bf16_f32 v100, v24, v25
    v_cvt_pk_bf16_f32 v101, v26, v27
    v_cvt_pk_bf16_f32 v102, v28, v29
    v_cvt_pk_bf16_f32 v103, v30, v31
    v_exp_f32 v32, v32
    v_exp_f32 v33, v33
    v_exp_f32 v34, v34
    v_exp_f32 v35, v35
    v_exp_f32 v36, v36
    v_exp_f32 v37, v37
    v_exp_f32 v38, v38
    v_exp_f32 v39, v39
    v_mfma_f32_32x32x16_bf16 v[80:95], v[132:135], v[100:103], v[80:95]
    s_mov_b64 exec, s[30:31]
    ds_read_b128 v[128:131], v6 offset:17920
    ds_read_b128 v[132:135], v6 offset:18560
    s_mov_b64 exec, -1
    v_mfma_f32_32x32x16_bf16 v[48:63], v[120:123], v[112:115], v[48:63]
    ds_read_b128 v[120:123], v4 offset:20480
    v_cvt_pk_bf16_f32 v104, v32, v33
    v_cvt_pk_bf16_f32 v105, v34, v35
    v_cvt_pk_bf16_f32 v106, v36, v37
    v_cvt_pk_bf16_f32 v107, v38, v39
    v_exp_f32 v40, v40
    v_exp_f32 v41, v41
    v_exp_f32 v42, v42
    v_exp_f32 v43, v43
    v_mfma_f32_32x32x16_bf16 v[64:79], v[124:127], v[112:115], v[64:79]
    ds_read_b128 v[124:127], v4 offset:21504
    s_waitcnt lgkmcnt(5)
    v_exp_f32 v44, v44
    v_exp_f32 v45, v45
    v_exp_f32 v46, v46
    v_exp_f32 v47, v47
    v_mfma_f32_32x32x16_bf16 v[80:95], v[136:139], v[104:107], v[80:95]
    v_cvt_pk_bf16_f32 v108, v40, v41
    v_cvt_pk_bf16_f32 v109, v42, v43
    v_cvt_pk_bf16_f32 v110, v44, v45
    v_cvt_pk_bf16_f32 v111, v46, v47
    s_nop 1
    v_mfma_f32_32x32x16_bf16 v[80:95], v[140:143], v[108:111], v[80:95]
    s_mov_b64 exec, s[30:31]
    ds_read_b128 v[136:139], v6 offset:19200
    ds_read_b128 v[140:143], v6 offset:19840
    s_mov_b64 exec, -1
    s_waitcnt lgkmcnt(2)
    v_mfma_f32_32x32x4_2b_bf16 v[16:47], v[118:119], v[116:117], 0
    ds_read_b64 v[118:119], v5 offset:25088
    v_exp_f32 v48, v48
    v_exp_f32 v49, v49
    v_exp_f32 v50, v50
    v_exp_f32 v51, v51
    v_exp_f32 v52, v52
    v_exp_f32 v53, v53
    v_exp_f32 v54, v54
    v_exp_f32 v55, v55
    v_cvt_pk_bf16_f32 v96, v48, v49
    v_cvt_pk_bf16_f32 v97, v50, v51
    v_cvt_pk_bf16_f32 v98, v52, v53
    v_cvt_pk_bf16_f32 v99, v54, v55
    v_exp_f32 v56, v56
    v_exp_f32 v57, v57
    v_exp_f32 v58, v58
    v_exp_f32 v59, v59
    v_exp_f32 v60, v60
    v_exp_f32 v61, v61
    v_exp_f32 v62, v62
    v_exp_f32 v63, v63
    v_mfma_f32_32x32x16_bf16 v[80:95], v[128:131], v[96:99], v[80:95]
    v_cvt_pk_bf16_f32 v100, v56, v57
    v_cvt_pk_bf16_f32 v101, v58, v59
    v_cvt_pk_bf16_f32 v102, v60, v61
    v_cvt_pk_bf16_f32 v103, v62, v63
    v_exp_f32 v64, v64
    v_exp_f32 v65, v65
    v_exp_f32 v66, v66
    v_exp_f32 v67, v67
    v_exp_f32 v68, v68
    v_exp_f32 v69, v69
    v_exp_f32 v70, v70
    v_exp_f32 v71, v71
    v_mfma_f32_32x32x16_bf16 v[80:95], v[132:135], v[100:103], v[80:95]
    s_mov_b64 exec, s[30:31]
    ds_read_b128 v[128:131], v6 offset:25600
    ds_read_b128 v[132:135], v6 offset:26240
    s_mov_b64 exec, -1
    v_mfma_f32_32x32x16_bf16 v[16:31], v[120:123], v[112:115], v[16:31]
    ds_read_b128 v[120:123], v4 offset:23040
    v_cvt_pk_bf16_f32 v104, v64, v65
    v_cvt_pk_bf16_f32 v105, v66, v67
    v_cvt_pk_bf16_f32 v106, v68, v69
    v_cvt_pk_bf16_f32 v107, v70, v71
    v_exp_f32 v72, v72
    v_exp_f32 v73, v73
    v_exp_f32 v74, v74
    v_exp_f32 v75, v75
    v_mfma_f32_32x32x16_bf16 v[32:47], v[124:127], v[112:115], v[32:47]
    ds_read_b128 v[124:127], v4 offset:24064
    s_waitcnt lgkmcnt(5)
    v_exp_f32 v76, v76
    v_exp_f32 v77, v77
    v_exp_f32 v78, v78
    v_exp_f32 v79, v79
    v_mfma_f32_32x32x16_bf16 v[80:95], v[136:139], v[104:107], v[80:95]
    v_cvt_pk_bf16_f32 v108, v72, v73
    v_cvt_pk_bf16_f32 v109, v74, v75
    v_cvt_pk_bf16_f32 v110, v76, v77
    v_cvt_pk_bf16_f32 v111, v78, v79
    s_nop 1
    v_mfma_f32_32x32x16_bf16 v[80:95], v[140:143], v[108:111], v[80:95]
    s_mov_b64 exec, s[30:31]
    ds_read_b128 v[136:139], v6 offset:26880
    ds_read_b128 v[140:143], v6 offset:27520
    s_mov_b64 exec, -1
    s_waitcnt lgkmcnt(2)
    s_cmp_lt_u32 s47, 16
    s_cbranch_scc1 AT_WAIT28
AT_BACK28:
    v_mfma_f32_32x32x4_2b_bf16 v[48:79], v[118:119], v[116:117], 0
    ds_read_b64 v[118:119], v145 offset:2048
    v_exp_f32 v16, v16
    v_exp_f32 v17, v17
    v_exp_f32 v18, v18
    v_exp_f32 v19, v19
    v_exp_f32 v20, v20
    v_exp_f32 v21, v21
    v_exp_f32 v22, v22
    v_exp_f32 v23, v23
    v_cvt_pk_bf16_f32 v96, v16, v17
    v_cvt_pk_bf16_f32 v97, v18, v19
    v_cvt_pk_bf16_f32 v98, v20, v21
    v_cvt_pk_bf16_f32 v99, v22, v23
    v_exp_f32 v24, v24
    v_exp_f32 v25, v25
    v_exp_f32 v26, v26
    v_exp_f32 v27, v27
    v_exp_f32 v28, v28
    v_exp_f32 v29, v29
    v_exp_f32 v30, v30
    v_exp_f32 v31, v31
    v_mfma_f32_32x32x16_bf16 v[80:95], v[128:131], v[96:99], v[80:95]
    v_cvt_pk_bf16_f32 v100, v24, v25
    v_cvt_pk_bf16_f32 v101, v26, v27
    v_cvt_pk_bf16_f32 v102, v28, v29
    v_cvt_pk_bf16_f32 v103, v30, v31
    v_exp_f32 v32, v32
    v_exp_f32 v33, v33
    v_exp_f32 v34, v34
    v_exp_f32 v35, v35
    v_exp_f32 v36, v36
    v_exp_f32 v37, v37
    v_exp_f32 v38, v38
    v_exp_f32 v39, v39
    v_mfma_f32_32x32x16_bf16 v[80:95], v[132:135], v[100:103], v[80:95]
    s_mov_b64 exec, s[30:31]
    ds_read_b128 v[128:131], v6 offset:28160
    ds_read_b128 v[132:135], v6 offset:28800
    s_mov_b64 exec, -1
    v_mfma_f32_32x32x16_bf16 v[48:63], v[120:123], v[112:115], v[48:63]
    ds_read_b128 v[120:123], v144 offset:0
    v_cvt_pk_bf16_f32 v104, v32, v33
    v_cvt_pk_bf16_f32 v105, v34, v35
    v_cvt_pk_bf16_f32 v106, v36, v37
    v_cvt_pk_bf16_f32 v107, v38, v39
    v_exp_f32 v40, v40
    v_exp_f32 v41, v41
    v_exp_f32 v42, v42
    v_exp_f32 v43, v43
    v_mfma_f32_32x32x16_bf16 v[64:79], v[124:127], v[112:115], v[64:79]
    ds_read_b128 v[124:127], v144 offset:1024
    s_waitcnt lgkmcnt(5)
    v_exp_f32 v44, v44
    v_exp_f32 v45, v45
    v_exp_f32 v46, v46
    v_exp_f32 v47, v47
    v_mfma_f32_32x32x16_bf16 v[80:95], v[136:139], v[104:107], v[80:95]
    v_cvt_pk_bf16_f32 v108, v40, v41
    v_cvt_pk_bf16_f32 v109, v42, v43
    v_cvt_pk_bf16_f32 v110, v44, v45
    v_cvt_pk_bf16_f32 v111, v46, v47
    s_nop 1
    v_mfma_f32_32x32x16_bf16 v[80:95], v[140:143], v[108:111], v[80:95]
    s_mov_b64 exec, s[30:31]
    ds_read_b128 v[136:139], v6 offset:29440
    ds_read_b128 v[140:143], v6 offset:30080
    s_mov_b64 exec, -1
    s_waitcnt lgkmcnt(2)
    v_mfma_f32_32x32x4_2b_bf16 v[16:47], v[118:119], v[116:117], 0
    ds_read_b64 v[118:119], v145 offset:4608
    v_exp_f32 v48, v48
    v_exp_f32 v49, v49
    v_exp_f32 v50, v50
    v_exp_f32 v51, v51
    v_exp_f32 v52, v52
    v_exp_f32 v53, v53
    v_exp_f32 v54, v54
    v_exp_f32 v55, v55
    v_cvt_pk_bf16_f32 v96, v48, v49
    v_cvt_pk_bf16_f32 v97, v50, v51
    v_cvt_pk_bf16_f32 v98, v52, v53
    v_cvt_pk_bf16_f32 v99, v54, v55
    v_exp_f32 v56, v56
    v_exp_f32 v57, v57
    v_exp_f32 v58, v58
    v_exp_f32 v59, v59
    v_exp_f32 v60, v60
    v_exp_f32 v61, v61
    v_exp_f32 v62, v62
    v_exp_f32 v63, v63
    v_mfma_f32_32x32x16_bf16 v[80:95], v[128:131], v[96:99], v[80:95]
    v_cvt_pk_bf16_f32 v100, v56, v57
    v_cvt_pk_bf16_f32 v101, v58, v59
    v_cvt_pk_bf16_f32 v102, v60, v61
    v_cvt_pk_bf16_f32 v103, v62, v63
    v_exp_f32 v64, v64
    v_exp_f32 v65, v65
    v_exp_f32 v66, v66
    v_exp_f32 v67, v67
    v_exp_f32 v68, v68
    v_exp_f32 v69, v69
    v_exp_f32 v70, v70
    v_exp_f32 v71, v71
    v_mfma_f32_32x32x16_bf16 v[80:95], v[132:135], v[100:103], v[80:95]
    s_mov_b64 exec, s[30:31]
    ds_read_b128 v[128:131], v146 offset:5120
    ds_read_b128 v[132:135], v146 offset:5760
    s_mov_b64 exec, -1
    v_mfma_f32_32x32x16_bf16 v[16:31], v[120:123], v[112:115], v[16:31]
    ds_read_b128 v[120:123], v144 offset:2560
    v_cvt_pk_bf16_f32 v104, v64, v65
    v_cvt_pk_bf16_f32 v105, v66, v67
    v_cvt_pk_bf16_f32 v106, v68, v69
    v_cvt_pk_bf16_f32 v107, v70, v71
    v_exp_f32 v72, v72
    v_exp_f32 v73, v73
    v_exp_f32 v74, v74
    v_exp_f32 v75, v75
    v_mfma_f32_32x32x16_bf16 v[32:47], v[124:127], v[112:115], v[32:47]
    ds_read_b128 v[124:127], v144 offset:3584
    s_waitcnt lgkmcnt(5)
    v_exp_f32 v76, v76
    v_exp_f32 v77, v77
    v_exp_f32 v78, v78
    v_exp_f32 v79, v79
    v_mfma_f32_32x32x16_bf16 v[80:95], v[136:139], v[104:107], v[80:95]
    v_cvt_pk_bf16_f32 v108, v72, v73
    v_cvt_pk_bf16_f32 v109, v74, v75
    v_cvt_pk_bf16_f32 v110, v76, v77
    v_cvt_pk_bf16_f32 v111, v78, v79
    s_nop 1
    v_mfma_f32_32x32x16_bf16 v[80:95], v[140:143], v[108:111], v[80:95]
    s_mov_b64 exec, s[30:31]
    ds_read_b128 v[136:139], v146 offset:6400
    ds_read_b128 v[140:143], v146 offset:7040
    s_mov_b64 exec, -1
    s_waitcnt lgkmcnt(2)
    v_mfma_f32_32x32x4_2b_bf16 v[48:79], v[118:119], v[116:117], 0
    v_exp_f32 v16, v16
    v_exp_f32 v17, v17
    v_exp_f32 v18, v18
    v_exp_f32 v19, v19
    v_exp_f32 v20, v20
    v_exp_f32 v21, v21
    v_exp_f32 v22, v22
    v_exp_f32 v23, v23
    v_cvt_pk_bf16_f32 v96, v16, v17
    v_cvt_pk_bf16_f32 v97, v18, v19
    v_cvt_pk_bf16_f32 v98, v20, v21
    v_cvt_pk_bf16_f32 v99, v22, v23
    v_exp_f32 v24, v24
    v_exp_f32 v25, v25
    v_exp_f32 v26, v26
    v_exp_f32 v27, v27
    v_exp_f32 v28, v28
    v_exp_f32 v29, v29
    v_exp_f32 v30, v30
    v_exp_f32 v31, v31
    v_mfma_f32_32x32x16_bf16 v[80:95], v[128:131], v[96:99], v[80:95]
    v_cvt_pk_bf16_f32 v100, v24, v25
    v_cvt_pk_bf16_f32 v101, v26, v27
    v_cvt_pk_bf16_f32 v102, v28, v29
    v_cvt_pk_bf16_f32 v103, v30, v31
    v_exp_f32 v32, v32
    v_exp_f32 v33, v33
    v_exp_f32 v34, v34
    v_exp_f32 v35, v35
    v_exp_f32 v36, v36
    v_exp_f32 v37, v37
    v_exp_f32 v38, v38
    v_exp_f32 v39, v39
    v_mfma_f32_32x32x16_bf16 v[80:95], v[132:135], v[100:103], v[80:95]
    s_mov_b64 exec, s[30:31]
    ds_read_b128 v[128:131], v146 offset:7680
    ds_read_b128 v[132:135], v146 offset:8320
    s_mov_b64 exec, -1
    v_mfma_f32_32x32x16_bf16 v[48:63], v[120:123], v[112:115], v[48:63]
    v_cvt_pk_bf16_f32 v104, v32, v33
    v_cvt_pk_bf16_f32 v105, v34, v35
    v_cvt_pk_bf16_f32 v106, v36, v37
    v_cvt_pk_bf16_f32 v107, v38, v39
    v_exp_f32 v40, v40
    v_exp_f32 v41, v41
    v_exp_f32 v42, v42
    v_exp_f32 v43, v43
    v_mfma_f32_32x32x16_bf16 v[64:79], v[124:127], v[112:115], v[64:79]
    s_waitcnt lgkmcnt(2)
    v_exp_f32 v44, v44
    v_exp_f32 v45, v45
    v_exp_f32 v46, v46
    v_exp_f32 v47, v47
    v_mfma_f32_32x32x16_bf16 v[80:95], v[136:139], v[104:107], v[80:95]
    v_cvt_pk_bf16_f32 v108, v40, v41
    v_cvt_pk_bf16_f32 v109, v42, v43
    v_cvt_pk_bf16_f32 v110, v44, v45
    v_cvt_pk_bf16_f32 v111, v46, v47
    s_nop 1
    v_mfma_f32_32x32x16_bf16 v[80:95], v[140:143], v[108:111], v[80:95]
    s_mov_b64 exec, s[30:31]
    ds_read_b128 v[136:139], v146 offset:8960
    ds_read_b128 v[140:143], v146 offset:9600
    s_mov_b64 exec, -1
    s_waitcnt lgkmcnt(2)
    v_exp_f32 v48, v48
    v_exp_f32 v49, v49
    v_exp_f32 v50, v50
    v_exp_f32 v51, v51
    v_exp_f32 v52, v52
    v_exp_f32 v53, v53
    v_exp_f32 v54, v54
    v_exp_f32 v55, v55
    v_cvt_pk_bf16_f32 v96, v48, v49
    v_cvt_pk_bf16_f32 v97, v50, v51
    v_cvt_pk_bf16_f32 v98, v52, v53
    v_cvt_pk_bf16_f32 v99, v54, v55
    v_exp_f32 v56, v56
    v_exp_f32 v57, v57
    v_exp_f32 v58, v58
    v_exp_f32 v59, v59
    v_exp_f32 v60, v60
    v_exp_f32 v61, v61
    v_exp_f32 v62, v62
    v_exp_f32 v63, v63
    v_mfma_f32_32x32x16_bf16 v[80:95], v[128:131], v[96:99], v[80:95]
    v_cvt_pk_bf16_f32 v100, v56, v57
    v_cvt_pk_bf16_f32 v101, v58, v59
    v_cvt_pk_bf16_f32 v102, v60, v61
    v_cvt_pk_bf16_f32 v103, v62, v63
    v_exp_f32 v64, v64
    v_exp_f32 v65, v65
    v_exp_f32 v66, v66
    v_exp_f32 v67, v67
    v_exp_f32 v68, v68
    v_exp_f32 v69, v69
    v_exp_f32 v70, v70
    v_exp_f32 v71, v71
    v_mfma_f32_32x32x16_bf16 v[80:95], v[132:135], v[100:103], v[80:95]
    v_cvt_pk_bf16_f32 v104, v64, v65
    v_cvt_pk_bf16_f32 v105, v66, v67
    v_cvt_pk_bf16_f32 v106, v68, v69
    v_cvt_pk_bf16_f32 v107, v70, v71
    v_exp_f32 v72, v72
    v_exp_f32 v73, v73
    v_exp_f32 v74, v74
    v_exp_f32 v75, v75
    s_waitcnt lgkmcnt(0)
    v_exp_f32 v76, v76
    v_exp_f32 v77, v77
    v_exp_f32 v78, v78
    v_exp_f32 v79, v79
    v_mfma_f32_32x32x16_bf16 v[80:95], v[136:139], v[104:107], v[80:95]
    v_cvt_pk_bf16_f32 v108, v72, v73
    v_cvt_pk_bf16_f32 v109, v74, v75
    v_cvt_pk_bf16_f32 v110, v76, v77
    v_cvt_pk_bf16_f32 v111, v78, v79
    s_nop 1
    v_mfma_f32_32x32x16_bf16 v[80:95], v[140:143], v[108:111], v[80:95]
    s_nop 11
    v_mov_b32 v10, v88
    v_mov_b32 v11, v88
    v_mul_f32 v12, 0, v80
    v_fma_f32 v12, v81, 0, v12
    v_fma_f32 v12, v82, 0, v12
    v_fma_f32 v12, v83, 0, v12
    v_fma_f32 v12, v84, 0, v12
    v_fma_f32 v12, v85, 0, v12
    v_fma_f32 v12, v86, 0, v12
    v_fma_f32 v12, v87, 0, v12
    v_fma_f32 v12, v88, 0, v12
    v_permlane32_swap_b32 v10, v11
    v_fma_f32 v12, v89, 0, v12
    v_fma_f32 v12, v90, 0, v12
    v_fma_f32 v12, v91, 0, v12
    s_mov_b32 s22, 0x1f800000
    s_mov_b32 s23, 0x71800000
    v_add_f32 v12, v12, v11
    v_cmp_nge_f32 s[24:25], v12, s22
    v_cmp_nle_f32 s[26:27], v12, s23
    s_nop 0
    s_or_b64 s[24:25], s[24:25], s[26:27]
    s_cmp_lg_u64 s[24:25], 0
    s_cbranch_scc1 AT_SLOW
AT_STORE:
    ds_read_b64 v[14:15], v7 offset:0
    v_rcp_f32 v11, v11
    v_lshlrev_b32 v8, 4, v0
    s_lshl_b32 s22, s18, 16
    s_lshl_b32 s23, s16, 11
    s_add_u32 s22, s22, s23
    s_add_u32 s22, s22, 16777216
    v_mul_f32 v80, v80, v11
    v_mul_f32 v81, v81, v11
    v_mul_f32 v82, v82, v11
    v_mul_f32 v83, v83, v11
    v_cvt_pk_bf16_f32 v108, v80, v81
    v_cvt_pk_bf16_f32 v109, v82, v83
    v_mul_f32 v84, v84, v11
    v_mul_f32 v85, v85, v11
    v_mul_f32 v86, v86, v11
    v_mul_f32 v87, v87, v11
    v_cvt_pk_bf16_f32 v110, v84, v85
    v_cvt_pk_bf16_f32 v112, v86, v87
    v_mul_f32 v88, v88, v11
    v_mul_f32 v89, v89, v11
    v_mul_f32 v90, v90, v11
    v_mul_f32 v91, v91, v11
    v_cvt_pk_bf16_f32 v113, v88, v89
    v_cvt_pk_bf16_f32 v114, v90, v91
    s_mov_b32 exec_lo, 0
    v_mov_b32 v113, 0
    v_mov_b32 v114, 0
    s_mov_b32 exec_lo, -1
    s_waitcnt lgkmcnt(0)
    v_mov_b32 v111, v14
    v_mov_b32 v115, v14
    v_readfirstlane_b32 s32, v14
    buffer_store_dwordx4 v[108:111], v8, s[12:15], s22 offen sc1
    buffer_store_dwordx4 v[112:115], v8, s[12:15], s22 offen offset:1024 sc1
    s_lshl_b32 s19, s18, 10
    s_lshl_b32 s24, s16, 5
    s_add_u32 s19, s19, s24
    s_add_u32 s19, s19, 16384000
    v_mov_b32 v13, 0
    s_mov_b64 exec, 1
    buffer_store_dwordx2 v[14:15], v13, s[12:15], s19 offen sc1
    s_mov_b64 exec, -1
    s_and_b32 s16, s2, 7
    s_lshr_b32 s17, s2, 3
    s_lshl_b32 s16, s16, 2
    s_and_b32 s18, s17, 3
    s_add_u32 s16, s16, s18
    s_lshr_b32 s17, s17, 2
    s_and_b32 s18, s3, 3
    s_lshr_b32 s19, s3, 2
    v_and_b32 v2, 15, v0
    v_lshrrev_b32 v3, 4, v0
    s_lshl_b32 s25, s16, 6
    s_lshl_b32 s26, s18, 4
    s_add_u32 s25, s25, s26
    v_lshlrev_b32 v9, 9, v3
    v_lshl_add_u32 v9, v2, 4, v9
    s_lshr_b32 s20, s25, 5
    s_lshl_b32 s20, s20, 16
    s_and_b32 s22, s18, 1
    s_lshl_b32 s22, s22, 8
    s_lshl_b32 s23, s19, 15
    s_add_u32 s20, s20, s22
    s_add_u32 s20, s20, s23
    s_add_u32 s36, s20, 16777216
    v_mov_b32 v1, 163584
    ds_read_b64 v[14:15], v1 offset:80
    s_add_u32 s37, s36, 4096
    s_add_u32 s38, s36, 8192
    s_add_u32 s39, s36, 12288
    s_add_u32 s40, s36, 16384
    s_add_u32 s41, s36, 20480
    s_add_u32 s42, s36, 24576
    s_add_u32 s43, s36, 28672
    s_mov_b32 s30, 0
    s_mov_b32 s31, 0
    s_lshl_b32 s33, s19, 4
    s_waitcnt lgkmcnt(0)
    v_readfirstlane_b32 s20, v14
    v_readfirstlane_b32 s21, v15
    s_bitcmp1_b32 s18, 1
    s_cselect_b32 s20, s21, s20
    s_lshr_b32 s20, s20, s33
    s_and_b32 s21, s20, 0xffff
    s_cmp_eq_u32 s21, 0xffff
    s_cselect_b32 s31, 15, 0
    s_bfe_u32 s21, s20, 0x40000
    s_bfe_u32 s22, s30, 0x10000
    s_sub_u32 s21, s21, s22
    s_cmp_lg_u32 s21, 15
    s_cbranch_scc1 OP_E_0
    buffer_load_dwordx4 v[44:47], v9, s[12:15], s36 offen offset:0 sc1
    buffer_load_dwordx4 v[48:51], v9, s[12:15], s36 offen offset:2048 sc1
    buffer_load_dwordx4 v[52:55], v9, s[12:15], s37 offen offset:0 sc1
    buffer_load_dwordx4 v[56:59], v9, s[12:15], s37 offen offset:2048 sc1
    s_bitset1_b32 s30, 0
OP_E_0:
    s_bfe_u32 s21, s20, 0x40004
    s_bfe_u32 s22, s30, 0x10001
    s_sub_u32 s21, s21, s22
    s_cmp_lg_u32 s21, 15
    s_cbranch_scc1 OP_E_1
    buffer_load_dwordx4 v[60:63], v9, s[12:15], s38 offen offset:0 sc1
    buffer_load_dwordx4 v[64:67], v9, s[12:15], s38 offen offset:2048 sc1
    buffer_load_dwordx4 v[68:71], v9, s[12:15], s39 offen offset:0 sc1
    buffer_load_dwordx4 v[72:75], v9, s[12:15], s39 offen offset:2048 sc1
    s_bitset1_b32 s30, 1
OP_E_1:
    s_bfe_u32 s21, s20, 0x40008
    s_bfe_u32 s22, s30, 0x10002
    s_sub_u32 s21, s21, s22
    s_cmp_lg_u32 s21, 15
    s_cbranch_scc1 OP_E_2
    buffer_load_dwordx4 v[76:79], v9, s[12:15], s40 offen offset:0 sc1
    buffer_load_dwordx4 v[80:83], v9, s[12:15], s40 offen offset:2048 sc1
    buffer_load_dwordx4 v[84:87], v9, s[12:15], s41 offen offset:0 sc1
    buffer_load_dwordx4 v[88:91], v9, s[12:15], s41 offen offset:2048 sc1
    s_bitset1_b32 s30, 2
OP_E_2:
    s_bfe_u32 s21, s20, 0x4000c
    s_bfe_u32 s22, s30, 0x10003
    s_sub_u32 s21, s21, s22
    s_cmp_lg_u32 s21, 15
    s_cbranch_scc1 OP_E_3
    buffer_load_dwordx4 v[92:95], v9, s[12:15], s42 offen offset:0 sc1
    buffer_load_dwordx4 v[96:99], v9, s[12:15], s42 offen offset:2048 sc1
    buffer_load_dwordx4 v[100:103], v9, s[12:15], s43 offen offset:0 sc1
    buffer_load_dwordx4 v[104:107], v9, s[12:15], s43 offen offset:2048 sc1
    s_bitset1_b32 s30, 3
OP_E_3:
    v_mov_b32 v10, 0x12818820
    v_mov_b32 v11, 0x1ac398a4
    v_cmp_eq_u32 vcc, 1, v3
    s_nop 1
    v_cndmask_b32 v10, v10, v11, vcc
    v_mov_b32 v11, 0x2728c16a
    v_cmp_eq_u32 vcc, 2, v3
    s_nop 1
    v_cndmask_b32 v10, v10, v11, vcc
    v_mov_b32 v11, 0x272291ee
    v_cmp_eq_u32 vcc, 3, v3
    s_nop 1
    v_cndmask_b32 v10, v10, v11, vcc
    v_bfe_u32 v4, v0, 2, 2
    v_and_b32 v11, 3, v0
    v_lshlrev_b32 v11, 3, v11
    s_mul_i32 s26, s19, 51200
    s_add_u32 s26, s26, 10240
    v_add_u32 v11, s26, v11
    v_mul_u32_u24 v12, 5, v4
    v_bfe_u32 v5, v10, v12, 5
    s_movk_i32 s27, 160
    v_mad_u32_u24 v5, v5, s27, v11
    v_cmp_gt_u32 vcc, 2, v4
    v_add_u32 v13, -10, v12
    v_add_u32 v14, 20, v12
    v_cndmask_b32 v13, v13, v14, vcc
    v_bfe_u32 v13, v10, v13, 5
    v_mov_b32 v14, 60
    v_cndmask_b32 v14, v14, 0, vcc
    v_add_u32 v13, v13, v14
    v_mad_u32_u24 v6, v13, s27, v11
    v_add_u32 v13, 0, v12
    v_add_u32 v14, 20, v12
    v_cndmask_b32 v13, v13, v14, vcc
    v_bfe_u32 v13, v10, v13, 5
    v_mov_b32 v14, 60
    v_cndmask_b32 v14, v14, 20, vcc
    v_add_u32 v13, v13, v14
    v_mad_u32_u24 v7, v13, s27, v11
    v_add_u32 v13, 10, v12
    v_add_u32 v14, 20, v12
    v_cndmask_b32 v13, v13, v14, vcc
    v_bfe_u32 v13, v10, v13, 5
    v_mov_b32 v14, 60
    v_cndmask_b32 v14, v14, 40, vcc
    v_add_u32 v13, v13, v14
    v_mad_u32_u24 v8, v13, s27, v11
    s_mul_i32 s24, s17, 80
    s_mul_i32 s26, s19, 48
    s_add_u32 s24, s24, s26
    v_add_u32 v12, s24, v2
    v_lshlrev_b32 v12, 12, v12
    v_lshl_add_u32 v12, v3, 3, v12
    s_lshl_b32 s26, s25, 1
    s_add_u32 s26, s26, 20971520
    s_add_u32 s27, s26, 65536
    s_add_u32 s28, s26, 131072
    s_cmp_eq_u32 s19, 1
    s_cselect_b32 s28, s27, s28
    s_lshl_b32 s29, s25, 2
    s_add_u32 s29, s29, 16252928
    v_lshlrev_b32 v13, 2, v2
    s_mov_b32 s35, 0
LW5:
    ds_read_b32 v14, v1 offset:76
    s_waitcnt lgkmcnt(0)
    v_readfirstlane_b32 s34, v14
    s_nop 0
    s_cmp_ge_u32 s34, 1
    s_cbranch_scc1 LD6
    s_sleep 1
    s_branch LW5
LD6:
    buffer_load_dwordx2 v[36:37], v12, s[12:15], s26 offen sc1
    buffer_load_dwordx2 v[38:39], v12, s[12:15], s27 offen sc1
    buffer_load_dwordx2 v[40:41], v12, s[12:15], s28 offen sc1
    buffer_load_dword v42, v13, s[12:15], s29 offen sc1
    ds_read_b64_tr_b16 v[108:109], v5 offset:0
    ds_read_b64_tr_b16 v[110:111], v6 offset:0
    ds_read_b64_tr_b16 v[112:113], v5 offset:32
    ds_read_b64_tr_b16 v[114:115], v6 offset:32
    ds_read_b64_tr_b16 v[116:117], v5 offset:64
    ds_read_b64_tr_b16 v[118:119], v6 offset:64
    ds_read_b64_tr_b16 v[120:121], v5 offset:96
    ds_read_b64_tr_b16 v[122:123], v6 offset:96
    ds_read_b64_tr_b16 v[124:125], v5 offset:128
    ds_read_b64_tr_b16 v[126:127], v6 offset:128
    ds_read_b64_tr_b16 v[128:129], v5 offset:3200
    ds_read_b64_tr_b16 v[130:131], v7 offset:0
    ds_read_b64_tr_b16 v[132:133], v5 offset:3232
    ds_read_b64_tr_b16 v[134:135], v7 offset:32
    ds_read_b64_tr_b16 v[136:137], v5 offset:3264
    ds_read_b64_tr_b16 v[138:139], v7 offset:64
    ds_read_b64_tr_b16 v[140:141], v5 offset:3296
    ds_read_b64_tr_b16 v[142:143], v7 offset:96
    ds_read_b64_tr_b16 v[144:145], v5 offset:3328
    ds_read_b64_tr_b16 v[146:147], v7 offset:128
    s_waitcnt lgkmcnt(5)
    ds_read_b64_tr_b16 v[148:149], v5 offset:6400
    ds_read_b64_tr_b16 v[150:151], v8 offset:0
    ds_read_b64_tr_b16 v[152:153], v5 offset:6432
    ds_read_b64_tr_b16 v[154:155], v8 offset:32
    ds_read_b64_tr_b16 v[156:157], v5 offset:6464
    ds_read_b64_tr_b16 v[158:159], v8 offset:64
    ds_read_b64_tr_b16 v[160:161], v5 offset:6496
    ds_read_b64_tr_b16 v[162:163], v8 offset:96
    ds_read_b64_tr_b16 v[164:165], v5 offset:6528
    ds_read_b64_tr_b16 v[166:167], v8 offset:128
    s_mov_b32 s8, s66
    s_mov_b32 s9, s67
    s_mov_b32 s10, 0x280000
    s_mov_b32 s11, 0x00020000
    s_mul_i32 s26, s3, 3072
    s_add_u32 s26, s26, 112640
    v_lshl_add_u32 v10, v0, 4, s26
    s_xor_b32 s27, s3, 4
    s_mul_i32 s27, s27, 3072
    s_add_u32 s27, s27, 112640
    v_lshl_add_u32 v11, v0, 4, s27
    v_mul_u32_u24 v4, 1280, v2
    v_lshl_add_u32 v4, v3, 3, v4
    s_mul_i32 s26, s25, 1280
    s_lshl_b32 s27, s24, 1
    s_add_u32 s26, s26, s27
    s_cmp_lg_u32 s31, 15
    s_cbranch_scc1 OP_W0
    s_waitcnt vmcnt(16)
OP_CK0:
    v_cmp_ne_u32 s[20:21], s32, v47
    v_cmp_ne_u32 s[22:23], s32, v51
    v_cmp_ne_u32 s[28:29], s32, v55
    v_cmp_ne_u32 vcc, s32, v59
    s_or_b64 s[20:21], s[20:21], s[22:23]
    s_or_b64 vcc, vcc, s[28:29]
    s_or_b64 vcc, vcc, s[20:21]
    s_cbranch_vccnz OP_RT0
OP_GO0:
    v_mov_b32 v47, v56
    v_mov_b32 v51, v57
    v_mov_b32 v55, v58
    s_waitcnt lgkmcnt(15)
    v_mfma_f32_16x16x32_bf16 v[16:19], v[108:111], v[44:47], 0
    v_mfma_f32_16x16x32_bf16 v[20:23], v[112:115], v[44:47], 0
    v_mfma_f32_16x16x32_bf16 v[24:27], v[116:119], v[44:47], 0
    v_mfma_f32_16x16x32_bf16 v[28:31], v[120:123], v[44:47], 0
    v_mfma_f32_16x16x32_bf16 v[32:35], v[124:127], v[44:47], 0
    ds_read_b64_tr_b16 v[108:109], v5 offset:12800
    ds_read_b64_tr_b16 v[110:111], v6 offset:12800
    ds_read_b64_tr_b16 v[112:113], v5 offset:12832
    ds_read_b64_tr_b16 v[114:115], v6 offset:12832
    ds_read_b64_tr_b16 v[116:117], v5 offset:12864
    ds_read_b64_tr_b16 v[118:119], v6 offset:12864
    ds_read_b64_tr_b16 v[120:121], v5 offset:12896
    ds_read_b64_tr_b16 v[122:123], v6 offset:12896
    ds_read_b64_tr_b16 v[124:125], v5 offset:12928
    ds_read_b64_tr_b16 v[126:127], v6 offset:12928
    s_waitcnt lgkmcnt(15)
    v_mfma_f32_16x16x32_bf16 v[16:19], v[128:131], v[48:51], v[16:19]
    v_mfma_f32_16x16x32_bf16 v[20:23], v[132:135], v[48:51], v[20:23]
    v_mfma_f32_16x16x32_bf16 v[24:27], v[136:139], v[48:51], v[24:27]
    v_mfma_f32_16x16x32_bf16 v[28:31], v[140:143], v[48:51], v[28:31]
    v_mfma_f32_16x16x32_bf16 v[32:35], v[144:147], v[48:51], v[32:35]
    ds_read_b64_tr_b16 v[128:129], v5 offset:16000
    ds_read_b64_tr_b16 v[130:131], v7 offset:12800
    ds_read_b64_tr_b16 v[132:133], v5 offset:16032
    ds_read_b64_tr_b16 v[134:135], v7 offset:12832
    ds_read_b64_tr_b16 v[136:137], v5 offset:16064
    ds_read_b64_tr_b16 v[138:139], v7 offset:12864
    ds_read_b64_tr_b16 v[140:141], v5 offset:16096
    ds_read_b64_tr_b16 v[142:143], v7 offset:12896
    ds_read_b64_tr_b16 v[144:145], v5 offset:16128
    ds_read_b64_tr_b16 v[146:147], v7 offset:12928
    s_waitcnt lgkmcnt(15)
    v_mfma_f32_16x16x32_bf16 v[16:19], v[148:151], v[52:55], v[16:19]
    v_mfma_f32_16x16x32_bf16 v[20:23], v[152:155], v[52:55], v[20:23]
    v_mfma_f32_16x16x32_bf16 v[24:27], v[156:159], v[52:55], v[24:27]
    v_mfma_f32_16x16x32_bf16 v[28:31], v[160:163], v[52:55], v[28:31]
    v_mfma_f32_16x16x32_bf16 v[32:35], v[164:167], v[52:55], v[32:35]
    ds_read_b64_tr_b16 v[148:149], v5 offset:19200
    ds_read_b64_tr_b16 v[150:151], v8 offset:12800
    ds_read_b64_tr_b16 v[152:153], v5 offset:19232
    ds_read_b64_tr_b16 v[154:155], v8 offset:12832
    ds_read_b64_tr_b16 v[156:157], v5 offset:19264
    ds_read_b64_tr_b16 v[158:159], v8 offset:12864
    ds_read_b64_tr_b16 v[160:161], v5 offset:19296
    ds_read_b64_tr_b16 v[162:163], v8 offset:12896
    ds_read_b64_tr_b16 v[164:165], v5 offset:19328
    ds_read_b64_tr_b16 v[166:167], v8 offset:12928
    s_cmp_lg_u32 s31, 15
    s_cbranch_scc1 OP_W1
    s_waitcnt vmcnt(12)
OP_CK1:
    v_cmp_ne_u32 s[20:21], s32, v63
    v_cmp_ne_u32 s[22:23], s32, v67
    v_cmp_ne_u32 s[28:29], s32, v71
    v_cmp_ne_u32 vcc, s32, v75
    s_or_b64 s[20:21], s[20:21], s[22:23]
    s_or_b64 vcc, vcc, s[28:29]
    s_or_b64 vcc, vcc, s[20:21]
    s_cbranch_vccnz OP_RT1
OP_GO1:
    v_mov_b32 v63, v72
    v_mov_b32 v67, v73
    v_mov_b32 v71, v74
    s_waitcnt lgkmcnt(15)
    v_mfma_f32_16x16x32_bf16 v[16:19], v[108:111], v[60:63], v[16:19]
    v_mfma_f32_16x16x32_bf16 v[20:23], v[112:115], v[60:63], v[20:23]
    v_mfma_f32_16x16x32_bf16 v[24:27], v[116:119], v[60:63], v[24:27]
    v_mfma_f32_16x16x32_bf16 v[28:31], v[120:123], v[60:63], v[28:31]
    v_mfma_f32_16x16x32_bf16 v[32:35], v[124:127], v[60:63], v[32:35]
    ds_read_b64_tr_b16 v[108:109], v5 offset:25600
    ds_read_b64_tr_b16 v[110:111], v6 offset:25600
    ds_read_b64_tr_b16 v[112:113], v5 offset:25632
    ds_read_b64_tr_b16 v[114:115], v6 offset:25632
    ds_read_b64_tr_b16 v[116:117], v5 offset:25664
    ds_read_b64_tr_b16 v[118:119], v6 offset:25664
    ds_read_b64_tr_b16 v[120:121], v5 offset:25696
    ds_read_b64_tr_b16 v[122:123], v6 offset:25696
    ds_read_b64_tr_b16 v[124:125], v5 offset:25728
    ds_read_b64_tr_b16 v[126:127], v6 offset:25728
    s_waitcnt lgkmcnt(15)
    v_mfma_f32_16x16x32_bf16 v[16:19], v[128:131], v[64:67], v[16:19]
    v_mfma_f32_16x16x32_bf16 v[20:23], v[132:135], v[64:67], v[20:23]
    v_mfma_f32_16x16x32_bf16 v[24:27], v[136:139], v[64:67], v[24:27]
    v_mfma_f32_16x16x32_bf16 v[28:31], v[140:143], v[64:67], v[28:31]
    v_mfma_f32_16x16x32_bf16 v[32:35], v[144:147], v[64:67], v[32:35]
    ds_read_b64_tr_b16 v[128:129], v5 offset:28800
    ds_read_b64_tr_b16 v[130:131], v7 offset:25600
    ds_read_b64_tr_b16 v[132:133], v5 offset:28832
    ds_read_b64_tr_b16 v[134:135], v7 offset:25632
    ds_read_b64_tr_b16 v[136:137], v5 offset:28864
    ds_read_b64_tr_b16 v[138:139], v7 offset:25664
    ds_read_b64_tr_b16 v[140:141], v5 offset:28896
    ds_read_b64_tr_b16 v[142:143], v7 offset:25696
    ds_read_b64_tr_b16 v[144:145], v5 offset:28928
    ds_read_b64_tr_b16 v[146:147], v7 offset:25728
    s_waitcnt lgkmcnt(15)
    v_mfma_f32_16x16x32_bf16 v[16:19], v[148:151], v[68:71], v[16:19]
    v_mfma_f32_16x16x32_bf16 v[20:23], v[152:155], v[68:71], v[20:23]
    v_mfma_f32_16x16x32_bf16 v[24:27], v[156:159], v[68:71], v[24:27]
    v_mfma_f32_16x16x32_bf16 v[28:31], v[160:163], v[68:71], v[28:31]
    v_mfma_f32_16x16x32_bf16 v[32:35], v[164:167], v[68:71], v[32:35]
    ds_read_b64_tr_b16 v[148:149], v5 offset:32000
    ds_read_b64_tr_b16 v[150:151], v8 offset:25600
    ds_read_b64_tr_b16 v[152:153], v5 offset:32032
    ds_read_b64_tr_b16 v[154:155], v8 offset:25632
    ds_read_b64_tr_b16 v[156:157], v5 offset:32064
    ds_read_b64_tr_b16 v[158:159], v8 offset:25664
    ds_read_b64_tr_b16 v[160:161], v5 offset:32096
    ds_read_b64_tr_b16 v[162:163], v8 offset:25696
    ds_read_b64_tr_b16 v[164:165], v5 offset:32128
    ds_read_b64_tr_b16 v[166:167], v8 offset:25728
    s_cmp_lg_u32 s31, 15
    s_cbranch_scc1 OP_W2
    s_waitcnt vmcnt(8)
OP_CK2:
    v_cmp_ne_u32 s[20:21], s32, v79
    v_cmp_ne_u32 s[22:23], s32, v83
    v_cmp_ne_u32 s[28:29], s32, v87
    v_cmp_ne_u32 vcc, s32, v91
    s_or_b64 s[20:21], s[20:21], s[22:23]
    s_or_b64 vcc, vcc, s[28:29]
    s_or_b64 vcc, vcc, s[20:21]
    s_cbranch_vccnz OP_RT2
OP_GO2:
    v_mov_b32 v79, v88
    v_mov_b32 v83, v89
    v_mov_b32 v87, v90
    s_waitcnt lgkmcnt(15)
    v_mfma_f32_16x16x32_bf16 v[16:19], v[108:111], v[76:79], v[16:19]
    v_mfma_f32_16x16x32_bf16 v[20:23], v[112:115], v[76:79], v[20:23]
    v_mfma_f32_16x16x32_bf16 v[24:27], v[116:119], v[76:79], v[24:27]
    v_mfma_f32_16x16x32_bf16 v[28:31], v[120:123], v[76:79], v[28:31]
    v_mfma_f32_16x16x32_bf16 v[32:35], v[124:127], v[76:79], v[32:35]
    ds_read_b64_tr_b16 v[108:109], v5 offset:38400
    ds_read_b64_tr_b16 v[110:111], v6 offset:38400
    ds_read_b64_tr_b16 v[112:113], v5 offset:38432
    ds_read_b64_tr_b16 v[114:115], v6 offset:38432
    ds_read_b64_tr_b16 v[116:117], v5 offset:38464
    ds_read_b64_tr_b16 v[118:119], v6 offset:38464
    ds_read_b64_tr_b16 v[120:121], v5 offset:38496
    ds_read_b64_tr_b16 v[122:123], v6 offset:38496
    ds_read_b64_tr_b16 v[124:125], v5 offset:38528
    ds_read_b64_tr_b16 v[126:127], v6 offset:38528
    s_waitcnt lgkmcnt(15)
    v_mfma_f32_16x16x32_bf16 v[16:19], v[128:131], v[80:83], v[16:19]
    v_mfma_f32_16x16x32_bf16 v[20:23], v[132:135], v[80:83], v[20:23]
    v_mfma_f32_16x16x32_bf16 v[24:27], v[136:139], v[80:83], v[24:27]
    v_mfma_f32_16x16x32_bf16 v[28:31], v[140:143], v[80:83], v[28:31]
    v_mfma_f32_16x16x32_bf16 v[32:35], v[144:147], v[80:83], v[32:35]
    ds_read_b64_tr_b16 v[128:129], v5 offset:41600
    ds_read_b64_tr_b16 v[130:131], v7 offset:38400
    ds_read_b64_tr_b16 v[132:133], v5 offset:41632
    ds_read_b64_tr_b16 v[134:135], v7 offset:38432
    ds_read_b64_tr_b16 v[136:137], v5 offset:41664
    ds_read_b64_tr_b16 v[138:139], v7 offset:38464
    ds_read_b64_tr_b16 v[140:141], v5 offset:41696
    ds_read_b64_tr_b16 v[142:143], v7 offset:38496
    ds_read_b64_tr_b16 v[144:145], v5 offset:41728
    ds_read_b64_tr_b16 v[146:147], v7 offset:38528
    v_lshlrev_b32 v13, 2, v3
    v_sub_u32 v13, v2, v13
    v_mov_b32 v56, 0
    v_mov_b32 v57, 0
    v_mov_b32 v14, 0x3f80
    v_mov_b32 v15, 0x3f800000
    v_cmp_eq_u32 vcc, 0, v13
    s_nop 1
    v_cndmask_b32 v56, v56, v14, vcc
    v_cmp_eq_u32 vcc, 1, v13
    s_nop 1
    v_cndmask_b32 v56, v56, v15, vcc
    v_cmp_eq_u32 vcc, 2, v13
    s_nop 1
    v_cndmask_b32 v57, v57, v14, vcc
    v_cmp_eq_u32 vcc, 3, v13
    s_nop 1
    v_cndmask_b32 v57, v57, v15, vcc
    s_cmp_lg_u32 s31, 15
    s_cbranch_scc1 OP_YOK
    s_waitcnt vmcnt(0)
OP_YOK:
    v_mfma_f32_16x16x16_bf16 v[44:47], v[36:37], v[56:57], 0
    v_mfma_f32_16x16x16_bf16 v[48:51], v[38:39], v[56:57], 0
    v_mfma_f32_16x16x16_bf16 v[52:55], v[40:41], v[56:57], 0
    v_sub_f32 v43, 1.0, v42
    v_cvt_pk_bf16_f32 v43, v43, v43
    v_lshlrev_b32 v43, 16, v43
    s_waitcnt lgkmcnt(15)
    v_mfma_f32_16x16x32_bf16 v[16:19], v[148:151], v[84:87], v[16:19]
    v_mfma_f32_16x16x32_bf16 v[20:23], v[152:155], v[84:87], v[20:23]
    v_mfma_f32_16x16x32_bf16 v[24:27], v[156:159], v[84:87], v[24:27]
    v_mfma_f32_16x16x32_bf16 v[28:31], v[160:163], v[84:87], v[28:31]
    v_mfma_f32_16x16x32_bf16 v[32:35], v[164:167], v[84:87], v[32:35]
    ds_read_b64_tr_b16 v[148:149], v5 offset:44800
    ds_read_b64_tr_b16 v[150:151], v8 offset:38400
    ds_read_b64_tr_b16 v[152:153], v5 offset:44832
    ds_read_b64_tr_b16 v[154:155], v8 offset:38432
    ds_read_b64_tr_b16 v[156:157], v5 offset:44864
    ds_read_b64_tr_b16 v[158:159], v8 offset:38464
    ds_read_b64_tr_b16 v[160:161], v5 offset:44896
    ds_read_b64_tr_b16 v[162:163], v8 offset:38496
    ds_read_b64_tr_b16 v[164:165], v5 offset:44928
    ds_read_b64_tr_b16 v[166:167], v8 offset:38528
    s_cmp_lg_u32 s31, 15
    s_cbranch_scc1 OP_W3
    s_waitcnt vmcnt(4)
OP_CK3:
    v_cmp_ne_u32 s[20:21], s32, v95
    v_cmp_ne_u32 s[22:23], s32, v99
    v_cmp_ne_u32 s[28:29], s32, v103
    v_cmp_ne_u32 vcc, s32, v107
    s_or_b64 s[20:21], s[20:21], s[22:23]
    s_or_b64 vcc, vcc, s[28:29]
    s_or_b64 vcc, vcc, s[20:21]
    s_cbranch_vccnz OP_RT3
OP_GO3:
    v_mov_b32 v95, v104
    v_mov_b32 v99, v105
    v_mov_b32 v103, v106
    s_waitcnt lgkmcnt(15)
    v_mfma_f32_16x16x32_bf16 v[16:19], v[108:111], v[92:95], v[16:19]
    v_mfma_f32_16x16x32_bf16 v[20:23], v[112:115], v[92:95], v[20:23]
    v_mfma_f32_16x16x32_bf16 v[24:27], v[116:119], v[92:95], v[24:27]
    v_mfma_f32_16x16x32_bf16 v[28:31], v[120:123], v[92:95], v[28:31]
    v_mfma_f32_16x16x32_bf16 v[32:35], v[124:127], v[92:95], v[32:35]
    v_mul_f32 v44, v44, v43
    v_mul_f32 v45, v45, v43
    v_mul_f32 v46, v46, v43
    v_mul_f32 v47, v47, v43
    v_mul_f32 v48, v48, v43
    v_mul_f32 v49, v49, v43
    v_mul_f32 v50, v50, v43
    v_mul_f32 v51, v51, v43
    v_mul_f32 v52, v52, v43
    v_mul_f32 v53, v53, v43
    v_mul_f32 v54, v54, v43
    v_mul_f32 v55, v55, v43
    s_waitcnt lgkmcnt(10)
    v_mfma_f32_16x16x32_bf16 v[16:19], v[128:131], v[96:99], v[16:19]
    v_mfma_f32_16x16x32_bf16 v[20:23], v[132:135], v[96:99], v[20:23]
    v_mfma_f32_16x16x32_bf16 v[24:27], v[136:139], v[96:99], v[24:27]
    v_mfma_f32_16x16x32_bf16 v[28:31], v[140:143], v[96:99], v[28:31]
    v_mfma_f32_16x16x32_bf16 v[32:35], v[144:147], v[96:99], v[32:35]
    s_waitcnt lgkmcnt(0)
    v_mfma_f32_16x16x32_bf16 v[16:19], v[148:151], v[100:103], v[16:19]
    v_mfma_f32_16x16x32_bf16 v[20:23], v[152:155], v[100:103], v[20:23]
    v_mfma_f32_16x16x32_bf16 v[24:27], v[156:159], v[100:103], v[24:27]
    v_mfma_f32_16x16x32_bf16 v[28:31], v[160:163], v[100:103], v[28:31]
    v_mfma_f32_16x16x32_bf16 v[32:35], v[164:167], v[100:103], v[32:35]
    s_barrier
    s_cmp_eq_u32 s19, 0
    s_cbranch_scc1 OP_KH0
    s_nop 0
    ds_write_b128 v10, v[16:19] offset:0
    ds_write_b128 v10, v[20:23] offset:1024
    ds_write_b128 v10, v[24:27] offset:2048
    s_waitcnt lgkmcnt(0)
    s_barrier
    ds_read_b128 v[108:111], v11 offset:0
    ds_read_b128 v[112:115], v11 offset:1024
    s_waitcnt lgkmcnt(1)
    v_add_f32 v28, v28, v108
    v_fma_f32 v28, v28, v42, v44
    v_add_f32 v29, v29, v109
    v_fma_f32 v29, v29, v42, v45
    v_add_f32 v30, v30, v110
    v_fma_f32 v30, v30, v42, v46
    v_add_f32 v31, v31, v111
    v_fma_f32 v31, v31, v42, v47
    v_cvt_pk_bf16_f32 v36, v28, v29
    v_cvt_pk_bf16_f32 v37, v30, v31
    buffer_store_dwordx2 v[36:37], v4, s[8:11], s26 offen offset:0
    s_waitcnt lgkmcnt(0)
    v_add_f32 v32, v32, v112
    v_fma_f32 v32, v32, v42, v48
    v_add_f32 v33, v33, v113
    v_fma_f32 v33, v33, v42, v49
    v_add_f32 v34, v34, v114
    v_fma_f32 v34, v34, v42, v50
    v_add_f32 v35, v35, v115
    v_fma_f32 v35, v35, v42, v51
    v_cvt_pk_bf16_f32 v38, v32, v33
    v_cvt_pk_bf16_f32 v39, v34, v35
    buffer_store_dwordx2 v[38:39], v4, s[8:11], s26 offen offset:32
    s_endpgm
OP_KH0:
    s_nop 7
    ds_write_b128 v10, v[28:31] offset:0
    ds_write_b128 v10, v[32:35] offset:1024
    s_waitcnt lgkmcnt(0)
    s_barrier
    ds_read_b128 v[108:111], v11 offset:0
    ds_read_b128 v[112:115], v11 offset:1024
    ds_read_b128 v[116:119], v11 offset:2048
    s_waitcnt lgkmcnt(2)
    v_add_f32 v16, v16, v108
    v_fma_f32 v16, v16, v42, v44
    v_add_f32 v17, v17, v109
    v_fma_f32 v17, v17, v42, v45
    v_add_f32 v18, v18, v110
    v_fma_f32 v18, v18, v42, v46
    v_add_f32 v19, v19, v111
    v_fma_f32 v19, v19, v42, v47
    v_cvt_pk_bf16_f32 v36, v16, v17
    v_cvt_pk_bf16_f32 v37, v18, v19
    buffer_store_dwordx2 v[36:37], v4, s[8:11], s26 offen offset:0
    s_waitcnt lgkmcnt(1)
    v_add_f32 v20, v20, v112
    v_fma_f32 v20, v20, v42, v48
    v_add_f32 v21, v21, v113
    v_fma_f32 v21, v21, v42, v49
    v_add_f32 v22, v22, v114
    v_fma_f32 v22, v22, v42, v50
    v_add_f32 v23, v23, v115
    v_fma_f32 v23, v23, v42, v51
    v_cvt_pk_bf16_f32 v38, v20, v21
    v_cvt_pk_bf16_f32 v39, v22, v23
    buffer_store_dwordx2 v[38:39], v4, s[8:11], s26 offen offset:32
    s_waitcnt lgkmcnt(0)
    v_add_f32 v24, v24, v116
    v_fma_f32 v24, v24, v42, v52
    v_add_f32 v25, v25, v117
    v_fma_f32 v25, v25, v42, v53
    v_add_f32 v26, v26, v118
    v_fma_f32 v26, v26, v42, v54
    v_add_f32 v27, v27, v119
    v_fma_f32 v27, v27, v42, v55
    v_cvt_pk_bf16_f32 v40, v24, v25
    v_cvt_pk_bf16_f32 v41, v26, v27
    buffer_store_dwordx2 v[40:41], v4, s[8:11], s26 offen offset:64
    s_endpgm
OP_W0:
    ds_read_b64 v[14:15], v1 offset:80
    s_waitcnt lgkmcnt(0)
    v_readfirstlane_b32 s20, v14
    v_readfirstlane_b32 s21, v15
    s_bitcmp1_b32 s18, 1
    s_cselect_b32 s20, s21, s20
    s_lshr_b32 s20, s20, s33
    s_bfe_u32 s21, s20, 0x40000
    s_bfe_u32 s22, s30, 0x10000
    s_sub_u32 s21, s21, s22
    s_cmp_lg_u32 s21, 15
    s_cbranch_scc1 OP_N0_0
    buffer_load_dwordx4 v[44:47], v9, s[12:15], s36 offen offset:0 sc1
    buffer_load_dwordx4 v[48:51], v9, s[12:15], s36 offen offset:2048 sc1
    buffer_load_dwordx4 v[52:55], v9, s[12:15], s37 offen offset:0 sc1
    buffer_load_dwordx4 v[56:59], v9, s[12:15], s37 offen offset:2048 sc1
    s_bitset1_b32 s30, 0
OP_N0_0:
    s_bfe_u32 s21, s20, 0x40004
    s_bfe_u32 s22, s30, 0x10001
    s_sub_u32 s21, s21, s22
    s_cmp_lg_u32 s21, 15
    s_cbranch_scc1 OP_N0_1
    buffer_load_dwordx4 v[60:63], v9, s[12:15], s38 offen offset:0 sc1
    buffer_load_dwordx4 v[64:67], v9, s[12:15], s38 offen offset:2048 sc1
    buffer_load_dwordx4 v[68:71], v9, s[12:15], s39 offen offset:0 sc1
    buffer_load_dwordx4 v[72:75], v9, s[12:15], s39 offen offset:2048 sc1
    s_bitset1_b32 s30, 1
OP_N0_1:
    s_bfe_u32 s21, s20, 0x40008
    s_bfe_u32 s22, s30, 0x10002
    s_sub_u32 s21, s21, s22
    s_cmp_lg_u32 s21, 15
    s_cbranch_scc1 OP_N0_2
    buffer_load_dwordx4 v[76:79], v9, s[12:15], s40 offen offset:0 sc1
    buffer_load_dwordx4 v[80:83], v9, s[12:15], s40 offen offset:2048 sc1
    buffer_load_dwordx4 v[84:87], v9, s[12:15], s41 offen offset:0 sc1
    buffer_load_dwordx4 v[88:91], v9, s[12:15], s41 offen offset:2048 sc1
    s_bitset1_b32 s30, 2
OP_N0_2:
    s_bfe_u32 s21, s20, 0x4000c
    s_bfe_u32 s22, s30, 0x10003
    s_sub_u32 s21, s21, s22
    s_cmp_lg_u32 s21, 15
    s_cbranch_scc1 OP_N0_3
    buffer_load_dwordx4 v[92:95], v9, s[12:15], s42 offen offset:0 sc1
    buffer_load_dwordx4 v[96:99], v9, s[12:15], s42 offen offset:2048 sc1
    buffer_load_dwordx4 v[100:103], v9, s[12:15], s43 offen offset:0 sc1
    buffer_load_dwordx4 v[104:107], v9, s[12:15], s43 offen offset:2048 sc1
    s_bitset1_b32 s30, 3
OP_N0_3:
    s_bitcmp1_b32 s31, 0
    s_cbranch_scc1 OP_CK0
    s_bitcmp1_b32 s30, 0
    s_cbranch_scc1 OP_D0
    s_sleep 1
    s_branch OP_W0
OP_D0:
    s_waitcnt vmcnt(0)
    s_mov_b32 s31, s30
    s_branch OP_CK0
OP_W1:
    ds_read_b64 v[14:15], v1 offset:80
    s_waitcnt lgkmcnt(0)
    v_readfirstlane_b32 s20, v14
    v_readfirstlane_b32 s21, v15
    s_bitcmp1_b32 s18, 1
    s_cselect_b32 s20, s21, s20
    s_lshr_b32 s20, s20, s33
    s_bfe_u32 s21, s20, 0x40004
    s_bfe_u32 s22, s30, 0x10001
    s_sub_u32 s21, s21, s22
    s_cmp_lg_u32 s21, 15
    s_cbranch_scc1 OP_N1_1
    buffer_load_dwordx4 v[60:63], v9, s[12:15], s38 offen offset:0 sc1
    buffer_load_dwordx4 v[64:67], v9, s[12:15], s38 offen offset:2048 sc1
    buffer_load_dwordx4 v[68:71], v9, s[12:15], s39 offen offset:0 sc1
    buffer_load_dwordx4 v[72:75], v9, s[12:15], s39 offen offset:2048 sc1
    s_bitset1_b32 s30, 1
OP_N1_1:
    s_bfe_u32 s21, s20, 0x40008
    s_bfe_u32 s22, s30, 0x10002
    s_sub_u32 s21, s21, s22
    s_cmp_lg_u32 s21, 15
    s_cbranch_scc1 OP_N1_2
    buffer_load_dwordx4 v[76:79], v9, s[12:15], s40 offen offset:0 sc1
    buffer_load_dwordx4 v[80:83], v9, s[12:15], s40 offen offset:2048 sc1
    buffer_load_dwordx4 v[84:87], v9, s[12:15], s41 offen offset:0 sc1
    buffer_load_dwordx4 v[88:91], v9, s[12:15], s41 offen offset:2048 sc1
    s_bitset1_b32 s30, 2
OP_N1_2:
    s_bfe_u32 s21, s20, 0x4000c
    s_bfe_u32 s22, s30, 0x10003
    s_sub_u32 s21, s21, s22
    s_cmp_lg_u32 s21, 15
    s_cbranch_scc1 OP_N1_3
    buffer_load_dwordx4 v[92:95], v9, s[12:15], s42 offen offset:0 sc1
    buffer_load_dwordx4 v[96:99], v9, s[12:15], s42 offen offset:2048 sc1
    buffer_load_dwordx4 v[100:103], v9, s[12:15], s43 offen offset:0 sc1
    buffer_load_dwordx4 v[104:107], v9, s[12:15], s43 offen offset:2048 sc1
    s_bitset1_b32 s30, 3
OP_N1_3:
    s_bitcmp1_b32 s31, 1
    s_cbranch_scc1 OP_CK1
    s_bitcmp1_b32 s30, 1
    s_cbranch_scc1 OP_D1
    s_sleep 1
    s_branch OP_W1
OP_D1:
    s_waitcnt vmcnt(0)
    s_mov_b32 s31, s30
    s_branch OP_CK1
OP_W2:
    ds_read_b64 v[14:15], v1 offset:80
    s_waitcnt lgkmcnt(0)
    v_readfirstlane_b32 s20, v14
    v_readfirstlane_b32 s21, v15
    s_bitcmp1_b32 s18, 1
    s_cselect_b32 s20, s21, s20
    s_lshr_b32 s20, s20, s33
    s_bfe_u32 s21, s20, 0x40008
    s_bfe_u32 s22, s30, 0x10002
    s_sub_u32 s21, s21, s22
    s_cmp_lg_u32 s21, 15
    s_cbranch_scc1 OP_N2_2
    buffer_load_dwordx4 v[76:79], v9, s[12:15], s40 offen offset:0 sc1
    buffer_load_dwordx4 v[80:83], v9, s[12:15], s40 offen offset:2048 sc1
    buffer_load_dwordx4 v[84:87], v9, s[12:15], s41 offen offset:0 sc1
    buffer_load_dwordx4 v[88:91], v9, s[12:15], s41 offen offset:2048 sc1
    s_bitset1_b32 s30, 2
OP_N2_2:
    s_bfe_u32 s21, s20, 0x4000c
    s_bfe_u32 s22, s30, 0x10003
    s_sub_u32 s21, s21, s22
    s_cmp_lg_u32 s21, 15
    s_cbranch_scc1 OP_N2_3
    buffer_load_dwordx4 v[92:95], v9, s[12:15], s42 offen offset:0 sc1
    buffer_load_dwordx4 v[96:99], v9, s[12:15], s42 offen offset:2048 sc1
    buffer_load_dwordx4 v[100:103], v9, s[12:15], s43 offen offset:0 sc1
    buffer_load_dwordx4 v[104:107], v9, s[12:15], s43 offen offset:2048 sc1
    s_bitset1_b32 s30, 3
OP_N2_3:
    s_bitcmp1_b32 s31, 2
    s_cbranch_scc1 OP_CK2
    s_bitcmp1_b32 s30, 2
    s_cbranch_scc1 OP_D2
    s_sleep 1
    s_branch OP_W2
OP_D2:
    s_waitcnt vmcnt(0)
    s_mov_b32 s31, s30
    s_branch OP_CK2
OP_W3:
    ds_read_b64 v[14:15], v1 offset:80
    s_waitcnt lgkmcnt(0)
    v_readfirstlane_b32 s20, v14
    v_readfirstlane_b32 s21, v15
    s_bitcmp1_b32 s18, 1
    s_cselect_b32 s20, s21, s20
    s_lshr_b32 s20, s20, s33
    s_bfe_u32 s21, s20, 0x4000c
    s_bfe_u32 s22, s30, 0x10003
    s_sub_u32 s21, s21, s22
    s_cmp_lg_u32 s21, 15
    s_cbranch_scc1 OP_N3_3
    buffer_load_dwordx4 v[92:95], v9, s[12:15], s42 offen offset:0 sc1
    buffer_load_dwordx4 v[96:99], v9, s[12:15], s42 offen offset:2048 sc1
    buffer_load_dwordx4 v[100:103], v9, s[12:15], s43 offen offset:0 sc1
    buffer_load_dwordx4 v[104:107], v9, s[12:15], s43 offen offset:2048 sc1
    s_bitset1_b32 s30, 3
OP_N3_3:
    s_bitcmp1_b32 s31, 3
    s_cbranch_scc1 OP_CK3
    s_bitcmp1_b32 s30, 3
    s_cbranch_scc1 OP_D3
    s_sleep 1
    s_branch OP_W3
OP_D3:
    s_waitcnt vmcnt(0)
    s_mov_b32 s31, s30
    s_branch OP_CK3
OP_RT0:
    s_add_u32 s35, s35, 1
    s_cmp_ge_u32 s35, 0x100000
    s_cbranch_scc1 OP_GO0
    buffer_load_dwordx4 v[44:47], v9, s[12:15], s36 offen offset:0 sc1
    buffer_load_dwordx4 v[48:51], v9, s[12:15], s36 offen offset:2048 sc1
    buffer_load_dwordx4 v[52:55], v9, s[12:15], s37 offen offset:0 sc1
    buffer_load_dwordx4 v[56:59], v9, s[12:15], s37 offen offset:2048 sc1
    s_waitcnt vmcnt(0)
    s_branch OP_CK0
OP_RT1:
    s_add_u32 s35, s35, 1
    s_cmp_ge_u32 s35, 0x100000
    s_cbranch_scc1 OP_GO1
    buffer_load_dwordx4 v[60:63], v9, s[12:15], s38 offen offset:0 sc1
    buffer_load_dwordx4 v[64:67], v9, s[12:15], s38 offen offset:2048 sc1
    buffer_load_dwordx4 v[68:71], v9, s[12:15], s39 offen offset:0 sc1
    buffer_load_dwordx4 v[72:75], v9, s[12:15], s39 offen offset:2048 sc1
    s_waitcnt vmcnt(0)
    s_branch OP_CK1
OP_RT2:
    s_add_u32 s35, s35, 1
    s_cmp_ge_u32 s35, 0x100000
    s_cbranch_scc1 OP_GO2
    buffer_load_dwordx4 v[76:79], v9, s[12:15], s40 offen offset:0 sc1
    buffer_load_dwordx4 v[80:83], v9, s[12:15], s40 offen offset:2048 sc1
    buffer_load_dwordx4 v[84:87], v9, s[12:15], s41 offen offset:0 sc1
    buffer_load_dwordx4 v[88:91], v9, s[12:15], s41 offen offset:2048 sc1
    s_waitcnt vmcnt(0)
    s_branch OP_CK2
OP_RT3:
    s_add_u32 s35, s35, 1
    s_cmp_ge_u32 s35, 0x100000
    s_cbranch_scc1 OP_GO3
    buffer_load_dwordx4 v[92:95], v9, s[12:15], s42 offen offset:0 sc1
    buffer_load_dwordx4 v[96:99], v9, s[12:15], s42 offen offset:2048 sc1
    buffer_load_dwordx4 v[100:103], v9, s[12:15], s43 offen offset:0 sc1
    buffer_load_dwordx4 v[104:107], v9, s[12:15], s43 offen offset:2048 sc1
    s_waitcnt vmcnt(0)
    s_branch OP_CK3
AT_WAIT0:
LW7:
    ds_read_b32 v147, v7 offset:12
    s_waitcnt lgkmcnt(0)
    v_readfirstlane_b32 s47, v147
    s_nop 0
    s_cmp_ge_u32 s47, 2
    s_cbranch_scc1 LD8
    s_sleep 1
    s_branch LW7
LD8:
    s_branch AT_BACK0
AT_WAIT2:
LW9:
    ds_read_b32 v147, v7 offset:12
    s_waitcnt lgkmcnt(0)
    v_readfirstlane_b32 s47, v147
    s_nop 0
    s_cmp_ge_u32 s47, 3
    s_cbranch_scc1 LD10
    s_sleep 1
    s_branch LW9
LD10:
    s_branch AT_BACK2
AT_WAIT4:
LW11:
    ds_read_b32 v147, v7 offset:12
    s_waitcnt lgkmcnt(0)
    v_readfirstlane_b32 s47, v147
    s_nop 0
    s_cmp_ge_u32 s47, 4
    s_cbranch_scc1 LD12
    s_sleep 1
    s_branch LW11
LD12:
    s_branch AT_BACK4
AT_WAIT6:
LW13:
    ds_read_b32 v147, v7 offset:12
    s_waitcnt lgkmcnt(0)
    v_readfirstlane_b32 s47, v147
    s_nop 0
    s_cmp_ge_u32 s47, 5
    s_cbranch_scc1 LD14
    s_sleep 1
    s_branch LW13
LD14:
    s_branch AT_BACK6
AT_WAIT8:
LW15:
    ds_read_b32 v147, v7 offset:12
    s_waitcnt lgkmcnt(0)
    v_readfirstlane_b32 s47, v147
    s_nop 0
    s_cmp_ge_u32 s47, 6
    s_cbranch_scc1 LD16
    s_sleep 1
    s_branch LW15
LD16:
    s_branch AT_BACK8
AT_WAIT10:
LW17:
    ds_read_b32 v147, v7 offset:12
    s_waitcnt lgkmcnt(0)
    v_readfirstlane_b32 s47, v147
    s_nop 0
    s_cmp_ge_u32 s47, 7
    s_cbranch_scc1 LD18
    s_sleep 1
    s_branch LW17
LD18:
    s_branch AT_BACK10
AT_WAIT12:
LW19:
    ds_read_b32 v147, v7 offset:12
    s_waitcnt lgkmcnt(0)
    v_readfirstlane_b32 s47, v147
    s_nop 0
    s_cmp_ge_u32 s47, 8
    s_cbranch_scc1 LD20
    s_sleep 1
    s_branch LW19
LD20:
    s_branch AT_BACK12
AT_WAIT14:
LW21:
    ds_read_b32 v147, v7 offset:12
    s_waitcnt lgkmcnt(0)
    v_readfirstlane_b32 s47, v147
    s_nop 0
    s_cmp_ge_u32 s47, 9
    s_cbranch_scc1 LD22
    s_sleep 1
    s_branch LW21
LD22:
    s_branch AT_BACK14
AT_WAIT16:
LW23:
    ds_read_b32 v147, v7 offset:12
    s_waitcnt lgkmcnt(0)
    v_readfirstlane_b32 s47, v147
    s_nop 0
    s_cmp_ge_u32 s47, 10
    s_cbranch_scc1 LD24
    s_sleep 1
    s_branch LW23
LD24:
    s_branch AT_BACK16
AT_WAIT18:
LW25:
    ds_read_b32 v147, v7 offset:12
    s_waitcnt lgkmcnt(0)
    v_readfirstlane_b32 s47, v147
    s_nop 0
    s_cmp_ge_u32 s47, 11
    s_cbranch_scc1 LD26
    s_sleep 1
    s_branch LW25
LD26:
    s_branch AT_BACK18
AT_WAIT20:
LW27:
    ds_read_b32 v147, v7 offset:12
    s_waitcnt lgkmcnt(0)
    v_readfirstlane_b32 s47, v147
    s_nop 0
    s_cmp_ge_u32 s47, 12
    s_cbranch_scc1 LD28
    s_sleep 1
    s_branch LW27
LD28:
    s_branch AT_BACK20
AT_WAIT22:
LW29:
    ds_read_b32 v147, v7 offset:12
    s_waitcnt lgkmcnt(0)
    v_readfirstlane_b32 s47, v147
    s_nop 0
    s_cmp_ge_u32 s47, 13
    s_cbranch_scc1 LD30
    s_sleep 1
    s_branch LW29
LD30:
    s_branch AT_BACK22
AT_WAIT24:
LW31:
    ds_read_b32 v147, v7 offset:12
    s_waitcnt lgkmcnt(0)
    v_readfirstlane_b32 s47, v147
    s_nop 0
    s_cmp_ge_u32 s47, 14
    s_cbranch_scc1 LD32
    s_sleep 1
    s_branch LW31
LD32:
    s_branch AT_BACK24
AT_WAIT26:
LW33:
    ds_read_b32 v147, v7 offset:12
    s_waitcnt lgkmcnt(0)
    v_readfirstlane_b32 s47, v147
    s_nop 0
    s_cmp_ge_u32 s47, 15
    s_cbranch_scc1 LD34
    s_sleep 1
    s_branch LW33
LD34:
    s_branch AT_BACK26
AT_WAIT28:
LW35:
    ds_read_b32 v147, v7 offset:12
    s_waitcnt lgkmcnt(0)
    v_readfirstlane_b32 s47, v147
    s_nop 0
    s_cmp_ge_u32 s47, 16
    s_cbranch_scc1 LD36
    s_sleep 1
    s_branch LW35
LD36:
    s_branch AT_BACK28
AT_SLOW:
    v_lshlrev_b32 v4, 4, v0
    v_lshlrev_b32 v5, 3, v0
    v_mov_b32 v6, v146
    v_mov_b32 v9, 0xff800000
    s_mov_b32 s22, 0
    s_mov_b32 s23, s20
    s_add_u32 s21, s20, 2621440
    v_mov_b32 v80, 0
    v_mov_b32 v81, 0
    v_mov_b32 v82, 0
    v_mov_b32 v83, 0
    v_mov_b32 v84, 0
    v_mov_b32 v85, 0
    v_mov_b32 v86, 0
    v_mov_b32 v87, 0
    v_mov_b32 v88, 0
    v_mov_b32 v89, 0
    v_mov_b32 v90, 0
    v_mov_b32 v91, 0
    v_mov_b32 v92, 0
    v_mov_b32 v93, 0
    v_mov_b32 v94, 0
    v_mov_b32 v95, 0
AT_SLOW_LOOP:
    buffer_load_dwordx2 v[118:119], v5, s[12:15], s23 offen offset:2048 sc1
    buffer_load_dwordx4 v[120:123], v4, s[12:15], s23 offen sc1
    buffer_load_dwordx4 v[124:127], v4, s[12:15], s23 offen offset:1024 sc1
    s_mov_b64 exec, s[30:31]
    buffer_load_dwordx4 v[128:131], v6, s[12:15], s21 offen sc1
    buffer_load_dwordx4 v[132:135], v6, s[12:15], s21 offen offset:640 sc1
    buffer_load_dwordx4 v[136:139], v6, s[12:15], s21 offen offset:1280 sc1
    buffer_load_dwordx4 v[140:143], v6, s[12:15], s21 offen offset:1920 sc1
    s_mov_b64 exec, -1
    s_waitcnt vmcnt(0)
    v_mfma_f32_32x32x4_2b_bf16 v[16:47], v[118:119], v[116:117], 0
    s_nop 15
    s_nop 1
    v_mfma_f32_32x32x16_bf16 v[16:31], v[120:123], v[112:115], v[16:31]
    v_mfma_f32_32x32x16_bf16 v[32:47], v[124:127], v[112:115], v[32:47]
    s_add_u32 s23, s23, 2560
    s_add_u32 s21, s21, 2560
    s_nop 8
    v_max3_f32 v10, v16, v17, v9
    v_max3_f32 v10, v18, v19, v10
    v_max3_f32 v10, v20, v21, v10
    v_max3_f32 v10, v22, v23, v10
    v_max3_f32 v10, v24, v25, v10
    v_max3_f32 v10, v26, v27, v10
    v_max3_f32 v10, v28, v29, v10
    v_max3_f32 v10, v30, v31, v10
    v_max3_f32 v10, v32, v33, v10
    v_max3_f32 v10, v34, v35, v10
    v_max3_f32 v10, v36, v37, v10
    v_max3_f32 v10, v38, v39, v10
    v_max3_f32 v10, v40, v41, v10
    v_max3_f32 v10, v42, v43, v10
    v_max3_f32 v10, v44, v45, v10
    v_max3_f32 v10, v46, v47, v10
    v_mov_b32 v11, v10
    s_nop 1
    v_permlane32_swap_b32 v10, v11
    v_max_f32 v10, v10, v11
    v_sub_f32 v11, v9, v10
    v_exp_f32 v11, v11
    v_mov_b32 v9, v10
    v_mul_f32 v80, v80, v11
    v_mul_f32 v81, v81, v11
    v_mul_f32 v82, v82, v11
    v_mul_f32 v83, v83, v11
    v_mul_f32 v84, v84, v11
    v_mul_f32 v85, v85, v11
    v_mul_f32 v86, v86, v11
    v_mul_f32 v87, v87, v11
    v_mul_f32 v88, v88, v11
    v_mul_f32 v89, v89, v11
    v_mul_f32 v90, v90, v11
    v_mul_f32 v91, v91, v11
    v_mul_f32 v92, v92, v11
    v_mul_f32 v93, v93, v11
    v_mul_f32 v94, v94, v11
    v_mul_f32 v95, v95, v11
    v_sub_f32 v16, v16, v9
    v_exp_f32 v16, v16
    v_sub_f32 v17, v17, v9
    v_exp_f32 v17, v17
    v_sub_f32 v18, v18, v9
    v_exp_f32 v18, v18
    v_sub_f32 v19, v19, v9
    v_exp_f32 v19, v19
    v_sub_f32 v20, v20, v9
    v_exp_f32 v20, v20
    v_sub_f32 v21, v21, v9
    v_exp_f32 v21, v21
    v_sub_f32 v22, v22, v9
    v_exp_f32 v22, v22
    v_sub_f32 v23, v23, v9
    v_exp_f32 v23, v23
    v_sub_f32 v24, v24, v9
    v_exp_f32 v24, v24
    v_sub_f32 v25, v25, v9
    v_exp_f32 v25, v25
    v_sub_f32 v26, v26, v9
    v_exp_f32 v26, v26
    v_sub_f32 v27, v27, v9
    v_exp_f32 v27, v27
    v_sub_f32 v28, v28, v9
    v_exp_f32 v28, v28
    v_sub_f32 v29, v29, v9
    v_exp_f32 v29, v29
    v_sub_f32 v30, v30, v9
    v_exp_f32 v30, v30
    v_sub_f32 v31, v31, v9
    v_exp_f32 v31, v31
    v_sub_f32 v32, v32, v9
    v_exp_f32 v32, v32
    v_sub_f32 v33, v33, v9
    v_exp_f32 v33, v33
    v_sub_f32 v34, v34, v9
    v_exp_f32 v34, v34
    v_sub_f32 v35, v35, v9
    v_exp_f32 v35, v35
    v_sub_f32 v36, v36, v9
    v_exp_f32 v36, v36
    v_sub_f32 v37, v37, v9
    v_exp_f32 v37, v37
    v_sub_f32 v38, v38, v9
    v_exp_f32 v38, v38
    v_sub_f32 v39, v39, v9
    v_exp_f32 v39, v39
    v_sub_f32 v40, v40, v9
    v_exp_f32 v40, v40
    v_sub_f32 v41, v41, v9
    v_exp_f32 v41, v41
    v_sub_f32 v42, v42, v9
    v_exp_f32 v42, v42
    v_sub_f32 v43, v43, v9
    v_exp_f32 v43, v43
    v_sub_f32 v44, v44, v9
    v_exp_f32 v44, v44
    v_sub_f32 v45, v45, v9
    v_exp_f32 v45, v45
    v_sub_f32 v46, v46, v9
    v_exp_f32 v46, v46
    v_sub_f32 v47, v47, v9
    v_exp_f32 v47, v47
    v_cvt_pk_bf16_f32 v96, v16, v17
    v_cvt_pk_bf16_f32 v97, v18, v19
    v_cvt_pk_bf16_f32 v98, v20, v21
    v_cvt_pk_bf16_f32 v99, v22, v23
    v_cvt_pk_bf16_f32 v100, v24, v25
    v_cvt_pk_bf16_f32 v101, v26, v27
    v_cvt_pk_bf16_f32 v102, v28, v29
    v_cvt_pk_bf16_f32 v103, v30, v31
    v_cvt_pk_bf16_f32 v104, v32, v33
    v_cvt_pk_bf16_f32 v105, v34, v35
    v_cvt_pk_bf16_f32 v106, v36, v37
    v_cvt_pk_bf16_f32 v107, v38, v39
    v_cvt_pk_bf16_f32 v108, v40, v41
    v_cvt_pk_bf16_f32 v109, v42, v43
    v_cvt_pk_bf16_f32 v110, v44, v45
    v_cvt_pk_bf16_f32 v111, v46, v47
    v_mfma_f32_32x32x16_bf16 v[80:95], v[128:131], v[96:99], v[80:95]
    v_mfma_f32_32x32x16_bf16 v[80:95], v[132:135], v[100:103], v[80:95]
    v_mfma_f32_32x32x16_bf16 v[80:95], v[136:139], v[104:107], v[80:95]
    v_mfma_f32_32x32x16_bf16 v[80:95], v[140:143], v[108:111], v[80:95]
    s_add_u32 s22, s22, 1
    s_cmp_lt_u32 s22, 32
    s_nop 15
    s_cbranch_scc1 AT_SLOW_LOOP
    v_mov_b32 v10, v88
    v_mov_b32 v11, v88
    s_nop 1
    v_permlane32_swap_b32 v10, v11
    s_nop 1
    s_branch AT_STORE
K_KGEN:
    s_mul_i32 s16, s2, 3
    s_add_u32 s16, s16, s3
    s_sub_u32 s16, s16, 8
    s_sub_u32 s18, s3, 8
    s_lshl_b32 s19, s18, 2
    s_add_u32 s19, s19, 163600
    v_mov_b32 v8, s19
    v_mov_b32 v9, 1
    s_cmp_ge_u32 s16, 640
    s_cbranch_scc1 KG_NONE
    s_setprio 2
    s_lshl_b32 s17, s16, 8
    v_lshl_add_u32 v2, v0, 2, s17
    s_lshl_b32 s17, s16, 1
    v_mov_b32 v3, s17
    s_mul_i32 s18, s18, 8704
    s_add_u32 s18, s18, 131072
    s_waitcnt lgkmcnt(0)
    global_load_ushort v16, v3, s[60:61]
    global_load_dword v10, v2, s[48:49]
    global_load_dword v11, v2, s[50:51]
    global_load_dword v12, v2, s[52:53]
    global_load_dword v13, v2, s[54:55]
    global_load_dword v14, v2, s[56:57]
    global_load_dword v15, v2, s[58:59]
    global_load_ushort v17, v3, s[62:63]
    v_lshl_add_u32 v4, v0, 2, s18
    v_and_b32 v6, 31, v0
    v_lshrrev_b32 v7, 5, v0
    v_mul_u32_u24 v5, 272, v6
    v_lshl_add_u32 v5, v7, 4, v5
    v_add_u32 v5, s18, v5
    s_mov_b32 s20, 0x3fb8aa3b
    s_mov_b32 s21, 0x32a57060
    s_mov_b32 s22, 0x3f317218
    s_mov_b32 s23, 0x3e22f983
    s_mov_b32 s24, 0xffff0000
    s_mov_b32 s25, 0x41000000
    s_mov_b32 s26, 0x43800000
    s_mov_b32 s12, s70
    s_mov_b32 s13, s71
    s_mov_b32 s14, 0x1680000
    s_mov_b32 s15, 0x00020000
    s_and_b32 s27, s2, 6
    s_lshl_b32 s27, s27, 1
    s_bfe_u32 s28, s2, 0x20003
    s_add_u32 s27, s27, s28
    s_and_b32 s28, s2, 1
    s_mul_i32 s29, s28, 5
    s_add_u32 s29, s29, 3
    s_mul_i32 s28, s28, 3
    s_cmp_lt_u32 s2, 96
    s_cselect_b32 s28, s28, s29
    s_lshr_b32 s29, s2, 5
    s_add_u32 s28, s28, s29
    s_mov_b32 s34, 10
    s_cmp_ge_u32 s28, 10
    s_cbranch_scc1 XT37n
    s_and_b32 s29, s27, 3
    s_mul_i32 s29, s29, 5
    s_lshr_b32 s29, s29, 1
    s_add_u32 s29, s29, s28
    s_sub_u32 s30, s29, 10
    s_cmp_ge_u32 s29, 10
    s_cselect_b32 s29, s30, s29
    s_lshl_b32 s29, s29, 18
    s_lshl_b32 s27, s27, 8
    s_add_u32 s29, s29, s27
    s_add_u32 s29, s29, 13631488
    s_sub_u32 s27, s3, 8
    s_mul_i32 s27, s27, 3
    s_mov_b32 s35, 0
    v_lshrrev_b32 v20, 4, v0
    v_bfe_u32 v21, v0, 2, 2
    v_lshl_add_u32 v22, v20, 3, v21
    v_lshlrev_b32 v22, 7, v22
    v_and_b32 v24, 1, v0
    v_lshl_add_u32 v22, v24, 3, v22
    s_and_b32 s30, s35, 3
    s_lshl_b32 s30, s30, 15
    v_add_u32 v22, s30, v22
    v_and_b32 v23, 1, v20
    v_lshlrev_b32 v23, 2, v23
    v_lshrrev_b32 v21, 1, v21
    v_add_u32 v23, v23, v21
    v_bfe_u32 v21, v0, 1, 1
    v_and_b32 v24, 15, v0
    v_lshlrev_b32 v24, 12, v24
    v_lshl_add_u32 v24, v20, 4, v24
    s_add_u32 s28, s27, 0
    s_min_u32 s28, s28, 7
    s_and_b32 s30, s28, 3
    s_lshr_b32 s31, s28, 2
    s_lshl_b32 s28, s30, 1
    v_add_u32 v25, s28, v21
    v_xor_b32 v25, v25, v23
    v_lshl_add_u32 v25, v25, 4, v22
    s_lshl_b32 s28, s31, 13
    v_add_u32 v26, s28, v25
    v_xor_b32 v29, 32, v26
    s_lshl_b32 s28, s30, 16
    s_lshl_b32 s31, s31, 7
    s_add_u32 s28, s28, s31
    v_add_u32 v32, s28, v24
    s_add_u32 s28, s27, 1
    s_min_u32 s28, s28, 7
    s_and_b32 s30, s28, 3
    s_lshr_b32 s31, s28, 2
    s_lshl_b32 s28, s30, 1
    v_add_u32 v25, s28, v21
    v_xor_b32 v25, v25, v23
    v_lshl_add_u32 v25, v25, 4, v22
    s_lshl_b32 s28, s31, 13
    v_add_u32 v27, s28, v25
    v_xor_b32 v30, 32, v27
    s_lshl_b32 s28, s30, 16
    s_lshl_b32 s31, s31, 7
    s_add_u32 s28, s28, s31
    v_add_u32 v33, s28, v24
    s_add_u32 s28, s27, 2
    s_min_u32 s28, s28, 7
    s_and_b32 s30, s28, 3
    s_lshr_b32 s31, s28, 2
    s_lshl_b32 s28, s30, 1
    v_add_u32 v25, s28, v21
    v_xor_b32 v25, v25, v23
    v_lshl_add_u32 v25, v25, 4, v22
    s_lshl_b32 s28, s31, 13
    v_add_u32 v28, s28, v25
    v_xor_b32 v31, 32, v28
    s_lshl_b32 s28, s30, 16
    s_lshl_b32 s31, s31, 7
    s_add_u32 s28, s28, s31
    v_add_u32 v34, s28, v24
    s_sub_u32 s34, 9, s35
XT37b:
    s_barrier
XT37e:
    s_sub_u32 s35, s35, 1
    s_cbranch_scc0 XT37b
    ds_read_b64_tr_b16 v[36:37], v26 offset:0
    ds_read_b64_tr_b16 v[38:39], v29 offset:512
    ds_read_b64_tr_b16 v[40:41], v26 offset:4096
    ds_read_b64_tr_b16 v[42:43], v29 offset:4608
    ds_read_b64_tr_b16 v[44:45], v27 offset:0
    ds_read_b64_tr_b16 v[46:47], v30 offset:512
    ds_read_b64_tr_b16 v[48:49], v27 offset:4096
    ds_read_b64_tr_b16 v[50:51], v30 offset:4608
    ds_read_b64_tr_b16 v[52:53], v28 offset:0
    ds_read_b64_tr_b16 v[54:55], v31 offset:512
    ds_read_b64_tr_b16 v[56:57], v28 offset:4096
    ds_read_b64_tr_b16 v[58:59], v31 offset:4608
    s_waitcnt lgkmcnt(0)
    s_barrier
    s_barrier
    s_barrier
    s_barrier
    s_barrier
    s_barrier
    s_barrier
    s_sub_u32 s34, s34, 7
    buffer_store_dwordx4 v[36:39], v32, s[12:15], s29 offen offset:0 sc1
    buffer_store_dwordx4 v[40:43], v32, s[12:15], s29 offen offset:64 sc1
    buffer_store_dwordx4 v[44:47], v33, s[12:15], s29 offen offset:0 sc1
    buffer_store_dwordx4 v[48:51], v33, s[12:15], s29 offen offset:64 sc1
    buffer_store_dwordx4 v[52:55], v34, s[12:15], s29 offen offset:0 sc1
    buffer_store_dwordx4 v[56:59], v34, s[12:15], s29 offen offset:64 sc1
XT37n:
    s_cmp_eq_u32 s34, 0
    s_cbranch_scc1 XT37d
XT37c:
    s_barrier
    s_sub_u32 s34, s34, 1
    s_cmp_lg_u32 s34, 0
    s_cbranch_scc1 XT37c
XT37d:
    v_mov_b32 v20, 163584
    v_mov_b32 v21, 1
    s_mov_b64 exec, 1
    s_waitcnt vmcnt(0)
    ds_add_u32 v20, v21 offset:8
    s_mov_b64 exec, -1
    s_waitcnt vmcnt(7)
    v_lshlrev_b32 v16, 16, v16
    v_mul_f32 v18, s20, v16
    v_fma_f32 v19, v16, s20, -v18
    v_fma_f32 v19, v16, s21, v19
    v_exp_f32 v18, v18
    v_mul_f32 v19, s22, v19
    v_fma_f32 v18, v18, v19, v18
    v_cvt_pk_bf16_f32 v18, v18, v18
    v_lshlrev_b32 v18, 16, v18
    s_waitcnt vmcnt(0)
    v_lshlrev_b32 v20, 16, v10
    v_and_b32 v128, s24, v10
    v_lshlrev_b32 v21, 16, v11
    v_and_b32 v129, s24, v11
    v_lshlrev_b32 v38, 16, v12
    v_and_b32 v146, s24, v12
    v_lshlrev_b32 v39, 16, v13
    v_and_b32 v147, s24, v13
    v_lshlrev_b32 v40, 16, v14
    v_and_b32 v148, s24, v14
    v_lshlrev_b32 v41, 16, v15
    v_and_b32 v149, s24, v15
    v_mul_f32 v20, v18, v20
    v_mul_f32 v128, v18, v128
    v_mul_f32 v21, v18, v21
    v_mul_f32 v129, v18, v129
    v_mul_f32 v38, v18, v38
    v_mul_f32 v146, v18, v146
    v_mul_f32 v39, v18, v39
    v_mul_f32 v147, v18, v147
    v_mul_f32 v20, s20, v20
    v_mul_f32 v128, s20, v128
    v_mul_f32 v21, s23, v21
    v_mul_f32 v129, s23, v129
    v_mul_f32 v22, v40, v38
    v_mul_f32 v130, v148, v146
    v_mul_f32 v23, v40, v39
    v_mul_f32 v131, v148, v147
    v_fma_f32 v22, -v41, v39, v22
    v_fma_f32 v130, -v149, v147, v130
    v_fma_f32 v23, v41, v38, v23
    v_fma_f32 v131, v149, v146, v131
    v_mul_f32 v42, s25, v20
    v_mul_f32 v150, s25, v128
    v_mul_f32 v43, s25, v21
    v_mul_f32 v151, s25, v129
    v_exp_f32 v42, v42
    v_exp_f32 v150, v150
    v_fract_f32 v43, v43
    v_fract_f32 v151, v151
    v_cos_f32 v26, v43
    v_cos_f32 v134, v151
    v_sin_f32 v27, v43
    v_sin_f32 v135, v151
    v_mul_f32 v26, v42, v26
    v_mul_f32 v134, v150, v134
    v_mul_f32 v27, v42, v27
    v_mul_f32 v135, v150, v135
    v_mul_f32 v42, 1.0, v20
    v_mul_f32 v150, 1.0, v128
    v_mul_f32 v43, 1.0, v21
    v_mul_f32 v151, 1.0, v129
    v_exp_f32 v42, v42
    v_exp_f32 v150, v150
    v_fract_f32 v43, v43
    v_fract_f32 v151, v151
    v_cos_f32 v24, v43
    v_cos_f32 v132, v151
    v_sin_f32 v25, v43
    v_sin_f32 v133, v151
    v_mul_f32 v24, v42, v24
    v_mul_f32 v132, v150, v132
    v_mul_f32 v25, v42, v25
    v_mul_f32 v133, v150, v133
    v_mul_f32 v42, s26, v20
    v_mul_f32 v150, s26, v128
    v_mul_f32 v43, s26, v21
    v_mul_f32 v151, s26, v129
    v_exp_f32 v42, v42
    v_exp_f32 v150, v150
    v_fract_f32 v43, v43
    v_fract_f32 v151, v151
    v_cos_f32 v28, v43
    v_cos_f32 v136, v151
    v_sin_f32 v29, v43
    v_sin_f32 v137, v151
    v_mul_f32 v28, v42, v28
    v_mul_f32 v136, v150, v136
    v_mul_f32 v29, v42, v29
    v_mul_f32 v137, v150, v137
    v_pk_mul_f32 v[38:39], v[26:27], v[26:27] op_sel:[0,0] op_sel_hi:[1,0]
    v_pk_mul_f32 v[146:147], v[134:135], v[134:135] op_sel:[0,0] op_sel_hi:[1,0]
    v_pk_fma_f32 v[34:35], v[26:27], v[26:27], v[38:39] op_sel:[1,1,0] op_sel_hi:[0,1,1] neg_lo:[1,0,0]
    v_pk_fma_f32 v[142:143], v[134:135], v[134:135], v[146:147] op_sel:[1,1,0] op_sel_hi:[0,1,1] neg_lo:[1,0,0]
    v_pk_mul_f32 v[38:39], v[24:25], v[24:25] op_sel:[0,0] op_sel_hi:[1,0]
    v_pk_mul_f32 v[146:147], v[132:133], v[132:133] op_sel:[0,0] op_sel_hi:[1,0]
    v_pk_fma_f32 v[30:31], v[24:25], v[24:25], v[38:39] op_sel:[1,1,0] op_sel_hi:[0,1,1] neg_lo:[1,0,0]
    v_pk_fma_f32 v[138:139], v[132:133], v[132:133], v[146:147] op_sel:[1,1,0] op_sel_hi:[0,1,1] neg_lo:[1,0,0]
    v_pk_mul_f32 v[38:39], v[28:29], v[28:29] op_sel:[0,0] op_sel_hi:[1,0]
    v_pk_mul_f32 v[146:147], v[136:137], v[136:137] op_sel:[0,0] op_sel_hi:[1,0]
    v_pk_fma_f32 v[36:37], v[28:29], v[28:29], v[38:39] op_sel:[1,1,0] op_sel_hi:[0,1,1] neg_lo:[1,0,0]
    v_pk_fma_f32 v[144:145], v[136:137], v[136:137], v[146:147] op_sel:[1,1,0] op_sel_hi:[0,1,1] neg_lo:[1,0,0]
    v_pk_mul_f32 v[38:39], v[30:31], v[30:31] op_sel:[0,0] op_sel_hi:[1,0]
    v_pk_mul_f32 v[146:147], v[138:139], v[138:139] op_sel:[0,0] op_sel_hi:[1,0]
    v_pk_fma_f32 v[32:33], v[30:31], v[30:31], v[38:39] op_sel:[1,1,0] op_sel_hi:[0,1,1] neg_lo:[1,0,0]
    v_pk_fma_f32 v[140:141], v[138:139], v[138:139], v[146:147] op_sel:[1,1,0] op_sel_hi:[0,1,1] neg_lo:[1,0,0]
    v_mov_b32 v164, 0x3f80
    ds_write_b32 v4, v164
    v_pk_mul_f32 v[160:161], v[26:27], v[34:35] op_sel:[0,0] op_sel_hi:[1,0]
    v_pk_mul_f32 v[162:163], v[34:35], v[34:35] op_sel:[0,0] op_sel_hi:[1,0]
    v_cvt_pk_bf16_f32 v164, v26, v27
    v_cvt_pk_bf16_f32 v165, v34, v35
    v_pk_fma_f32 v[154:155], v[26:27], v[34:35], v[160:161] op_sel:[1,1,0] op_sel_hi:[0,1,1] neg_lo:[1,0,0]
    v_pk_fma_f32 v[152:153], v[34:35], v[34:35], v[162:163] op_sel:[1,1,0] op_sel_hi:[0,1,1] neg_lo:[1,0,0]
    ds_write_b32 v4, v164 offset:272
    ds_write_b32 v4, v165 offset:544
    v_pk_mul_f32 v[160:161], v[154:155], v[34:35] op_sel:[0,0] op_sel_hi:[1,0]
    v_pk_mul_f32 v[162:163], v[152:153], v[34:35] op_sel:[0,0] op_sel_hi:[1,0]
    v_cvt_pk_bf16_f32 v164, v154, v155
    v_cvt_pk_bf16_f32 v165, v152, v153
    v_pk_fma_f32 v[158:159], v[154:155], v[34:35], v[160:161] op_sel:[1,1,0] op_sel_hi:[0,1,1] neg_lo:[1,0,0]
    v_pk_fma_f32 v[156:157], v[152:153], v[34:35], v[162:163] op_sel:[1,1,0] op_sel_hi:[0,1,1] neg_lo:[1,0,0]
    ds_write_b32 v4, v164 offset:816
    ds_write_b32 v4, v165 offset:1088
    v_pk_mul_f32 v[160:161], v[158:159], v[34:35] op_sel:[0,0] op_sel_hi:[1,0]
    v_pk_mul_f32 v[162:163], v[156:157], v[34:35] op_sel:[0,0] op_sel_hi:[1,0]
    v_cvt_pk_bf16_f32 v164, v158, v159
    v_cvt_pk_bf16_f32 v165, v156, v157
    v_pk_fma_f32 v[154:155], v[158:159], v[34:35], v[160:161] op_sel:[1,1,0] op_sel_hi:[0,1,1] neg_lo:[1,0,0]
    v_pk_fma_f32 v[152:153], v[156:157], v[34:35], v[162:163] op_sel:[1,1,0] op_sel_hi:[0,1,1] neg_lo:[1,0,0]
    ds_write_b32 v4, v164 offset:1360
    ds_write_b32 v4, v165 offset:1632
    v_pk_mul_f32 v[160:161], v[154:155], v[34:35] op_sel:[0,0] op_sel_hi:[1,0]
    v_pk_mul_f32 v[162:163], v[152:153], v[34:35] op_sel:[0,0] op_sel_hi:[1,0]
    v_cvt_pk_bf16_f32 v164, v154, v155
    v_cvt_pk_bf16_f32 v165, v152, v153
    v_pk_fma_f32 v[158:159], v[154:155], v[34:35], v[160:161] op_sel:[1,1,0] op_sel_hi:[0,1,1] neg_lo:[1,0,0]
    v_pk_fma_f32 v[156:157], v[152:153], v[34:35], v[162:163] op_sel:[1,1,0] op_sel_hi:[0,1,1] neg_lo:[1,0,0]
    ds_write_b32 v4, v164 offset:1904
    ds_write_b32 v4, v165 offset:2176
    v_pk_mul_f32 v[160:161], v[158:159], v[34:35] op_sel:[0,0] op_sel_hi:[1,0]
    v_pk_mul_f32 v[162:163], v[156:157], v[34:35] op_sel:[0,0] op_sel_hi:[1,0]
    v_cvt_pk_bf16_f32 v164, v158, v159
    v_cvt_pk_bf16_f32 v165, v156, v157
    v_pk_fma_f32 v[154:155], v[158:159], v[34:35], v[160:161] op_sel:[1,1,0] op_sel_hi:[0,1,1] neg_lo:[1,0,0]
    v_pk_fma_f32 v[152:153], v[156:157], v[34:35], v[162:163] op_sel:[1,1,0] op_sel_hi:[0,1,1] neg_lo:[1,0,0]
    ds_write_b32 v4, v164 offset:2448
    ds_write_b32 v4, v165 offset:2720
    v_pk_mul_f32 v[160:161], v[154:155], v[34:35] op_sel:[0,0] op_sel_hi:[1,0]
    v_pk_mul_f32 v[162:163], v[152:153], v[34:35] op_sel:[0,0] op_sel_hi:[1,0]
    v_cvt_pk_bf16_f32 v164, v154, v155
    v_cvt_pk_bf16_f32 v165, v152, v153
    v_pk_fma_f32 v[158:159], v[154:155], v[34:35], v[160:161] op_sel:[1,1,0] op_sel_hi:[0,1,1] neg_lo:[1,0,0]
    v_pk_fma_f32 v[156:157], v[152:153], v[34:35], v[162:163] op_sel:[1,1,0] op_sel_hi:[0,1,1] neg_lo:[1,0,0]
    ds_write_b32 v4, v164 offset:2992
    ds_write_b32 v4, v165 offset:3264
    v_pk_mul_f32 v[160:161], v[158:159], v[34:35] op_sel:[0,0] op_sel_hi:[1,0]
    v_pk_mul_f32 v[162:163], v[156:157], v[34:35] op_sel:[0,0] op_sel_hi:[1,0]
    v_cvt_pk_bf16_f32 v164, v158, v159
    v_cvt_pk_bf16_f32 v165, v156, v157
    v_pk_fma_f32 v[154:155], v[158:159], v[34:35], v[160:161] op_sel:[1,1,0] op_sel_hi:[0,1,1] neg_lo:[1,0,0]
    v_pk_fma_f32 v[152:153], v[156:157], v[34:35], v[162:163] op_sel:[1,1,0] op_sel_hi:[0,1,1] neg_lo:[1,0,0]
    ds_write_b32 v4, v164 offset:3536
    ds_write_b32 v4, v165 offset:3808
    v_pk_mul_f32 v[160:161], v[154:155], v[34:35] op_sel:[0,0] op_sel_hi:[1,0]
    v_pk_mul_f32 v[162:163], v[152:153], v[34:35] op_sel:[0,0] op_sel_hi:[1,0]
    v_cvt_pk_bf16_f32 v164, v154, v155
    v_cvt_pk_bf16_f32 v165, v152, v153
    v_pk_fma_f32 v[158:159], v[154:155], v[34:35], v[160:161] op_sel:[1,1,0] op_sel_hi:[0,1,1] neg_lo:[1,0,0]
    v_pk_fma_f32 v[156:157], v[152:153], v[34:35], v[162:163] op_sel:[1,1,0] op_sel_hi:[0,1,1] neg_lo:[1,0,0]
    ds_write_b32 v4, v164 offset:4080
    ds_write_b32 v4, v165 offset:4352
    v_pk_mul_f32 v[160:161], v[158:159], v[34:35] op_sel:[0,0] op_sel_hi:[1,0]
    v_pk_mul_f32 v[162:163], v[156:157], v[34:35] op_sel:[0,0] op_sel_hi:[1,0]
    v_cvt_pk_bf16_f32 v164, v158, v159
    v_cvt_pk_bf16_f32 v165, v156, v157
    v_pk_fma_f32 v[154:155], v[158:159], v[34:35], v[160:161] op_sel:[1,1,0] op_sel_hi:[0,1,1] neg_lo:[1,0,0]
    v_pk_fma_f32 v[152:153], v[156:157], v[34:35], v[162:163] op_sel:[1,1,0] op_sel_hi:[0,1,1] neg_lo:[1,0,0]
    ds_write_b32 v4, v164 offset:4624
    ds_write_b32 v4, v165 offset:4896
    v_pk_mul_f32 v[160:161], v[154:155], v[34:35] op_sel:[0,0] op_sel_hi:[1,0]
    v_pk_mul_f32 v[162:163], v[152:153], v[34:35] op_sel:[0,0] op_sel_hi:[1,0]
    v_cvt_pk_bf16_f32 v164, v154, v155
    v_cvt_pk_bf16_f32 v165, v152, v153
    v_pk_fma_f32 v[158:159], v[154:155], v[34:35], v[160:161] op_sel:[1,1,0] op_sel_hi:[0,1,1] neg_lo:[1,0,0]
    v_pk_fma_f32 v[156:157], v[152:153], v[34:35], v[162:163] op_sel:[1,1,0] op_sel_hi:[0,1,1] neg_lo:[1,0,0]
    ds_write_b32 v4, v164 offset:5168
    ds_write_b32 v4, v165 offset:5440
    v_pk_mul_f32 v[160:161], v[158:159], v[34:35] op_sel:[0,0] op_sel_hi:[1,0]
    v_pk_mul_f32 v[162:163], v[156:157], v[34:35] op_sel:[0,0] op_sel_hi:[1,0]
    v_cvt_pk_bf16_f32 v164, v158, v159
    v_cvt_pk_bf16_f32 v165, v156, v157
    v_pk_fma_f32 v[154:155], v[158:159], v[34:35], v[160:161] op_sel:[1,1,0] op_sel_hi:[0,1,1] neg_lo:[1,0,0]
    v_pk_fma_f32 v[152:153], v[156:157], v[34:35], v[162:163] op_sel:[1,1,0] op_sel_hi:[0,1,1] neg_lo:[1,0,0]
    ds_write_b32 v4, v164 offset:5712
    ds_write_b32 v4, v165 offset:5984
    v_pk_mul_f32 v[160:161], v[154:155], v[34:35] op_sel:[0,0] op_sel_hi:[1,0]
    v_pk_mul_f32 v[162:163], v[152:153], v[34:35] op_sel:[0,0] op_sel_hi:[1,0]
    v_cvt_pk_bf16_f32 v164, v154, v155
    v_cvt_pk_bf16_f32 v165, v152, v153
    v_pk_fma_f32 v[158:159], v[154:155], v[34:35], v[160:161] op_sel:[1,1,0] op_sel_hi:[0,1,1] neg_lo:[1,0,0]
    v_pk_fma_f32 v[156:157], v[152:153], v[34:35], v[162:163] op_sel:[1,1,0] op_sel_hi:[0,1,1] neg_lo:[1,0,0]
    ds_write_b32 v4, v164 offset:6256
    ds_write_b32 v4, v165 offset:6528
    v_pk_mul_f32 v[160:161], v[158:159], v[34:35] op_sel:[0,0] op_sel_hi:[1,0]
    v_pk_mul_f32 v[162:163], v[156:157], v[34:35] op_sel:[0,0] op_sel_hi:[1,0]
    v_cvt_pk_bf16_f32 v164, v158, v159
    v_cvt_pk_bf16_f32 v165, v156, v157
    v_pk_fma_f32 v[154:155], v[158:159], v[34:35], v[160:161] op_sel:[1,1,0] op_sel_hi:[0,1,1] neg_lo:[1,0,0]
    v_pk_fma_f32 v[152:153], v[156:157], v[34:35], v[162:163] op_sel:[1,1,0] op_sel_hi:[0,1,1] neg_lo:[1,0,0]
    ds_write_b32 v4, v164 offset:6800
    ds_write_b32 v4, v165 offset:7072
    v_pk_mul_f32 v[160:161], v[154:155], v[34:35] op_sel:[0,0] op_sel_hi:[1,0]
    v_pk_mul_f32 v[162:163], v[152:153], v[34:35] op_sel:[0,0] op_sel_hi:[1,0]
    v_cvt_pk_bf16_f32 v164, v154, v155
    v_cvt_pk_bf16_f32 v165, v152, v153
    v_pk_fma_f32 v[158:159], v[154:155], v[34:35], v[160:161] op_sel:[1,1,0] op_sel_hi:[0,1,1] neg_lo:[1,0,0]
    v_pk_fma_f32 v[156:157], v[152:153], v[34:35], v[162:163] op_sel:[1,1,0] op_sel_hi:[0,1,1] neg_lo:[1,0,0]
    ds_write_b32 v4, v164 offset:7344
    ds_write_b32 v4, v165 offset:7616
    v_pk_mul_f32 v[160:161], v[158:159], v[34:35] op_sel:[0,0] op_sel_hi:[1,0]
    v_cvt_pk_bf16_f32 v164, v158, v159
    v_cvt_pk_bf16_f32 v165, v156, v157
    v_pk_fma_f32 v[154:155], v[158:159], v[34:35], v[160:161] op_sel:[1,1,0] op_sel_hi:[0,1,1] neg_lo:[1,0,0]
    ds_write_b32 v4, v164 offset:7888
    ds_write_b32 v4, v165 offset:8160
    v_pk_mul_f32 v[160:161], v[22:23], v[24:25] op_sel:[0,0] op_sel_hi:[1,0]
    v_pk_mul_f32 v[162:163], v[22:23], v[28:29] op_sel:[0,0] op_sel_hi:[1,0]
    v_cvt_pk_bf16_f32 v164, v154, v155
    v_pk_fma_f32 v[152:153], v[22:23], v[24:25], v[160:161] op_sel:[1,1,0] op_sel_hi:[0,1,1] neg_lo:[1,0,0]
    v_pk_fma_f32 v[156:157], v[22:23], v[28:29], v[162:163] op_sel:[1,1,0] op_sel_hi:[0,1,1] neg_lo:[1,0,0]
    ds_write_b32 v4, v164 offset:8432
    ds_read_b128 v[64:67], v5 offset:0
    ds_read_b128 v[68:71], v5 offset:32
    ds_read_b128 v[72:75], v5 offset:64
    ds_read_b128 v[76:79], v5 offset:96
    ds_read_b128 v[80:83], v5 offset:128
    ds_read_b128 v[84:87], v5 offset:160
    ds_read_b128 v[88:91], v5 offset:192
    ds_read_b128 v[92:95], v5 offset:224
    v_cvt_pk_bf16_f32 v164, v22, -v23
    ds_write_b32 v4, v164
    v_pk_mul_f32 v[160:161], v[22:23], v[30:31] op_sel:[0,0] op_sel_hi:[1,0]
    v_pk_mul_f32 v[162:163], v[152:153], v[30:31] op_sel:[0,0] op_sel_hi:[1,0]
    v_cvt_pk_bf16_f32 v164, v152, -v153
    v_cvt_pk_bf16_f32 v165, v156, -v157
    v_pk_fma_f32 v[154:155], v[22:23], v[30:31], v[160:161] op_sel:[1,1,0] op_sel_hi:[0,1,1] neg_lo:[1,0,0]
    v_pk_fma_f32 v[158:159], v[152:153], v[30:31], v[162:163] op_sel:[1,1,0] op_sel_hi:[0,1,1] neg_lo:[1,0,0]
    ds_write_b32 v4, v164 offset:272
    ds_write_b32 v4, v165 offset:2176
    v_pk_mul_f32 v[160:161], v[156:157], v[30:31] op_sel:[0,0] op_sel_hi:[1,0]
    v_pk_mul_f32 v[162:163], v[156:157], v[28:29] op_sel:[0,0] op_sel_hi:[1,0]
    v_cvt_pk_bf16_f32 v164, v154, -v155
    v_cvt_pk_bf16_f32 v165, v158, -v159
    v_pk_fma_f32 v[38:39], v[156:157], v[30:31], v[160:161] op_sel:[1,1,0] op_sel_hi:[0,1,1] neg_lo:[1,0,0]
    v_pk_fma_f32 v[40:41], v[156:157], v[28:29], v[162:163] op_sel:[1,1,0] op_sel_hi:[0,1,1] neg_lo:[1,0,0]
    ds_write_b32 v4, v164 offset:544
    ds_write_b32 v4, v165 offset:816
    v_pk_mul_f32 v[160:161], v[154:155], v[30:31] op_sel:[0,0] op_sel_hi:[1,0]
    v_pk_mul_f32 v[162:163], v[158:159], v[30:31] op_sel:[0,0] op_sel_hi:[1,0]
    v_cvt_pk_bf16_f32 v164, v38, -v39
    v_cvt_pk_bf16_f32 v165, v40, -v41
    v_pk_fma_f32 v[152:153], v[154:155], v[30:31], v[160:161] op_sel:[1,1,0] op_sel_hi:[0,1,1] neg_lo:[1,0,0]
    v_pk_fma_f32 v[42:43], v[158:159], v[30:31], v[162:163] op_sel:[1,1,0] op_sel_hi:[0,1,1] neg_lo:[1,0,0]
    ds_write_b32 v4, v164 offset:2448
    ds_write_b32 v4, v165 offset:3264
    v_pk_mul_f32 v[160:161], v[156:157], v[32:33] op_sel:[0,0] op_sel_hi:[1,0]
    v_pk_mul_f32 v[162:163], v[38:39], v[32:33] op_sel:[0,0] op_sel_hi:[1,0]
    v_cvt_pk_bf16_f32 v164, v152, -v153
    v_cvt_pk_bf16_f32 v165, v42, -v43
    v_pk_fma_f32 v[154:155], v[156:157], v[32:33], v[160:161] op_sel:[1,1,0] op_sel_hi:[0,1,1] neg_lo:[1,0,0]
    v_pk_fma_f32 v[158:159], v[38:39], v[32:33], v[162:163] op_sel:[1,1,0] op_sel_hi:[0,1,1] neg_lo:[1,0,0]
    ds_write_b32 v4, v164 offset:1088
    ds_write_b32 v4, v165 offset:1360
    v_pk_mul_f32 v[160:161], v[152:153], v[30:31] op_sel:[0,0] op_sel_hi:[1,0]
    v_pk_mul_f32 v[162:163], v[42:43], v[30:31] op_sel:[0,0] op_sel_hi:[1,0]
    v_cvt_pk_bf16_f32 v164, v154, -v155
    v_cvt_pk_bf16_f32 v165, v158, -v159
    v_pk_fma_f32 v[38:39], v[152:153], v[30:31], v[160:161] op_sel:[1,1,0] op_sel_hi:[0,1,1] neg_lo:[1,0,0]
    v_pk_fma_f32 v[20:21], v[42:43], v[30:31], v[162:163] op_sel:[1,1,0] op_sel_hi:[0,1,1] neg_lo:[1,0,0]
    ds_write_b32 v4, v164 offset:2720
    ds_write_b32 v4, v165 offset:2992
    v_pk_mul_f32 v[160:161], v[156:157], v[36:37] op_sel:[0,0] op_sel_hi:[1,0]
    v_pk_mul_f32 v[162:163], v[40:41], v[32:33] op_sel:[0,0] op_sel_hi:[1,0]
    v_cvt_pk_bf16_f32 v164, v38, -v39
    v_cvt_pk_bf16_f32 v165, v20, -v21
    v_pk_fma_f32 v[152:153], v[156:157], v[36:37], v[160:161] op_sel:[1,1,0] op_sel_hi:[0,1,1] neg_lo:[1,0,0]
    v_pk_fma_f32 v[154:155], v[40:41], v[32:33], v[162:163] op_sel:[1,1,0] op_sel_hi:[0,1,1] neg_lo:[1,0,0]
    ds_write_b32 v4, v164 offset:1632
    ds_write_b32 v4, v165 offset:1904
    v_pk_mul_f32 v[160:161], v[40:41], v[36:37] op_sel:[0,0] op_sel_hi:[1,0]
    v_pk_mul_f32 v[162:163], v[152:153], v[32:33] op_sel:[0,0] op_sel_hi:[1,0]
    v_cvt_pk_bf16_f32 v164, v152, -v153
    v_cvt_pk_bf16_f32 v165, v154, -v155
    v_pk_fma_f32 v[158:159], v[40:41], v[36:37], v[160:161] op_sel:[1,1,0] op_sel_hi:[0,1,1] neg_lo:[1,0,0]
    v_pk_fma_f32 v[42:43], v[152:153], v[32:33], v[162:163] op_sel:[1,1,0] op_sel_hi:[0,1,1] neg_lo:[1,0,0]
    ds_write_b32 v4, v164 offset:3808
    ds_write_b32 v4, v165 offset:3536
    v_pk_mul_f32 v[160:161], v[152:153], v[36:37] op_sel:[0,0] op_sel_hi:[1,0]
    v_pk_mul_f32 v[162:163], v[158:159], v[36:37] op_sel:[0,0] op_sel_hi:[1,0]
    v_cvt_pk_bf16_f32 v164, v158, -v159
    v_cvt_pk_bf16_f32 v165, v42, -v43
    v_pk_fma_f32 v[156:157], v[152:153], v[36:37], v[160:161] op_sel:[1,1,0] op_sel_hi:[0,1,1] neg_lo:[1,0,0]
    v_pk_fma_f32 v[40:41], v[158:159], v[36:37], v[162:163] op_sel:[1,1,0] op_sel_hi:[0,1,1] neg_lo:[1,0,0]
    ds_write_b32 v4, v164 offset:4352
    ds_write_b32 v4, v165 offset:4080
    v_pk_mul_f32 v[160:161], v[156:157], v[36:37] op_sel:[0,0] op_sel_hi:[1,0]
    v_pk_mul_f32 v[162:163], v[40:41], v[36:37] op_sel:[0,0] op_sel_hi:[1,0]
    v_cvt_pk_bf16_f32 v164, v156, -v157
    v_cvt_pk_bf16_f32 v165, v40, -v41
    v_pk_fma_f32 v[152:153], v[156:157], v[36:37], v[160:161] op_sel:[1,1,0] op_sel_hi:[0,1,1] neg_lo:[1,0,0]
    v_pk_fma_f32 v[154:155], v[40:41], v[36:37], v[162:163] op_sel:[1,1,0] op_sel_hi:[0,1,1] neg_lo:[1,0,0]
    ds_write_b32 v4, v164 offset:4624
    ds_write_b32 v4, v165 offset:4896
    v_cvt_pk_bf16_f32 v164, v152, -v153
    v_cvt_pk_bf16_f32 v165, v154, -v155
    ds_write_b32 v4, v164 offset:5168
    ds_write_b32 v4, v165 offset:5440
    ds_read_b128 v[96:99], v5 offset:0
    ds_read_b128 v[100:103], v5 offset:32
    ds_read_b128 v[104:107], v5 offset:64
    ds_read_b128 v[108:111], v5 offset:96
    ds_read_b128 v[112:115], v5 offset:128
    ds_read_b128 v[116:119], v5 offset:160
    ds_read_b128 v[120:123], v5 offset:192
    ds_read_b128 v[124:127], v5 offset:224
    v_mov_b32 v164, 0x3f80
    ds_write_b32 v4, v164
    v_pk_mul_f32 v[160:161], v[134:135], v[142:143] op_sel:[0,0] op_sel_hi:[1,0]
    v_pk_mul_f32 v[162:163], v[142:143], v[142:143] op_sel:[0,0] op_sel_hi:[1,0]
    v_cvt_pk_bf16_f32 v164, v134, v135
    v_cvt_pk_bf16_f32 v165, v142, v143
    s_nop 0
    v_pk_fma_f32 v[154:155], v[134:135], v[142:143], v[160:161] op_sel:[1,1,0] op_sel_hi:[0,1,1] neg_lo:[1,0,0]
    v_pk_fma_f32 v[152:153], v[142:143], v[142:143], v[162:163] op_sel:[1,1,0] op_sel_hi:[0,1,1] neg_lo:[1,0,0]
    ds_write_b32 v4, v164 offset:272
    ds_write_b32 v4, v165 offset:544
    v_pk_mul_f32 v[160:161], v[154:155], v[142:143] op_sel:[0,0] op_sel_hi:[1,0]
    v_pk_mul_f32 v[162:163], v[152:153], v[142:143] op_sel:[0,0] op_sel_hi:[1,0]
    v_cvt_pk_bf16_f32 v164, v154, v155
    v_cvt_pk_bf16_f32 v165, v152, v153
    s_nop 0
    v_pk_fma_f32 v[158:159], v[154:155], v[142:143], v[160:161] op_sel:[1,1,0] op_sel_hi:[0,1,1] neg_lo:[1,0,0]
    v_pk_fma_f32 v[156:157], v[152:153], v[142:143], v[162:163] op_sel:[1,1,0] op_sel_hi:[0,1,1] neg_lo:[1,0,0]
    ds_write_b32 v4, v164 offset:816
    ds_write_b32 v4, v165 offset:1088
    v_pk_mul_f32 v[160:161], v[158:159], v[142:143] op_sel:[0,0] op_sel_hi:[1,0]
    v_pk_mul_f32 v[162:163], v[156:157], v[142:143] op_sel:[0,0] op_sel_hi:[1,0]
    v_cvt_pk_bf16_f32 v164, v158, v159
    v_cvt_pk_bf16_f32 v165, v156, v157
    s_nop 0
    v_pk_fma_f32 v[154:155], v[158:159], v[142:143], v[160:161] op_sel:[1,1,0] op_sel_hi:[0,1,1] neg_lo:[1,0,0]
    v_pk_fma_f32 v[152:153], v[156:157], v[142:143], v[162:163] op_sel:[1,1,0] op_sel_hi:[0,1,1] neg_lo:[1,0,0]
    ds_write_b32 v4, v164 offset:1360
    ds_write_b32 v4, v165 offset:1632
    v_pk_mul_f32 v[160:161], v[154:155], v[142:143] op_sel:[0,0] op_sel_hi:[1,0]
    v_pk_mul_f32 v[162:163], v[152:153], v[142:143] op_sel:[0,0] op_sel_hi:[1,0]
    v_cvt_pk_bf16_f32 v164, v154, v155
    v_cvt_pk_bf16_f32 v165, v152, v153
    s_waitcnt lgkmcnt(6)
    v_pk_fma_f32 v[158:159], v[154:155], v[142:143], v[160:161] op_sel:[1,1,0] op_sel_hi:[0,1,1] neg_lo:[1,0,0]
    v_pk_fma_f32 v[156:157], v[152:153], v[142:143], v[162:163] op_sel:[1,1,0] op_sel_hi:[0,1,1] neg_lo:[1,0,0]
    ds_write_b32 v4, v164 offset:1904
    ds_write_b32 v4, v165 offset:2176
    v_pk_mul_f32 v[160:161], v[158:159], v[142:143] op_sel:[0,0] op_sel_hi:[1,0]
    v_pk_mul_f32 v[162:163], v[156:157], v[142:143] op_sel:[0,0] op_sel_hi:[1,0]
    v_cvt_pk_bf16_f32 v164, v158, v159
    v_cvt_pk_bf16_f32 v165, v156, v157
    v_mfma_f32_32x32x16_bf16 v[48:63], v[96:99], v[64:67], 0
    v_pk_fma_f32 v[154:155], v[158:159], v[142:143], v[160:161] op_sel:[1,1,0] op_sel_hi:[0,1,1] neg_lo:[1,0,0]
    v_pk_fma_f32 v[152:153], v[156:157], v[142:143], v[162:163] op_sel:[1,1,0] op_sel_hi:[0,1,1] neg_lo:[1,0,0]
    ds_write_b32 v4, v164 offset:2448
    ds_write_b32 v4, v165 offset:2720
    v_pk_mul_f32 v[160:161], v[154:155], v[142:143] op_sel:[0,0] op_sel_hi:[1,0]
    v_pk_mul_f32 v[162:163], v[152:153], v[142:143] op_sel:[0,0] op_sel_hi:[1,0]
    v_cvt_pk_bf16_f32 v164, v154, v155
    v_cvt_pk_bf16_f32 v165, v152, v153
    v_mfma_f32_32x32x16_bf16 v[48:63], v[100:103], v[68:71], v[48:63]
    v_pk_fma_f32 v[158:159], v[154:155], v[142:143], v[160:161] op_sel:[1,1,0] op_sel_hi:[0,1,1] neg_lo:[1,0,0]
    v_pk_fma_f32 v[156:157], v[152:153], v[142:143], v[162:163] op_sel:[1,1,0] op_sel_hi:[0,1,1] neg_lo:[1,0,0]
    ds_write_b32 v4, v164 offset:2992
    ds_write_b32 v4, v165 offset:3264
    v_pk_mul_f32 v[160:161], v[158:159], v[142:143] op_sel:[0,0] op_sel_hi:[1,0]
    v_pk_mul_f32 v[162:163], v[156:157], v[142:143] op_sel:[0,0] op_sel_hi:[1,0]
    v_cvt_pk_bf16_f32 v164, v158, v159
    v_cvt_pk_bf16_f32 v165, v156, v157
    v_mfma_f32_32x32x16_bf16 v[48:63], v[104:107], v[72:75], v[48:63]
    v_pk_fma_f32 v[154:155], v[158:159], v[142:143], v[160:161] op_sel:[1,1,0] op_sel_hi:[0,1,1] neg_lo:[1,0,0]
    v_pk_fma_f32 v[152:153], v[156:157], v[142:143], v[162:163] op_sel:[1,1,0] op_sel_hi:[0,1,1] neg_lo:[1,0,0]
    ds_write_b32 v4, v164 offset:3536
    ds_write_b32 v4, v165 offset:3808
    v_pk_mul_f32 v[160:161], v[154:155], v[142:143] op_sel:[0,0] op_sel_hi:[1,0]
    v_pk_mul_f32 v[162:163], v[152:153], v[142:143] op_sel:[0,0] op_sel_hi:[1,0]
    v_cvt_pk_bf16_f32 v164, v154, v155
    v_cvt_pk_bf16_f32 v165, v152, v153
    v_mfma_f32_32x32x16_bf16 v[48:63], v[108:111], v[76:79], v[48:63]
    v_pk_fma_f32 v[158:159], v[154:155], v[142:143], v[160:161] op_sel:[1,1,0] op_sel_hi:[0,1,1] neg_lo:[1,0,0]
    v_pk_fma_f32 v[156:157], v[152:153], v[142:143], v[162:163] op_sel:[1,1,0] op_sel_hi:[0,1,1] neg_lo:[1,0,0]
    ds_write_b32 v4, v164 offset:4080
    ds_write_b32 v4, v165 offset:4352
    v_pk_mul_f32 v[160:161], v[158:159], v[142:143] op_sel:[0,0] op_sel_hi:[1,0]
    v_pk_mul_f32 v[162:163], v[156:157], v[142:143] op_sel:[0,0] op_sel_hi:[1,0]
    v_cvt_pk_bf16_f32 v164, v158, v159
    v_cvt_pk_bf16_f32 v165, v156, v157
    v_mfma_f32_32x32x16_bf16 v[48:63], v[112:115], v[80:83], v[48:63]
    v_pk_fma_f32 v[154:155], v[158:159], v[142:143], v[160:161] op_sel:[1,1,0] op_sel_hi:[0,1,1] neg_lo:[1,0,0]
    v_pk_fma_f32 v[152:153], v[156:157], v[142:143], v[162:163] op_sel:[1,1,0] op_sel_hi:[0,1,1] neg_lo:[1,0,0]
    ds_write_b32 v4, v164 offset:4624
    ds_write_b32 v4, v165 offset:4896
    v_pk_mul_f32 v[160:161], v[154:155], v[142:143] op_sel:[0,0] op_sel_hi:[1,0]
    v_pk_mul_f32 v[162:163], v[152:153], v[142:143] op_sel:[0,0] op_sel_hi:[1,0]
    v_cvt_pk_bf16_f32 v164, v154, v155
    v_cvt_pk_bf16_f32 v165, v152, v153
    v_mfma_f32_32x32x16_bf16 v[48:63], v[116:119], v[84:87], v[48:63]
    v_pk_fma_f32 v[158:159], v[154:155], v[142:143], v[160:161] op_sel:[1,1,0] op_sel_hi:[0,1,1] neg_lo:[1,0,0]
    v_pk_fma_f32 v[156:157], v[152:153], v[142:143], v[162:163] op_sel:[1,1,0] op_sel_hi:[0,1,1] neg_lo:[1,0,0]
    ds_write_b32 v4, v164 offset:5168
    ds_write_b32 v4, v165 offset:5440
    v_pk_mul_f32 v[160:161], v[158:159], v[142:143] op_sel:[0,0] op_sel_hi:[1,0]
    v_pk_mul_f32 v[162:163], v[156:157], v[142:143] op_sel:[0,0] op_sel_hi:[1,0]
    v_cvt_pk_bf16_f32 v164, v158, v159
    v_cvt_pk_bf16_f32 v165, v156, v157
    v_mfma_f32_32x32x16_bf16 v[48:63], v[120:123], v[88:91], v[48:63]
    v_pk_fma_f32 v[154:155], v[158:159], v[142:143], v[160:161] op_sel:[1,1,0] op_sel_hi:[0,1,1] neg_lo:[1,0,0]
    v_pk_fma_f32 v[152:153], v[156:157], v[142:143], v[162:163] op_sel:[1,1,0] op_sel_hi:[0,1,1] neg_lo:[1,0,0]
    ds_write_b32 v4, v164 offset:5712
    ds_write_b32 v4, v165 offset:5984
    v_pk_mul_f32 v[160:161], v[154:155], v[142:143] op_sel:[0,0] op_sel_hi:[1,0]
    v_pk_mul_f32 v[162:163], v[152:153], v[142:143] op_sel:[0,0] op_sel_hi:[1,0]
    v_cvt_pk_bf16_f32 v164, v154, v155
    v_cvt_pk_bf16_f32 v165, v152, v153
    v_mfma_f32_32x32x16_bf16 v[48:63], v[124:127], v[92:95], v[48:63]
    v_pk_fma_f32 v[158:159], v[154:155], v[142:143], v[160:161] op_sel:[1,1,0] op_sel_hi:[0,1,1] neg_lo:[1,0,0]
    v_pk_fma_f32 v[156:157], v[152:153], v[142:143], v[162:163] op_sel:[1,1,0] op_sel_hi:[0,1,1] neg_lo:[1,0,0]
    ds_write_b32 v4, v164 offset:6256
    ds_write_b32 v4, v165 offset:6528
    v_pk_mul_f32 v[160:161], v[158:159], v[142:143] op_sel:[0,0] op_sel_hi:[1,0]
    v_pk_mul_f32 v[162:163], v[156:157], v[142:143] op_sel:[0,0] op_sel_hi:[1,0]
    v_cvt_pk_bf16_f32 v164, v158, v159
    v_cvt_pk_bf16_f32 v165, v156, v157
    v_pk_fma_f32 v[154:155], v[158:159], v[142:143], v[160:161] op_sel:[1,1,0] op_sel_hi:[0,1,1] neg_lo:[1,0,0]
    v_pk_fma_f32 v[152:153], v[156:157], v[142:143], v[162:163] op_sel:[1,1,0] op_sel_hi:[0,1,1] neg_lo:[1,0,0]
    ds_write_b32 v4, v164 offset:6800
    ds_write_b32 v4, v165 offset:7072
    v_pk_mul_f32 v[160:161], v[154:155], v[142:143] op_sel:[0,0] op_sel_hi:[1,0]
    v_pk_mul_f32 v[162:163], v[152:153], v[142:143] op_sel:[0,0] op_sel_hi:[1,0]
    v_cvt_pk_bf16_f32 v164, v154, v155
    v_cvt_pk_bf16_f32 v165, v152, v153
    v_pk_fma_f32 v[158:159], v[154:155], v[142:143], v[160:161] op_sel:[1,1,0] op_sel_hi:[0,1,1] neg_lo:[1,0,0]
    v_pk_fma_f32 v[156:157], v[152:153], v[142:143], v[162:163] op_sel:[1,1,0] op_sel_hi:[0,1,1] neg_lo:[1,0,0]
    ds_write_b32 v4, v164 offset:7344
    ds_write_b32 v4, v165 offset:7616
    v_pk_mul_f32 v[160:161], v[158:159], v[142:143] op_sel:[0,0] op_sel_hi:[1,0]
    v_cvt_pk_bf16_f32 v164, v158, v159
    v_cvt_pk_bf16_f32 v165, v156, v157
    v_pk_fma_f32 v[154:155], v[158:159], v[142:143], v[160:161] op_sel:[1,1,0] op_sel_hi:[0,1,1] neg_lo:[1,0,0]
    ds_write_b32 v4, v164 offset:7888
    ds_write_b32 v4, v165 offset:8160
    v_pk_mul_f32 v[160:161], v[130:131], v[132:133] op_sel:[0,0] op_sel_hi:[1,0]
    v_pk_mul_f32 v[162:163], v[130:131], v[136:137] op_sel:[0,0] op_sel_hi:[1,0]
    v_cvt_pk_bf16_f32 v164, v154, v155
    v_pk_fma_f32 v[152:153], v[130:131], v[132:133], v[160:161] op_sel:[1,1,0] op_sel_hi:[0,1,1] neg_lo:[1,0,0]
    v_pk_fma_f32 v[156:157], v[130:131], v[136:137], v[162:163] op_sel:[1,1,0] op_sel_hi:[0,1,1] neg_lo:[1,0,0]
    ds_write_b32 v4, v164 offset:8432
    ds_read_b128 v[64:67], v5 offset:0
    ds_read_b128 v[68:71], v5 offset:32
    ds_read_b128 v[72:75], v5 offset:64
    ds_read_b128 v[76:79], v5 offset:96
    ds_read_b128 v[80:83], v5 offset:128
    ds_read_b128 v[84:87], v5 offset:160
    ds_read_b128 v[88:91], v5 offset:192
    ds_read_b128 v[92:95], v5 offset:224
    v_cvt_pk_bf16_f32 v164, v130, -v131
    ds_write_b32 v4, v164
    v_pk_mul_f32 v[160:161], v[130:131], v[138:139] op_sel:[0,0] op_sel_hi:[1,0]
    v_pk_mul_f32 v[162:163], v[152:153], v[138:139] op_sel:[0,0] op_sel_hi:[1,0]
    v_cvt_pk_bf16_f32 v164, v152, -v153
    v_cvt_pk_bf16_f32 v165, v156, -v157
    v_pk_fma_f32 v[154:155], v[130:131], v[138:139], v[160:161] op_sel:[1,1,0] op_sel_hi:[0,1,1] neg_lo:[1,0,0]
    v_pk_fma_f32 v[158:159], v[152:153], v[138:139], v[162:163] op_sel:[1,1,0] op_sel_hi:[0,1,1] neg_lo:[1,0,0]
    ds_write_b32 v4, v164 offset:272
    ds_write_b32 v4, v165 offset:2176
    v_pk_mul_f32 v[160:161], v[156:157], v[138:139] op_sel:[0,0] op_sel_hi:[1,0]
    v_pk_mul_f32 v[162:163], v[156:157], v[136:137] op_sel:[0,0] op_sel_hi:[1,0]
    v_cvt_pk_bf16_f32 v164, v154, -v155
    v_cvt_pk_bf16_f32 v165, v158, -v159
    v_pk_fma_f32 v[146:147], v[156:157], v[138:139], v[160:161] op_sel:[1,1,0] op_sel_hi:[0,1,1] neg_lo:[1,0,0]
    v_pk_fma_f32 v[148:149], v[156:157], v[136:137], v[162:163] op_sel:[1,1,0] op_sel_hi:[0,1,1] neg_lo:[1,0,0]
    ds_write_b32 v4, v164 offset:544
    ds_write_b32 v4, v165 offset:816
    v_pk_mul_f32 v[160:161], v[154:155], v[138:139] op_sel:[0,0] op_sel_hi:[1,0]
    v_pk_mul_f32 v[162:163], v[158:159], v[138:139] op_sel:[0,0] op_sel_hi:[1,0]
    v_cvt_pk_bf16_f32 v164, v146, -v147
    v_cvt_pk_bf16_f32 v165, v148, -v149
    v_pk_fma_f32 v[152:153], v[154:155], v[138:139], v[160:161] op_sel:[1,1,0] op_sel_hi:[0,1,1] neg_lo:[1,0,0]
    v_pk_fma_f32 v[150:151], v[158:159], v[138:139], v[162:163] op_sel:[1,1,0] op_sel_hi:[0,1,1] neg_lo:[1,0,0]
    ds_write_b32 v4, v164 offset:2448
    ds_write_b32 v4, v165 offset:3264
    v_pk_mul_f32 v[160:161], v[156:157], v[140:141] op_sel:[0,0] op_sel_hi:[1,0]
    v_pk_mul_f32 v[162:163], v[146:147], v[140:141] op_sel:[0,0] op_sel_hi:[1,0]
    v_cvt_pk_bf16_f32 v164, v152, -v153
    v_cvt_pk_bf16_f32 v165, v150, -v151
    v_pk_fma_f32 v[154:155], v[156:157], v[140:141], v[160:161] op_sel:[1,1,0] op_sel_hi:[0,1,1] neg_lo:[1,0,0]
    v_pk_fma_f32 v[158:159], v[146:147], v[140:141], v[162:163] op_sel:[1,1,0] op_sel_hi:[0,1,1] neg_lo:[1,0,0]
    ds_write_b32 v4, v164 offset:1088
    ds_write_b32 v4, v165 offset:1360
    v_pk_mul_f32 v[160:161], v[152:153], v[138:139] op_sel:[0,0] op_sel_hi:[1,0]
    v_pk_mul_f32 v[162:163], v[150:151], v[138:139] op_sel:[0,0] op_sel_hi:[1,0]
    v_cvt_pk_bf16_f32 v164, v154, -v155
    v_cvt_pk_bf16_f32 v165, v158, -v159
    v_pk_fma_f32 v[146:147], v[152:153], v[138:139], v[160:161] op_sel:[1,1,0] op_sel_hi:[0,1,1] neg_lo:[1,0,0]
    v_pk_fma_f32 v[128:129], v[150:151], v[138:139], v[162:163] op_sel:[1,1,0] op_sel_hi:[0,1,1] neg_lo:[1,0,0]
    ds_write_b32 v4, v164 offset:2720
    ds_write_b32 v4, v165 offset:2992
    v_pk_mul_f32 v[160:161], v[156:157], v[144:145] op_sel:[0,0] op_sel_hi:[1,0]
    v_pk_mul_f32 v[162:163], v[148:149], v[140:141] op_sel:[0,0] op_sel_hi:[1,0]
    v_cvt_pk_bf16_f32 v164, v146, -v147
    v_cvt_pk_bf16_f32 v165, v128, -v129
    v_pk_fma_f32 v[152:153], v[156:157], v[144:145], v[160:161] op_sel:[1,1,0] op_sel_hi:[0,1,1] neg_lo:[1,0,0]
    v_pk_fma_f32 v[154:155], v[148:149], v[140:141], v[162:163] op_sel:[1,1,0] op_sel_hi:[0,1,1] neg_lo:[1,0,0]
    ds_write_b32 v4, v164 offset:1632
    ds_write_b32 v4, v165 offset:1904
    v_pk_mul_f32 v[160:161], v[148:149], v[144:145] op_sel:[0,0] op_sel_hi:[1,0]
    v_pk_mul_f32 v[162:163], v[152:153], v[140:141] op_sel:[0,0] op_sel_hi:[1,0]
    v_cvt_pk_bf16_f32 v164, v152, -v153
    v_cvt_pk_bf16_f32 v165, v154, -v155
    v_pk_fma_f32 v[158:159], v[148:149], v[144:145], v[160:161] op_sel:[1,1,0] op_sel_hi:[0,1,1] neg_lo:[1,0,0]
    v_pk_fma_f32 v[150:151], v[152:153], v[140:141], v[162:163] op_sel:[1,1,0] op_sel_hi:[0,1,1] neg_lo:[1,0,0]
    ds_write_b32 v4, v164 offset:3808
    ds_write_b32 v4, v165 offset:3536
    v_pk_mul_f32 v[160:161], v[152:153], v[144:145] op_sel:[0,0] op_sel_hi:[1,0]
    v_pk_mul_f32 v[162:163], v[158:159], v[144:145] op_sel:[0,0] op_sel_hi:[1,0]
    v_cvt_pk_bf16_f32 v164, v158, -v159
    v_cvt_pk_bf16_f32 v165, v150, -v151
    v_pk_fma_f32 v[156:157], v[152:153], v[144:145], v[160:161] op_sel:[1,1,0] op_sel_hi:[0,1,1] neg_lo:[1,0,0]
    v_pk_fma_f32 v[148:149], v[158:159], v[144:145], v[162:163] op_sel:[1,1,0] op_sel_hi:[0,1,1] neg_lo:[1,0,0]
    ds_write_b32 v4, v164 offset:4352
    ds_write_b32 v4, v165 offset:4080
    v_pk_mul_f32 v[160:161], v[156:157], v[144:145] op_sel:[0,0] op_sel_hi:[1,0]
    v_pk_mul_f32 v[162:163], v[148:149], v[144:145] op_sel:[0,0] op_sel_hi:[1,0]
    v_cvt_pk_bf16_f32 v164, v156, -v157
    v_cvt_pk_bf16_f32 v165, v148, -v149
    v_pk_fma_f32 v[152:153], v[156:157], v[144:145], v[160:161] op_sel:[1,1,0] op_sel_hi:[0,1,1] neg_lo:[1,0,0]
    v_pk_fma_f32 v[154:155], v[148:149], v[144:145], v[162:163] op_sel:[1,1,0] op_sel_hi:[0,1,1] neg_lo:[1,0,0]
    ds_write_b32 v4, v164 offset:4624
    ds_write_b32 v4, v165 offset:4896
    v_cvt_pk_bf16_f32 v164, v152, -v153
    v_cvt_pk_bf16_f32 v165, v154, -v155
    ds_write_b32 v4, v164 offset:5168
    ds_write_b32 v4, v165 offset:5440
    ds_read_b128 v[96:99], v5 offset:0
    ds_read_b128 v[100:103], v5 offset:32
    ds_read_b128 v[104:107], v5 offset:64
    ds_read_b128 v[108:111], v5 offset:96
    ds_read_b128 v[112:115], v5 offset:128
    ds_read_b128 v[116:119], v5 offset:160
    ds_read_b128 v[120:123], v5 offset:192
    ds_read_b128 v[124:127], v5 offset:224
    s_waitcnt lgkmcnt(0)
    v_mfma_f32_32x32x16_bf16 v[48:63], v[96:99], v[64:67], v[48:63]
    v_mfma_f32_32x32x16_bf16 v[48:63], v[100:103], v[68:71], v[48:63]
    v_mfma_f32_32x32x16_bf16 v[48:63], v[104:107], v[72:75], v[48:63]
    v_mfma_f32_32x32x16_bf16 v[48:63], v[108:111], v[76:79], v[48:63]
    v_mfma_f32_32x32x16_bf16 v[48:63], v[112:115], v[80:83], v[48:63]
    v_mfma_f32_32x32x16_bf16 v[48:63], v[116:119], v[84:87], v[48:63]
    v_mfma_f32_32x32x16_bf16 v[48:63], v[120:123], v[88:91], v[48:63]
    v_mfma_f32_32x32x16_bf16 v[48:63], v[124:127], v[92:95], v[48:63]
    v_lshlrev_b32 v17, 16, v17
    v_cmp_eq_u32 vcc, 0, v0
    s_nop 1
    v_cndmask_b32 v17, 0, v17, vcc
    v_lshlrev_b32 v20, 5, v6
    v_lshl_add_u32 v20, v7, 4, v20
    v_add_u32 v20, s18, v20
    v_lshlrev_b32 v21, 4, v6
    v_add_u32 v21, 1024, v21
    v_add_u32 v22, 8, v21
    v_lshlrev_b32 v23, 3, v6
    v_add_u32 v24, 1792, v23
    v_add_u32 v23, 1536, v23
    v_cmp_eq_u32 vcc, 1, v7
    s_nop 1
    v_cndmask_b32 v21, v21, v23, vcc
    v_cndmask_b32 v22, v22, v24, vcc
    v_add_u32 v21, s18, v21
    v_add_u32 v22, s18, v22
    v_lshlrev_b32 v23, 2, v6
    v_lshl_add_u32 v23, v7, 9, v23
    v_add_u32 v23, s18, v23
    v_lshl_add_u32 v24, v0, 3, s18
    v_lshl_add_u32 v25, v0, 4, s18
    v_cmp_eq_u32 vcc, 0, v0
    v_add_u32 v26, -4, v25
    v_add_u32 v27, 1024, v24
    v_add_u32 v28, 1020, v24
    v_cndmask_b32 v26, v26, v25, vcc
    v_cndmask_b32 v27, v27, v28, vcc
    s_mul_i32 s17, s16, 8320
    s_add_u32 s17, s17, 7864320
    s_add_u32 s19, s17, 4160
    v_lshlrev_b32 v30, 5, v0
    v_sub_u32 v30, 2016, v30
    v_lshlrev_b32 v31, 4, v0
    v_sub_u32 v31, 3056, v31
    v_lshlrev_b32 v33, 3, v0
    v_sub_u32 v32, 3576, v33
    v_sub_u32 v33, 4088, v33
    v_and_b32 v34, 15, v0
    v_lshlrev_b32 v34, 2, v34
    v_bfe_u32 v35, v0, 4, 1
    v_mul_u32_u24 v35, 4160, v35
    v_add_u32 v34, v34, v35
    v_mov_b32 v35, 0
    v_add_u32 v34, 4096, v34
    v_add_f32 v48, v48, v17
    ds_write_b128 v20, v[48:51]
    ds_write_b64 v21, v[52:53]
    ds_write_b64 v22, v[54:55]
    ds_write_b32 v23, v56 offset:2048
    ds_write_b32 v23, v57 offset:2176
    ds_write_b32 v23, v58 offset:2304
    ds_write_b32 v23, v59 offset:2432
    ds_read_b64 v[64:65], v24 offset:2048
    ds_read_b32 v66, v24 offset:2056
    ds_read_b64 v[68:69], v24 offset:1536
    ds_read_b32 v70, v24 offset:1544
    ds_read_b64 v[72:73], v24 offset:1024
    ds_read_b32 v74, v24 offset:1032
    ds_read_b32 v75, v27
    ds_read_b128 v[76:79], v25
    ds_read_b32 v80, v26
    s_waitcnt lgkmcnt(0)
    ds_write_b32 v8, v9
    v_cndmask_b32 v80, v80, v35, vcc
    buffer_store_dword v35, v34, s[12:15], s17 offen
    v_cvt_pk_bf16_f32 v84, v66, v66
    v_cvt_pk_bf16_f32 v85, v66, v66
    v_cvt_pk_bf16_f32 v86, v65, v65
    v_cvt_pk_bf16_f32 v87, v65, v65
    v_cvt_pk_bf16_f32 v88, v65, v65
    v_cvt_pk_bf16_f32 v89, v65, v64
    v_cvt_pk_bf16_f32 v90, v64, v64
    v_cvt_pk_bf16_f32 v91, v64, v64
    buffer_store_dwordx4 v[84:87], v30, s[12:15], s19 offen
    buffer_store_dwordx4 v[88:91], v30, s[12:15], s19 offen offset:16
    v_cvt_pk_bf16_f32 v92, v66, v66
    v_cvt_pk_bf16_f32 v93, v66, v65
    v_cvt_pk_bf16_f32 v94, v65, v65
    v_cvt_pk_bf16_f32 v95, v65, v65
    v_cvt_pk_bf16_f32 v96, v65, v65
    v_cvt_pk_bf16_f32 v97, v64, v64
    v_cvt_pk_bf16_f32 v98, v64, v64
    v_cvt_pk_bf16_f32 v99, v64, v64
    buffer_store_dwordx4 v[92:95], v30, s[12:15], s17 offen
    buffer_store_dwordx4 v[96:99], v30, s[12:15], s17 offen offset:16
    v_cvt_pk_bf16_f32 v100, v70, v70
    v_cvt_pk_bf16_f32 v101, v69, v69
    v_cvt_pk_bf16_f32 v102, v69, v68
    v_cvt_pk_bf16_f32 v103, v68, v68
    buffer_store_dwordx4 v[100:103], v31, s[12:15], s19 offen
    v_cvt_pk_bf16_f32 v104, v70, v69
    v_cvt_pk_bf16_f32 v105, v69, v69
    v_cvt_pk_bf16_f32 v106, v68, v68
    v_cvt_pk_bf16_f32 v107, v68, v68
    buffer_store_dwordx4 v[104:107], v31, s[12:15], s17 offen
    v_cvt_pk_bf16_f32 v108, v74, v73
    v_cvt_pk_bf16_f32 v109, v72, v72
    buffer_store_dwordx2 v[108:109], v32, s[12:15], s19 offen
    v_cvt_pk_bf16_f32 v110, v73, v72
    v_cvt_pk_bf16_f32 v111, v72, v75
    buffer_store_dwordx2 v[110:111], v32, s[12:15], s17 offen
    v_cvt_pk_bf16_f32 v112, v79, v78
    v_cvt_pk_bf16_f32 v113, v77, v76
    buffer_store_dwordx2 v[112:113], v33, s[12:15], s19 offen
    v_cvt_pk_bf16_f32 v114, v78, v77
    v_cvt_pk_bf16_f32 v115, v76, v80
    buffer_store_dwordx2 v[114:115], v33, s[12:15], s17 offen
    v_mov_b32 v6, 163584
    s_setprio 0
    v_and_b32 v2, 15, v0
    v_lshrrev_b32 v3, 4, v0
    v_lshlrev_b32 v1, 3, v3
    v_sub_u32 v1, v1, v2
    v_add_u32 v1, 15, v1
    v_and_b32 v7, 1, v1
    v_sub_u32 v1, v1, v7
    v_lshlrev_b32 v1, 1, v1
    v_xor_b32 v7, 1, v7
    v_mul_u32_u24 v7, 4160, v7
    v_add_u32 v1, v1, v7
    v_lshlrev_b32 v2, 5, v2
    v_lshl_add_u32 v0, v3, 3, v2
    v_lshl_add_u32 v2, v3, 4, v2
    s_add_u32 s4, s70, s17
    s_addc_u32 s5, s71, 0
    s_mov_b32 s6, 8320
    s_mov_b32 s7, 0x00020000
    s_lshl_b32 s21, s16, 12
    s_add_u32 s22, s21, 13631488
    s_add_u32 s8, s70, s22
    s_addc_u32 s9, s71, 0
    s_mov_b32 s10, 4096
    s_mov_b32 s11, 0x00020000
    s_add_u32 s21, s21, 20971520
LW38:
    ds_read_b32 v7, v6 offset:64
    s_waitcnt lgkmcnt(0)
    v_readfirstlane_b32 s34, v7
    s_nop 0
    s_cmp_ge_u32 s34, 1
    s_cbranch_scc1 LD39
    s_sleep 1
    s_branch LW38
LD39:
    ds_read_b64 v[4:5], v6 offset:0
    s_waitcnt lgkmcnt(0)
    v_readfirstlane_b32 s32, v4
    v_readfirstlane_b32 s33, v5
    s_waitcnt vmcnt(0)
    s_mov_b32 s22, 448
    s_mov_b32 s23, 480
    v_subrev_u32 v3, 32, v2
    buffer_load_dwordx4 v[68:71], v3, s[8:11], 0 offen sc1
    buffer_load_dwordx4 v[72:75], v2, s[8:11], s23 offen offset:0 sc1
    buffer_load_dwordx4 v[76:79], v2, s[8:11], s23 offen offset:512 sc1
    buffer_load_dwordx4 v[80:83], v2, s[8:11], s23 offen offset:1024 sc1
    buffer_load_dwordx4 v[84:87], v2, s[8:11], s23 offen offset:1536 sc1
    buffer_load_dwordx4 v[88:91], v2, s[8:11], s23 offen offset:2048 sc1
    buffer_load_dwordx4 v[92:95], v2, s[8:11], s23 offen offset:2560 sc1
    buffer_load_dwordx4 v[96:99], v2, s[8:11], s23 offen offset:3072 sc1
    buffer_load_dwordx4 v[36:39], v1, s[4:7], s22 offen offset:3584
    buffer_load_dwordx4 v[40:43], v1, s[4:7], s22 offen offset:3072
    buffer_load_dwordx4 v[44:47], v1, s[4:7], s22 offen offset:2560
    buffer_load_dwordx4 v[48:51], v1, s[4:7], s22 offen offset:2048
    buffer_load_dwordx4 v[52:55], v1, s[4:7], s22 offen offset:1536
    buffer_load_dwordx4 v[56:59], v1, s[4:7], s22 offen offset:1024
    buffer_load_dwordx4 v[60:63], v1, s[4:7], s22 offen offset:512
    buffer_load_dwordx4 v[64:67], v1, s[4:7], s22 offen offset:0
    s_mov_b32 s22, 384
    s_mov_b32 s23, 416
    v_subrev_u32 v3, 96, v2
    buffer_load_dwordx4 v[132:135], v3, s[8:11], 0 offen sc1
    buffer_load_dwordx4 v[136:139], v2, s[8:11], s23 offen offset:0 sc1
    buffer_load_dwordx4 v[140:143], v2, s[8:11], s23 offen offset:512 sc1
    buffer_load_dwordx4 v[144:147], v2, s[8:11], s23 offen offset:1024 sc1
    buffer_load_dwordx4 v[148:151], v2, s[8:11], s23 offen offset:1536 sc1
    buffer_load_dwordx4 v[152:155], v2, s[8:11], s23 offen offset:2048 sc1
    buffer_load_dwordx4 v[156:159], v2, s[8:11], s23 offen offset:2560 sc1
    buffer_load_dwordx4 v[160:163], v2, s[8:11], s23 offen offset:3072 sc1
    buffer_load_dwordx4 v[100:103], v1, s[4:7], s22 offen offset:3584
    buffer_load_dwordx4 v[104:107], v1, s[4:7], s22 offen offset:3072
    buffer_load_dwordx4 v[108:111], v1, s[4:7], s22 offen offset:2560
    buffer_load_dwordx4 v[112:115], v1, s[4:7], s22 offen offset:2048
    buffer_load_dwordx4 v[116:119], v1, s[4:7], s22 offen offset:1536
    buffer_load_dwordx4 v[120:123], v1, s[4:7], s22 offen offset:1024
    buffer_load_dwordx4 v[124:127], v1, s[4:7], s22 offen offset:512
    buffer_load_dwordx4 v[128:131], v1, s[4:7], s22 offen offset:0
    s_waitcnt vmcnt(16)
    v_mfma_f32_16x16x32_bf16 v[4:7], v[36:39], v[68:71], 0
    v_mfma_f32_16x16x32_bf16 v[8:11], v[36:39], v[72:75], 0
    v_mfma_f32_16x16x32_bf16 v[12:15], v[36:39], v[76:79], 0
    v_mfma_f32_16x16x32_bf16 v[16:19], v[36:39], v[80:83], 0
    v_mfma_f32_16x16x32_bf16 v[20:23], v[36:39], v[84:87], 0
    v_mfma_f32_16x16x32_bf16 v[24:27], v[36:39], v[88:91], 0
    v_mfma_f32_16x16x32_bf16 v[28:31], v[36:39], v[92:95], 0
    v_mfma_f32_16x16x32_bf16 v[32:35], v[36:39], v[96:99], 0
    v_mfma_f32_16x16x32_bf16 v[8:11], v[40:43], v[68:71], v[8:11]
    v_mfma_f32_16x16x32_bf16 v[12:15], v[40:43], v[72:75], v[12:15]
    v_mfma_f32_16x16x32_bf16 v[16:19], v[40:43], v[76:79], v[16:19]
    v_mfma_f32_16x16x32_bf16 v[20:23], v[40:43], v[80:83], v[20:23]
    v_mfma_f32_16x16x32_bf16 v[24:27], v[40:43], v[84:87], v[24:27]
    v_mfma_f32_16x16x32_bf16 v[28:31], v[40:43], v[88:91], v[28:31]
    v_mfma_f32_16x16x32_bf16 v[32:35], v[40:43], v[92:95], v[32:35]
    v_mfma_f32_16x16x32_bf16 v[12:15], v[44:47], v[68:71], v[12:15]
    v_mfma_f32_16x16x32_bf16 v[16:19], v[44:47], v[72:75], v[16:19]
    v_mfma_f32_16x16x32_bf16 v[20:23], v[44:47], v[76:79], v[20:23]
    v_mfma_f32_16x16x32_bf16 v[24:27], v[44:47], v[80:83], v[24:27]
    v_mfma_f32_16x16x32_bf16 v[28:31], v[44:47], v[84:87], v[28:31]
    v_mfma_f32_16x16x32_bf16 v[32:35], v[44:47], v[88:91], v[32:35]
    v_mfma_f32_16x16x32_bf16 v[16:19], v[48:51], v[68:71], v[16:19]
    v_mfma_f32_16x16x32_bf16 v[20:23], v[48:51], v[72:75], v[20:23]
    v_mfma_f32_16x16x32_bf16 v[24:27], v[48:51], v[76:79], v[24:27]
    v_mfma_f32_16x16x32_bf16 v[28:31], v[48:51], v[80:83], v[28:31]
    v_mfma_f32_16x16x32_bf16 v[32:35], v[48:51], v[84:87], v[32:35]
    v_mfma_f32_16x16x32_bf16 v[20:23], v[52:55], v[68:71], v[20:23]
    v_mfma_f32_16x16x32_bf16 v[24:27], v[52:55], v[72:75], v[24:27]
    v_mfma_f32_16x16x32_bf16 v[28:31], v[52:55], v[76:79], v[28:31]
    v_mfma_f32_16x16x32_bf16 v[32:35], v[52:55], v[80:83], v[32:35]
    v_mfma_f32_16x16x32_bf16 v[24:27], v[56:59], v[68:71], v[24:27]
    v_mfma_f32_16x16x32_bf16 v[28:31], v[56:59], v[72:75], v[28:31]
    v_mfma_f32_16x16x32_bf16 v[32:35], v[56:59], v[76:79], v[32:35]
    v_mfma_f32_16x16x32_bf16 v[28:31], v[60:63], v[68:71], v[28:31]
    v_mfma_f32_16x16x32_bf16 v[32:35], v[60:63], v[72:75], v[32:35]
    v_mfma_f32_16x16x32_bf16 v[32:35], v[64:67], v[68:71], v[32:35]
    s_mov_b32 s22, 320
    s_mov_b32 s23, 352
    v_subrev_u32 v3, 160, v2
    buffer_load_dwordx4 v[68:71], v3, s[8:11], 0 offen sc1
    buffer_load_dwordx4 v[72:75], v2, s[8:11], s23 offen offset:0 sc1
    buffer_load_dwordx4 v[76:79], v2, s[8:11], s23 offen offset:512 sc1
    buffer_load_dwordx4 v[80:83], v2, s[8:11], s23 offen offset:1024 sc1
    buffer_load_dwordx4 v[84:87], v2, s[8:11], s23 offen offset:1536 sc1
    buffer_load_dwordx4 v[88:91], v2, s[8:11], s23 offen offset:2048 sc1
    buffer_load_dwordx4 v[92:95], v2, s[8:11], s23 offen offset:2560 sc1
    buffer_load_dwordx4 v[96:99], v2, s[8:11], s23 offen offset:3072 sc1
    buffer_load_dwordx4 v[36:39], v1, s[4:7], s22 offen offset:3584
    buffer_load_dwordx4 v[40:43], v1, s[4:7], s22 offen offset:3072
    buffer_load_dwordx4 v[44:47], v1, s[4:7], s22 offen offset:2560
    buffer_load_dwordx4 v[48:51], v1, s[4:7], s22 offen offset:2048
    buffer_load_dwordx4 v[52:55], v1, s[4:7], s22 offen offset:1536
    buffer_load_dwordx4 v[56:59], v1, s[4:7], s22 offen offset:1024
    buffer_load_dwordx4 v[60:63], v1, s[4:7], s22 offen offset:512
    buffer_load_dwordx4 v[64:67], v1, s[4:7], s22 offen offset:0
    s_waitcnt vmcnt(16)
    v_mfma_f32_16x16x32_bf16 v[4:7], v[100:103], v[132:135], v[4:7]
    v_mfma_f32_16x16x32_bf16 v[8:11], v[100:103], v[136:139], v[8:11]
    v_mfma_f32_16x16x32_bf16 v[12:15], v[100:103], v[140:143], v[12:15]
    v_mfma_f32_16x16x32_bf16 v[16:19], v[100:103], v[144:147], v[16:19]
    v_mfma_f32_16x16x32_bf16 v[20:23], v[100:103], v[148:151], v[20:23]
    v_mfma_f32_16x16x32_bf16 v[24:27], v[100:103], v[152:155], v[24:27]
    v_mfma_f32_16x16x32_bf16 v[28:31], v[100:103], v[156:159], v[28:31]
    v_mfma_f32_16x16x32_bf16 v[32:35], v[100:103], v[160:163], v[32:35]
    v_mfma_f32_16x16x32_bf16 v[8:11], v[104:107], v[132:135], v[8:11]
    v_mfma_f32_16x16x32_bf16 v[12:15], v[104:107], v[136:139], v[12:15]
    v_mfma_f32_16x16x32_bf16 v[16:19], v[104:107], v[140:143], v[16:19]
    v_mfma_f32_16x16x32_bf16 v[20:23], v[104:107], v[144:147], v[20:23]
    v_mfma_f32_16x16x32_bf16 v[24:27], v[104:107], v[148:151], v[24:27]
    v_mfma_f32_16x16x32_bf16 v[28:31], v[104:107], v[152:155], v[28:31]
    v_mfma_f32_16x16x32_bf16 v[32:35], v[104:107], v[156:159], v[32:35]
    v_mfma_f32_16x16x32_bf16 v[12:15], v[108:111], v[132:135], v[12:15]
    v_mfma_f32_16x16x32_bf16 v[16:19], v[108:111], v[136:139], v[16:19]
    v_mfma_f32_16x16x32_bf16 v[20:23], v[108:111], v[140:143], v[20:23]
    v_mfma_f32_16x16x32_bf16 v[24:27], v[108:111], v[144:147], v[24:27]
    v_mfma_f32_16x16x32_bf16 v[28:31], v[108:111], v[148:151], v[28:31]
    v_mfma_f32_16x16x32_bf16 v[32:35], v[108:111], v[152:155], v[32:35]
    v_mfma_f32_16x16x32_bf16 v[16:19], v[112:115], v[132:135], v[16:19]
    v_mfma_f32_16x16x32_bf16 v[20:23], v[112:115], v[136:139], v[20:23]
    v_mfma_f32_16x16x32_bf16 v[24:27], v[112:115], v[140:143], v[24:27]
    v_mfma_f32_16x16x32_bf16 v[28:31], v[112:115], v[144:147], v[28:31]
    v_mfma_f32_16x16x32_bf16 v[32:35], v[112:115], v[148:151], v[32:35]
    v_mfma_f32_16x16x32_bf16 v[20:23], v[116:119], v[132:135], v[20:23]
    v_mfma_f32_16x16x32_bf16 v[24:27], v[116:119], v[136:139], v[24:27]
    v_mfma_f32_16x16x32_bf16 v[28:31], v[116:119], v[140:143], v[28:31]
    v_mfma_f32_16x16x32_bf16 v[32:35], v[116:119], v[144:147], v[32:35]
    v_mfma_f32_16x16x32_bf16 v[24:27], v[120:123], v[132:135], v[24:27]
    v_mfma_f32_16x16x32_bf16 v[28:31], v[120:123], v[136:139], v[28:31]
    v_mfma_f32_16x16x32_bf16 v[32:35], v[120:123], v[140:143], v[32:35]
    v_mfma_f32_16x16x32_bf16 v[28:31], v[124:127], v[132:135], v[28:31]
    v_mfma_f32_16x16x32_bf16 v[32:35], v[124:127], v[136:139], v[32:35]
    v_mfma_f32_16x16x32_bf16 v[32:35], v[128:131], v[132:135], v[32:35]
    s_mov_b32 s22, 256
    s_mov_b32 s23, 288
    v_subrev_u32 v3, 224, v2
    buffer_load_dwordx4 v[132:135], v3, s[8:11], 0 offen sc1
    buffer_load_dwordx4 v[136:139], v2, s[8:11], s23 offen offset:0 sc1
    buffer_load_dwordx4 v[140:143], v2, s[8:11], s23 offen offset:512 sc1
    buffer_load_dwordx4 v[144:147], v2, s[8:11], s23 offen offset:1024 sc1
    buffer_load_dwordx4 v[148:151], v2, s[8:11], s23 offen offset:1536 sc1
    buffer_load_dwordx4 v[152:155], v2, s[8:11], s23 offen offset:2048 sc1
    buffer_load_dwordx4 v[156:159], v2, s[8:11], s23 offen offset:2560 sc1
    buffer_load_dwordx4 v[160:163], v2, s[8:11], s23 offen offset:3072 sc1
    buffer_load_dwordx4 v[100:103], v1, s[4:7], s22 offen offset:3584
    buffer_load_dwordx4 v[104:107], v1, s[4:7], s22 offen offset:3072
    buffer_load_dwordx4 v[108:111], v1, s[4:7], s22 offen offset:2560
    buffer_load_dwordx4 v[112:115], v1, s[4:7], s22 offen offset:2048
    buffer_load_dwordx4 v[116:119], v1, s[4:7], s22 offen offset:1536
    buffer_load_dwordx4 v[120:123], v1, s[4:7], s22 offen offset:1024
    buffer_load_dwordx4 v[124:127], v1, s[4:7], s22 offen offset:512
    buffer_load_dwordx4 v[128:131], v1, s[4:7], s22 offen offset:0
    s_waitcnt vmcnt(16)
    v_mfma_f32_16x16x32_bf16 v[4:7], v[36:39], v[68:71], v[4:7]
    v_mfma_f32_16x16x32_bf16 v[8:11], v[36:39], v[72:75], v[8:11]
    v_mfma_f32_16x16x32_bf16 v[12:15], v[36:39], v[76:79], v[12:15]
    v_mfma_f32_16x16x32_bf16 v[16:19], v[36:39], v[80:83], v[16:19]
    v_mfma_f32_16x16x32_bf16 v[20:23], v[36:39], v[84:87], v[20:23]
    v_mfma_f32_16x16x32_bf16 v[24:27], v[36:39], v[88:91], v[24:27]
    v_mfma_f32_16x16x32_bf16 v[28:31], v[36:39], v[92:95], v[28:31]
    v_mfma_f32_16x16x32_bf16 v[32:35], v[36:39], v[96:99], v[32:35]
    v_mfma_f32_16x16x32_bf16 v[8:11], v[40:43], v[68:71], v[8:11]
    v_mfma_f32_16x16x32_bf16 v[12:15], v[40:43], v[72:75], v[12:15]
    v_mfma_f32_16x16x32_bf16 v[16:19], v[40:43], v[76:79], v[16:19]
    v_mfma_f32_16x16x32_bf16 v[20:23], v[40:43], v[80:83], v[20:23]
    v_mfma_f32_16x16x32_bf16 v[24:27], v[40:43], v[84:87], v[24:27]
    v_mfma_f32_16x16x32_bf16 v[28:31], v[40:43], v[88:91], v[28:31]
    v_mfma_f32_16x16x32_bf16 v[32:35], v[40:43], v[92:95], v[32:35]
    v_mfma_f32_16x16x32_bf16 v[12:15], v[44:47], v[68:71], v[12:15]
    v_mfma_f32_16x16x32_bf16 v[16:19], v[44:47], v[72:75], v[16:19]
    v_mfma_f32_16x16x32_bf16 v[20:23], v[44:47], v[76:79], v[20:23]
    v_mfma_f32_16x16x32_bf16 v[24:27], v[44:47], v[80:83], v[24:27]
    v_mfma_f32_16x16x32_bf16 v[28:31], v[44:47], v[84:87], v[28:31]
    v_mfma_f32_16x16x32_bf16 v[32:35], v[44:47], v[88:91], v[32:35]
    v_mfma_f32_16x16x32_bf16 v[16:19], v[48:51], v[68:71], v[16:19]
    v_mfma_f32_16x16x32_bf16 v[20:23], v[48:51], v[72:75], v[20:23]
    v_mfma_f32_16x16x32_bf16 v[24:27], v[48:51], v[76:79], v[24:27]
    v_mfma_f32_16x16x32_bf16 v[28:31], v[48:51], v[80:83], v[28:31]
    v_mfma_f32_16x16x32_bf16 v[32:35], v[48:51], v[84:87], v[32:35]
    v_mfma_f32_16x16x32_bf16 v[20:23], v[52:55], v[68:71], v[20:23]
    v_mfma_f32_16x16x32_bf16 v[24:27], v[52:55], v[72:75], v[24:27]
    v_mfma_f32_16x16x32_bf16 v[28:31], v[52:55], v[76:79], v[28:31]
    v_mfma_f32_16x16x32_bf16 v[32:35], v[52:55], v[80:83], v[32:35]
    v_mfma_f32_16x16x32_bf16 v[24:27], v[56:59], v[68:71], v[24:27]
    v_mfma_f32_16x16x32_bf16 v[28:31], v[56:59], v[72:75], v[28:31]
    v_mfma_f32_16x16x32_bf16 v[32:35], v[56:59], v[76:79], v[32:35]
    v_mfma_f32_16x16x32_bf16 v[28:31], v[60:63], v[68:71], v[28:31]
    v_mfma_f32_16x16x32_bf16 v[32:35], v[60:63], v[72:75], v[32:35]
    v_mfma_f32_16x16x32_bf16 v[32:35], v[64:67], v[68:71], v[32:35]
    s_mov_b32 s22, 192
    s_mov_b32 s23, 224
    v_subrev_u32 v3, 288, v2
    buffer_load_dwordx4 v[68:71], v3, s[8:11], 0 offen sc1
    buffer_load_dwordx4 v[72:75], v2, s[8:11], s23 offen offset:0 sc1
    buffer_load_dwordx4 v[76:79], v2, s[8:11], s23 offen offset:512 sc1
    buffer_load_dwordx4 v[80:83], v2, s[8:11], s23 offen offset:1024 sc1
    buffer_load_dwordx4 v[84:87], v2, s[8:11], s23 offen offset:1536 sc1
    buffer_load_dwordx4 v[88:91], v2, s[8:11], s23 offen offset:2048 sc1
    buffer_load_dwordx4 v[92:95], v2, s[8:11], s23 offen offset:2560 sc1
    buffer_load_dwordx4 v[96:99], v2, s[8:11], s23 offen offset:3072 sc1
    buffer_load_dwordx4 v[36:39], v1, s[4:7], s22 offen offset:3584
    buffer_load_dwordx4 v[40:43], v1, s[4:7], s22 offen offset:3072
    buffer_load_dwordx4 v[44:47], v1, s[4:7], s22 offen offset:2560
    buffer_load_dwordx4 v[48:51], v1, s[4:7], s22 offen offset:2048
    buffer_load_dwordx4 v[52:55], v1, s[4:7], s22 offen offset:1536
    buffer_load_dwordx4 v[56:59], v1, s[4:7], s22 offen offset:1024
    buffer_load_dwordx4 v[60:63], v1, s[4:7], s22 offen offset:512
    buffer_load_dwordx4 v[64:67], v1, s[4:7], s22 offen offset:0
    s_waitcnt vmcnt(16)
    v_mfma_f32_16x16x32_bf16 v[4:7], v[100:103], v[132:135], v[4:7]
    v_mfma_f32_16x16x32_bf16 v[8:11], v[100:103], v[136:139], v[8:11]
    v_mfma_f32_16x16x32_bf16 v[12:15], v[100:103], v[140:143], v[12:15]
    v_mfma_f32_16x16x32_bf16 v[16:19], v[100:103], v[144:147], v[16:19]
    v_mfma_f32_16x16x32_bf16 v[20:23], v[100:103], v[148:151], v[20:23]
    v_mfma_f32_16x16x32_bf16 v[24:27], v[100:103], v[152:155], v[24:27]
    v_mfma_f32_16x16x32_bf16 v[28:31], v[100:103], v[156:159], v[28:31]
    v_mfma_f32_16x16x32_bf16 v[32:35], v[100:103], v[160:163], v[32:35]
    v_mfma_f32_16x16x32_bf16 v[8:11], v[104:107], v[132:135], v[8:11]
    v_mfma_f32_16x16x32_bf16 v[12:15], v[104:107], v[136:139], v[12:15]
    v_mfma_f32_16x16x32_bf16 v[16:19], v[104:107], v[140:143], v[16:19]
    v_mfma_f32_16x16x32_bf16 v[20:23], v[104:107], v[144:147], v[20:23]
    v_mfma_f32_16x16x32_bf16 v[24:27], v[104:107], v[148:151], v[24:27]
    v_mfma_f32_16x16x32_bf16 v[28:31], v[104:107], v[152:155], v[28:31]
    v_mfma_f32_16x16x32_bf16 v[32:35], v[104:107], v[156:159], v[32:35]
    v_mfma_f32_16x16x32_bf16 v[12:15], v[108:111], v[132:135], v[12:15]
    v_mfma_f32_16x16x32_bf16 v[16:19], v[108:111], v[136:139], v[16:19]
    v_mfma_f32_16x16x32_bf16 v[20:23], v[108:111], v[140:143], v[20:23]
    v_mfma_f32_16x16x32_bf16 v[24:27], v[108:111], v[144:147], v[24:27]
    v_mfma_f32_16x16x32_bf16 v[28:31], v[108:111], v[148:151], v[28:31]
    v_mfma_f32_16x16x32_bf16 v[32:35], v[108:111], v[152:155], v[32:35]
    v_mfma_f32_16x16x32_bf16 v[16:19], v[112:115], v[132:135], v[16:19]
    v_mfma_f32_16x16x32_bf16 v[20:23], v[112:115], v[136:139], v[20:23]
    v_mfma_f32_16x16x32_bf16 v[24:27], v[112:115], v[140:143], v[24:27]
    v_mfma_f32_16x16x32_bf16 v[28:31], v[112:115], v[144:147], v[28:31]
    v_mfma_f32_16x16x32_bf16 v[32:35], v[112:115], v[148:151], v[32:35]
    v_mfma_f32_16x16x32_bf16 v[20:23], v[116:119], v[132:135], v[20:23]
    v_mfma_f32_16x16x32_bf16 v[24:27], v[116:119], v[136:139], v[24:27]
    v_mfma_f32_16x16x32_bf16 v[28:31], v[116:119], v[140:143], v[28:31]
    v_mfma_f32_16x16x32_bf16 v[32:35], v[116:119], v[144:147], v[32:35]
    v_mfma_f32_16x16x32_bf16 v[24:27], v[120:123], v[132:135], v[24:27]
    v_mfma_f32_16x16x32_bf16 v[28:31], v[120:123], v[136:139], v[28:31]
    v_mfma_f32_16x16x32_bf16 v[32:35], v[120:123], v[140:143], v[32:35]
    v_mfma_f32_16x16x32_bf16 v[28:31], v[124:127], v[132:135], v[28:31]
    v_mfma_f32_16x16x32_bf16 v[32:35], v[124:127], v[136:139], v[32:35]
    v_mfma_f32_16x16x32_bf16 v[32:35], v[128:131], v[132:135], v[32:35]
    s_mov_b32 s22, 128
    s_mov_b32 s23, 160
    v_subrev_u32 v3, 352, v2
    buffer_load_dwordx4 v[132:135], v3, s[8:11], 0 offen sc1
    buffer_load_dwordx4 v[136:139], v2, s[8:11], s23 offen offset:0 sc1
    buffer_load_dwordx4 v[140:143], v2, s[8:11], s23 offen offset:512 sc1
    buffer_load_dwordx4 v[144:147], v2, s[8:11], s23 offen offset:1024 sc1
    buffer_load_dwordx4 v[148:151], v2, s[8:11], s23 offen offset:1536 sc1
    buffer_load_dwordx4 v[152:155], v2, s[8:11], s23 offen offset:2048 sc1
    buffer_load_dwordx4 v[156:159], v2, s[8:11], s23 offen offset:2560 sc1
    buffer_load_dwordx4 v[160:163], v2, s[8:11], s23 offen offset:3072 sc1
    buffer_load_dwordx4 v[100:103], v1, s[4:7], s22 offen offset:3584
    buffer_load_dwordx4 v[104:107], v1, s[4:7], s22 offen offset:3072
    buffer_load_dwordx4 v[108:111], v1, s[4:7], s22 offen offset:2560
    buffer_load_dwordx4 v[112:115], v1, s[4:7], s22 offen offset:2048
    buffer_load_dwordx4 v[116:119], v1, s[4:7], s22 offen offset:1536
    buffer_load_dwordx4 v[120:123], v1, s[4:7], s22 offen offset:1024
    buffer_load_dwordx4 v[124:127], v1, s[4:7], s22 offen offset:512
    buffer_load_dwordx4 v[128:131], v1, s[4:7], s22 offen offset:0
    s_waitcnt vmcnt(16)
    v_mfma_f32_16x16x32_bf16 v[4:7], v[36:39], v[68:71], v[4:7]
    v_mfma_f32_16x16x32_bf16 v[8:11], v[36:39], v[72:75], v[8:11]
    v_mfma_f32_16x16x32_bf16 v[12:15], v[36:39], v[76:79], v[12:15]
    v_mfma_f32_16x16x32_bf16 v[16:19], v[36:39], v[80:83], v[16:19]
    v_mfma_f32_16x16x32_bf16 v[20:23], v[36:39], v[84:87], v[20:23]
    v_mfma_f32_16x16x32_bf16 v[24:27], v[36:39], v[88:91], v[24:27]
    v_mfma_f32_16x16x32_bf16 v[28:31], v[36:39], v[92:95], v[28:31]
    v_mfma_f32_16x16x32_bf16 v[32:35], v[36:39], v[96:99], v[32:35]
    v_mfma_f32_16x16x32_bf16 v[8:11], v[40:43], v[68:71], v[8:11]
    v_mfma_f32_16x16x32_bf16 v[12:15], v[40:43], v[72:75], v[12:15]
    v_mfma_f32_16x16x32_bf16 v[16:19], v[40:43], v[76:79], v[16:19]
    v_mfma_f32_16x16x32_bf16 v[20:23], v[40:43], v[80:83], v[20:23]
    v_mfma_f32_16x16x32_bf16 v[24:27], v[40:43], v[84:87], v[24:27]
    v_mfma_f32_16x16x32_bf16 v[28:31], v[40:43], v[88:91], v[28:31]
    v_mfma_f32_16x16x32_bf16 v[32:35], v[40:43], v[92:95], v[32:35]
    v_mfma_f32_16x16x32_bf16 v[12:15], v[44:47], v[68:71], v[12:15]
    v_mfma_f32_16x16x32_bf16 v[16:19], v[44:47], v[72:75], v[16:19]
    v_mfma_f32_16x16x32_bf16 v[20:23], v[44:47], v[76:79], v[20:23]
    v_mfma_f32_16x16x32_bf16 v[24:27], v[44:47], v[80:83], v[24:27]
    v_mfma_f32_16x16x32_bf16 v[28:31], v[44:47], v[84:87], v[28:31]
    v_mfma_f32_16x16x32_bf16 v[32:35], v[44:47], v[88:91], v[32:35]
    v_mfma_f32_16x16x32_bf16 v[16:19], v[48:51], v[68:71], v[16:19]
    v_mfma_f32_16x16x32_bf16 v[20:23], v[48:51], v[72:75], v[20:23]
    v_mfma_f32_16x16x32_bf16 v[24:27], v[48:51], v[76:79], v[24:27]
    v_mfma_f32_16x16x32_bf16 v[28:31], v[48:51], v[80:83], v[28:31]
    v_mfma_f32_16x16x32_bf16 v[32:35], v[48:51], v[84:87], v[32:35]
    v_mfma_f32_16x16x32_bf16 v[20:23], v[52:55], v[68:71], v[20:23]
    v_mfma_f32_16x16x32_bf16 v[24:27], v[52:55], v[72:75], v[24:27]
    v_mfma_f32_16x16x32_bf16 v[28:31], v[52:55], v[76:79], v[28:31]
    v_mfma_f32_16x16x32_bf16 v[32:35], v[52:55], v[80:83], v[32:35]
    v_mfma_f32_16x16x32_bf16 v[24:27], v[56:59], v[68:71], v[24:27]
    v_mfma_f32_16x16x32_bf16 v[28:31], v[56:59], v[72:75], v[28:31]
    v_mfma_f32_16x16x32_bf16 v[32:35], v[56:59], v[76:79], v[32:35]
    v_mfma_f32_16x16x32_bf16 v[28:31], v[60:63], v[68:71], v[28:31]
    v_mfma_f32_16x16x32_bf16 v[32:35], v[60:63], v[72:75], v[32:35]
    v_mfma_f32_16x16x32_bf16 v[32:35], v[64:67], v[68:71], v[32:35]
    s_mov_b32 s22, 64
    s_mov_b32 s23, 96
    v_subrev_u32 v3, 416, v2
    buffer_load_dwordx4 v[68:71], v3, s[8:11], 0 offen sc1
    buffer_load_dwordx4 v[72:75], v2, s[8:11], s23 offen offset:0 sc1
    buffer_load_dwordx4 v[76:79], v2, s[8:11], s23 offen offset:512 sc1
    buffer_load_dwordx4 v[80:83], v2, s[8:11], s23 offen offset:1024 sc1
    buffer_load_dwordx4 v[84:87], v2, s[8:11], s23 offen offset:1536 sc1
    buffer_load_dwordx4 v[88:91], v2, s[8:11], s23 offen offset:2048 sc1
    buffer_load_dwordx4 v[92:95], v2, s[8:11], s23 offen offset:2560 sc1
    buffer_load_dwordx4 v[96:99], v2, s[8:11], s23 offen offset:3072 sc1
    buffer_load_dwordx4 v[36:39], v1, s[4:7], s22 offen offset:3584
    buffer_load_dwordx4 v[40:43], v1, s[4:7], s22 offen offset:3072
    buffer_load_dwordx4 v[44:47], v1, s[4:7], s22 offen offset:2560
    buffer_load_dwordx4 v[48:51], v1, s[4:7], s22 offen offset:2048
    buffer_load_dwordx4 v[52:55], v1, s[4:7], s22 offen offset:1536
    buffer_load_dwordx4 v[56:59], v1, s[4:7], s22 offen offset:1024
    buffer_load_dwordx4 v[60:63], v1, s[4:7], s22 offen offset:512
    buffer_load_dwordx4 v[64:67], v1, s[4:7], s22 offen offset:0
    s_waitcnt vmcnt(16)
    v_mfma_f32_16x16x32_bf16 v[4:7], v[100:103], v[132:135], v[4:7]
    v_mfma_f32_16x16x32_bf16 v[8:11], v[100:103], v[136:139], v[8:11]
    v_mfma_f32_16x16x32_bf16 v[12:15], v[100:103], v[140:143], v[12:15]
    v_mfma_f32_16x16x32_bf16 v[16:19], v[100:103], v[144:147], v[16:19]
    v_mfma_f32_16x16x32_bf16 v[20:23], v[100:103], v[148:151], v[20:23]
    v_mfma_f32_16x16x32_bf16 v[24:27], v[100:103], v[152:155], v[24:27]
    v_mfma_f32_16x16x32_bf16 v[28:31], v[100:103], v[156:159], v[28:31]
    v_mfma_f32_16x16x32_bf16 v[32:35], v[100:103], v[160:163], v[32:35]
    v_mfma_f32_16x16x32_bf16 v[8:11], v[104:107], v[132:135], v[8:11]
    v_mfma_f32_16x16x32_bf16 v[12:15], v[104:107], v[136:139], v[12:15]
    v_mfma_f32_16x16x32_bf16 v[16:19], v[104:107], v[140:143], v[16:19]
    v_mfma_f32_16x16x32_bf16 v[20:23], v[104:107], v[144:147], v[20:23]
    v_mfma_f32_16x16x32_bf16 v[24:27], v[104:107], v[148:151], v[24:27]
    v_mfma_f32_16x16x32_bf16 v[28:31], v[104:107], v[152:155], v[28:31]
    v_mfma_f32_16x16x32_bf16 v[32:35], v[104:107], v[156:159], v[32:35]
    v_mfma_f32_16x16x32_bf16 v[12:15], v[108:111], v[132:135], v[12:15]
    v_mfma_f32_16x16x32_bf16 v[16:19], v[108:111], v[136:139], v[16:19]
    v_mfma_f32_16x16x32_bf16 v[20:23], v[108:111], v[140:143], v[20:23]
    v_mfma_f32_16x16x32_bf16 v[24:27], v[108:111], v[144:147], v[24:27]
    v_mfma_f32_16x16x32_bf16 v[28:31], v[108:111], v[148:151], v[28:31]
    v_mfma_f32_16x16x32_bf16 v[32:35], v[108:111], v[152:155], v[32:35]
    v_mfma_f32_16x16x32_bf16 v[16:19], v[112:115], v[132:135], v[16:19]
    v_mfma_f32_16x16x32_bf16 v[20:23], v[112:115], v[136:139], v[20:23]
    v_mfma_f32_16x16x32_bf16 v[24:27], v[112:115], v[140:143], v[24:27]
    v_mfma_f32_16x16x32_bf16 v[28:31], v[112:115], v[144:147], v[28:31]
    v_mfma_f32_16x16x32_bf16 v[32:35], v[112:115], v[148:151], v[32:35]
    v_mfma_f32_16x16x32_bf16 v[20:23], v[116:119], v[132:135], v[20:23]
    v_mfma_f32_16x16x32_bf16 v[24:27], v[116:119], v[136:139], v[24:27]
    v_mfma_f32_16x16x32_bf16 v[28:31], v[116:119], v[140:143], v[28:31]
    v_mfma_f32_16x16x32_bf16 v[32:35], v[116:119], v[144:147], v[32:35]
    v_mfma_f32_16x16x32_bf16 v[24:27], v[120:123], v[132:135], v[24:27]
    v_mfma_f32_16x16x32_bf16 v[28:31], v[120:123], v[136:139], v[28:31]
    v_mfma_f32_16x16x32_bf16 v[32:35], v[120:123], v[140:143], v[32:35]
    v_mfma_f32_16x16x32_bf16 v[28:31], v[124:127], v[132:135], v[28:31]
    v_mfma_f32_16x16x32_bf16 v[32:35], v[124:127], v[136:139], v[32:35]
    v_mfma_f32_16x16x32_bf16 v[32:35], v[128:131], v[132:135], v[32:35]
    s_mov_b32 s22, 0
    s_mov_b32 s23, 32
    v_subrev_u32 v3, 480, v2
    buffer_load_dwordx4 v[132:135], v3, s[8:11], 0 offen sc1
    buffer_load_dwordx4 v[136:139], v2, s[8:11], s23 offen offset:0 sc1
    buffer_load_dwordx4 v[140:143], v2, s[8:11], s23 offen offset:512 sc1
    buffer_load_dwordx4 v[144:147], v2, s[8:11], s23 offen offset:1024 sc1
    buffer_load_dwordx4 v[148:151], v2, s[8:11], s23 offen offset:1536 sc1
    buffer_load_dwordx4 v[152:155], v2, s[8:11], s23 offen offset:2048 sc1
    buffer_load_dwordx4 v[156:159], v2, s[8:11], s23 offen offset:2560 sc1
    buffer_load_dwordx4 v[160:163], v2, s[8:11], s23 offen offset:3072 sc1
    buffer_load_dwordx4 v[100:103], v1, s[4:7], s22 offen offset:3584
    buffer_load_dwordx4 v[104:107], v1, s[4:7], s22 offen offset:3072
    buffer_load_dwordx4 v[108:111], v1, s[4:7], s22 offen offset:2560
    buffer_load_dwordx4 v[112:115], v1, s[4:7], s22 offen offset:2048
    buffer_load_dwordx4 v[116:119], v1, s[4:7], s22 offen offset:1536
    buffer_load_dwordx4 v[120:123], v1, s[4:7], s22 offen offset:1024
    buffer_load_dwordx4 v[124:127], v1, s[4:7], s22 offen offset:512
    buffer_load_dwordx4 v[128:131], v1, s[4:7], s22 offen offset:0
    s_waitcnt vmcnt(16)
    v_mfma_f32_16x16x32_bf16 v[4:7], v[36:39], v[68:71], v[4:7]
    v_mfma_f32_16x16x32_bf16 v[8:11], v[36:39], v[72:75], v[8:11]
    v_mfma_f32_16x16x32_bf16 v[12:15], v[36:39], v[76:79], v[12:15]
    v_mfma_f32_16x16x32_bf16 v[16:19], v[36:39], v[80:83], v[16:19]
    v_mfma_f32_16x16x32_bf16 v[20:23], v[36:39], v[84:87], v[20:23]
    v_mfma_f32_16x16x32_bf16 v[24:27], v[36:39], v[88:91], v[24:27]
    v_mfma_f32_16x16x32_bf16 v[28:31], v[36:39], v[92:95], v[28:31]
    v_mfma_f32_16x16x32_bf16 v[32:35], v[36:39], v[96:99], v[32:35]
    v_mfma_f32_16x16x32_bf16 v[8:11], v[40:43], v[68:71], v[8:11]
    v_mfma_f32_16x16x32_bf16 v[12:15], v[40:43], v[72:75], v[12:15]
    v_mfma_f32_16x16x32_bf16 v[16:19], v[40:43], v[76:79], v[16:19]
    v_mfma_f32_16x16x32_bf16 v[20:23], v[40:43], v[80:83], v[20:23]
    v_mfma_f32_16x16x32_bf16 v[24:27], v[40:43], v[84:87], v[24:27]
    v_mfma_f32_16x16x32_bf16 v[28:31], v[40:43], v[88:91], v[28:31]
    v_mfma_f32_16x16x32_bf16 v[32:35], v[40:43], v[92:95], v[32:35]
    v_mfma_f32_16x16x32_bf16 v[12:15], v[44:47], v[68:71], v[12:15]
    v_mfma_f32_16x16x32_bf16 v[16:19], v[44:47], v[72:75], v[16:19]
    v_mfma_f32_16x16x32_bf16 v[20:23], v[44:47], v[76:79], v[20:23]
    v_mfma_f32_16x16x32_bf16 v[24:27], v[44:47], v[80:83], v[24:27]
    v_mfma_f32_16x16x32_bf16 v[28:31], v[44:47], v[84:87], v[28:31]
    v_mfma_f32_16x16x32_bf16 v[32:35], v[44:47], v[88:91], v[32:35]
    v_mfma_f32_16x16x32_bf16 v[16:19], v[48:51], v[68:71], v[16:19]
    v_mfma_f32_16x16x32_bf16 v[20:23], v[48:51], v[72:75], v[20:23]
    v_mfma_f32_16x16x32_bf16 v[24:27], v[48:51], v[76:79], v[24:27]
    v_mfma_f32_16x16x32_bf16 v[28:31], v[48:51], v[80:83], v[28:31]
    v_mfma_f32_16x16x32_bf16 v[32:35], v[48:51], v[84:87], v[32:35]
    v_mfma_f32_16x16x32_bf16 v[20:23], v[52:55], v[68:71], v[20:23]
    v_mfma_f32_16x16x32_bf16 v[24:27], v[52:55], v[72:75], v[24:27]
    v_mfma_f32_16x16x32_bf16 v[28:31], v[52:55], v[76:79], v[28:31]
    v_mfma_f32_16x16x32_bf16 v[32:35], v[52:55], v[80:83], v[32:35]
    v_mfma_f32_16x16x32_bf16 v[24:27], v[56:59], v[68:71], v[24:27]
    v_mfma_f32_16x16x32_bf16 v[28:31], v[56:59], v[72:75], v[28:31]
    v_mfma_f32_16x16x32_bf16 v[32:35], v[56:59], v[76:79], v[32:35]
    v_mfma_f32_16x16x32_bf16 v[28:31], v[60:63], v[68:71], v[28:31]
    v_mfma_f32_16x16x32_bf16 v[32:35], v[60:63], v[72:75], v[32:35]
    v_mfma_f32_16x16x32_bf16 v[32:35], v[64:67], v[68:71], v[32:35]
    s_waitcnt vmcnt(0)
    v_mfma_f32_16x16x32_bf16 v[4:7], v[100:103], v[132:135], v[4:7]
    v_mfma_f32_16x16x32_bf16 v[8:11], v[100:103], v[136:139], v[8:11]
    v_mfma_f32_16x16x32_bf16 v[12:15], v[100:103], v[140:143], v[12:15]
    v_mfma_f32_16x16x32_bf16 v[16:19], v[100:103], v[144:147], v[16:19]
    v_mfma_f32_16x16x32_bf16 v[20:23], v[100:103], v[148:151], v[20:23]
    v_mfma_f32_16x16x32_bf16 v[24:27], v[100:103], v[152:155], v[24:27]
    v_mfma_f32_16x16x32_bf16 v[28:31], v[100:103], v[156:159], v[28:31]
    v_mfma_f32_16x16x32_bf16 v[32:35], v[100:103], v[160:163], v[32:35]
    v_mfma_f32_16x16x32_bf16 v[8:11], v[104:107], v[132:135], v[8:11]
    v_mfma_f32_16x16x32_bf16 v[12:15], v[104:107], v[136:139], v[12:15]
    v_mfma_f32_16x16x32_bf16 v[16:19], v[104:107], v[140:143], v[16:19]
    v_mfma_f32_16x16x32_bf16 v[20:23], v[104:107], v[144:147], v[20:23]
    v_mfma_f32_16x16x32_bf16 v[24:27], v[104:107], v[148:151], v[24:27]
    v_mfma_f32_16x16x32_bf16 v[28:31], v[104:107], v[152:155], v[28:31]
    v_mfma_f32_16x16x32_bf16 v[32:35], v[104:107], v[156:159], v[32:35]
    v_mfma_f32_16x16x32_bf16 v[12:15], v[108:111], v[132:135], v[12:15]
    v_mfma_f32_16x16x32_bf16 v[16:19], v[108:111], v[136:139], v[16:19]
    v_mfma_f32_16x16x32_bf16 v[20:23], v[108:111], v[140:143], v[20:23]
    v_mfma_f32_16x16x32_bf16 v[24:27], v[108:111], v[144:147], v[24:27]
    v_mfma_f32_16x16x32_bf16 v[28:31], v[108:111], v[148:151], v[28:31]
    v_mfma_f32_16x16x32_bf16 v[32:35], v[108:111], v[152:155], v[32:35]
    v_mfma_f32_16x16x32_bf16 v[16:19], v[112:115], v[132:135], v[16:19]
    v_mfma_f32_16x16x32_bf16 v[20:23], v[112:115], v[136:139], v[20:23]
    v_mfma_f32_16x16x32_bf16 v[24:27], v[112:115], v[140:143], v[24:27]
    v_mfma_f32_16x16x32_bf16 v[28:31], v[112:115], v[144:147], v[28:31]
    v_mfma_f32_16x16x32_bf16 v[32:35], v[112:115], v[148:151], v[32:35]
    v_mfma_f32_16x16x32_bf16 v[20:23], v[116:119], v[132:135], v[20:23]
    v_mfma_f32_16x16x32_bf16 v[24:27], v[116:119], v[136:139], v[24:27]
    v_mfma_f32_16x16x32_bf16 v[28:31], v[116:119], v[140:143], v[28:31]
    v_mfma_f32_16x16x32_bf16 v[32:35], v[116:119], v[144:147], v[32:35]
    v_mfma_f32_16x16x32_bf16 v[24:27], v[120:123], v[132:135], v[24:27]
    v_mfma_f32_16x16x32_bf16 v[28:31], v[120:123], v[136:139], v[28:31]
    v_mfma_f32_16x16x32_bf16 v[32:35], v[120:123], v[140:143], v[32:35]
    v_mfma_f32_16x16x32_bf16 v[28:31], v[124:127], v[132:135], v[28:31]
    v_mfma_f32_16x16x32_bf16 v[32:35], v[124:127], v[136:139], v[32:35]
    v_mfma_f32_16x16x32_bf16 v[32:35], v[128:131], v[132:135], v[32:35]
    v_cvt_pk_bf16_f32 v36, v4, v5
    v_cvt_pk_bf16_f32 v37, v6, v7
    buffer_store_dwordx2 v[36:37], v0, s[12:15], s21 offen offset:0 sc1
    v_cvt_pk_bf16_f32 v38, v8, v9
    v_cvt_pk_bf16_f32 v39, v10, v11
    buffer_store_dwordx2 v[38:39], v0, s[12:15], s21 offen offset:512 sc1
    v_cvt_pk_bf16_f32 v40, v12, v13
    v_cvt_pk_bf16_f32 v41, v14, v15
    buffer_store_dwordx2 v[40:41], v0, s[12:15], s21 offen offset:1024 sc1
    v_cvt_pk_bf16_f32 v42, v16, v17
    v_cvt_pk_bf16_f32 v43, v18, v19
    buffer_store_dwordx2 v[42:43], v0, s[12:15], s21 offen offset:1536 sc1
    v_cvt_pk_bf16_f32 v44, v20, v21
    v_cvt_pk_bf16_f32 v45, v22, v23
    buffer_store_dwordx2 v[44:45], v0, s[12:15], s21 offen offset:2048 sc1
    v_cvt_pk_bf16_f32 v46, v24, v25
    v_cvt_pk_bf16_f32 v47, v26, v27
    buffer_store_dwordx2 v[46:47], v0, s[12:15], s21 offen offset:2560 sc1
    v_cvt_pk_bf16_f32 v48, v28, v29
    v_cvt_pk_bf16_f32 v49, v30, v31
    buffer_store_dwordx2 v[48:49], v0, s[12:15], s21 offen offset:3072 sc1
    v_cvt_pk_bf16_f32 v50, v32, v33
    v_cvt_pk_bf16_f32 v51, v34, v35
    buffer_store_dwordx2 v[50:51], v0, s[12:15], s21 offen offset:3584 sc1
    s_lshl_b32 s19, s16, 3
    s_add_u32 s19, s19, 16351232
    s_waitcnt vmcnt(0)
    v_mov_b32 v8, s32
    v_mov_b32 v9, s33
    v_mov_b32 v10, 0
    s_mov_b64 exec, 1
    buffer_store_dwordx2 v[8:9], v10, s[12:15], s19 offen sc1
    s_mov_b64 exec, -1
    s_endpgm
KG_NONE:
    s_waitcnt lgkmcnt(0)
    s_mov_b32 s12, s70
    s_mov_b32 s13, s71
    s_mov_b32 s14, 0x1680000
    s_mov_b32 s15, 0x00020000
    s_and_b32 s27, s2, 6
    s_lshl_b32 s27, s27, 1
    s_bfe_u32 s28, s2, 0x20003
    s_add_u32 s27, s27, s28
    s_and_b32 s28, s2, 1
    s_mul_i32 s29, s28, 5
    s_add_u32 s29, s29, 3
    s_mul_i32 s28, s28, 3
    s_cmp_lt_u32 s2, 96
    s_cselect_b32 s28, s28, s29
    s_lshr_b32 s29, s2, 5
    s_add_u32 s28, s28, s29
    s_mov_b32 s34, 10
    s_cmp_ge_u32 s28, 10
    s_cbranch_scc1 XT40n
    s_and_b32 s29, s27, 3
    s_mul_i32 s29, s29, 5
    s_lshr_b32 s29, s29, 1
    s_add_u32 s29, s29, s28
    s_sub_u32 s30, s29, 10
    s_cmp_ge_u32 s29, 10
    s_cselect_b32 s29, s30, s29
    s_lshl_b32 s29, s29, 18
    s_lshl_b32 s27, s27, 8
    s_add_u32 s29, s29, s27
    s_add_u32 s29, s29, 13631488
    s_sub_u32 s27, s3, 8
    s_mul_i32 s27, s27, 3
    s_mov_b32 s35, 0
    v_lshrrev_b32 v20, 4, v0
    v_bfe_u32 v21, v0, 2, 2
    v_lshl_add_u32 v22, v20, 3, v21
    v_lshlrev_b32 v22, 7, v22
    v_and_b32 v24, 1, v0
    v_lshl_add_u32 v22, v24, 3, v22
    s_and_b32 s30, s35, 3
    s_lshl_b32 s30, s30, 15
    v_add_u32 v22, s30, v22
    v_and_b32 v23, 1, v20
    v_lshlrev_b32 v23, 2, v23
    v_lshrrev_b32 v21, 1, v21
    v_add_u32 v23, v23, v21
    v_bfe_u32 v21, v0, 1, 1
    v_and_b32 v24, 15, v0
    v_lshlrev_b32 v24, 12, v24
    v_lshl_add_u32 v24, v20, 4, v24
    s_add_u32 s28, s27, 0
    s_min_u32 s28, s28, 7
    s_and_b32 s30, s28, 3
    s_lshr_b32 s31, s28, 2
    s_lshl_b32 s28, s30, 1
    v_add_u32 v25, s28, v21
    v_xor_b32 v25, v25, v23
    v_lshl_add_u32 v25, v25, 4, v22
    s_lshl_b32 s28, s31, 13
    v_add_u32 v26, s28, v25
    v_xor_b32 v29, 32, v26
    s_lshl_b32 s28, s30, 16
    s_lshl_b32 s31, s31, 7
    s_add_u32 s28, s28, s31
    v_add_u32 v32, s28, v24
    s_add_u32 s28, s27, 1
    s_min_u32 s28, s28, 7
    s_and_b32 s30, s28, 3
    s_lshr_b32 s31, s28, 2
    s_lshl_b32 s28, s30, 1
    v_add_u32 v25, s28, v21
    v_xor_b32 v25, v25, v23
    v_lshl_add_u32 v25, v25, 4, v22
    s_lshl_b32 s28, s31, 13
    v_add_u32 v27, s28, v25
    v_xor_b32 v30, 32, v27
    s_lshl_b32 s28, s30, 16
    s_lshl_b32 s31, s31, 7
    s_add_u32 s28, s28, s31
    v_add_u32 v33, s28, v24
    s_add_u32 s28, s27, 2
    s_min_u32 s28, s28, 7
    s_and_b32 s30, s28, 3
    s_lshr_b32 s31, s28, 2
    s_lshl_b32 s28, s30, 1
    v_add_u32 v25, s28, v21
    v_xor_b32 v25, v25, v23
    v_lshl_add_u32 v25, v25, 4, v22
    s_lshl_b32 s28, s31, 13
    v_add_u32 v28, s28, v25
    v_xor_b32 v31, 32, v28
    s_lshl_b32 s28, s30, 16
    s_lshl_b32 s31, s31, 7
    s_add_u32 s28, s28, s31
    v_add_u32 v34, s28, v24
    s_sub_u32 s34, 9, s35
XT40b:
    s_barrier
XT40e:
    s_sub_u32 s35, s35, 1
    s_cbranch_scc0 XT40b
    ds_read_b64_tr_b16 v[36:37], v26 offset:0
    ds_read_b64_tr_b16 v[38:39], v29 offset:512
    ds_read_b64_tr_b16 v[40:41], v26 offset:4096
    ds_read_b64_tr_b16 v[42:43], v29 offset:4608
    ds_read_b64_tr_b16 v[44:45], v27 offset:0
    ds_read_b64_tr_b16 v[46:47], v30 offset:512
    ds_read_b64_tr_b16 v[48:49], v27 offset:4096
    ds_read_b64_tr_b16 v[50:51], v30 offset:4608
    ds_read_b64_tr_b16 v[52:53], v28 offset:0
    ds_read_b64_tr_b16 v[54:55], v31 offset:512
    ds_read_b64_tr_b16 v[56:57], v28 offset:4096
    ds_read_b64_tr_b16 v[58:59], v31 offset:4608
    s_waitcnt lgkmcnt(0)
    s_barrier
    s_barrier
    s_barrier
    s_barrier
    s_barrier
    s_barrier
    s_barrier
    s_sub_u32 s34, s34, 7
    buffer_store_dwordx4 v[36:39], v32, s[12:15], s29 offen offset:0 sc1
    buffer_store_dwordx4 v[40:43], v32, s[12:15], s29 offen offset:64 sc1
    buffer_store_dwordx4 v[44:47], v33, s[12:15], s29 offen offset:0 sc1
    buffer_store_dwordx4 v[48:51], v33, s[12:15], s29 offen offset:64 sc1
    buffer_store_dwordx4 v[52:55], v34, s[12:15], s29 offen offset:0 sc1
    buffer_store_dwordx4 v[56:59], v34, s[12:15], s29 offen offset:64 sc1
XT40n:
    s_cmp_eq_u32 s34, 0
    s_cbranch_scc1 XT40d
XT40c:
    s_barrier
    s_sub_u32 s34, s34, 1
    s_cmp_lg_u32 s34, 0
    s_cbranch_scc1 XT40c
XT40d:
    v_mov_b32 v20, 163584
    v_mov_b32 v21, 1
    s_mov_b64 exec, 1
    s_waitcnt vmcnt(0)
    ds_add_u32 v20, v21 offset:8
    s_mov_b64 exec, -1
    ds_write_b32 v8, v9
    s_sub_u32 s16, s16, 640
    s_waitcnt lgkmcnt(0)
    s_mul_i32 s17, s16, 20480
    v_and_b32 v2, 15, v0
    v_lshrrev_b32 v3, 4, v0
    v_mul_u32_u24 v4, 1280, v2
    v_lshl_add_u32 v4, v3, 4, v4
    v_lshlrev_b32 v5, 4, v3
    v_mov_b32 v6, 163584
    s_mov_b32 s4, s36
    s_mov_b32 s5, s37
    s_mov_b32 s6, 0x280000
    s_mov_b32 s7, 0x00020000
    s_mov_b32 s8, s64
    s_mov_b32 s9, s65
    s_mov_b32 s10, 0x500
    s_mov_b32 s11, 0x00020000
    s_mov_b32 s12, s70
    s_mov_b32 s13, s71
    s_mov_b32 s14, 0x1680000
    s_mov_b32 s15, 0x00020000
LW41:
    ds_read_b32 v7, v6 offset:12
    s_waitcnt lgkmcnt(0)
    v_readfirstlane_b32 s34, v7
    s_nop 0
    s_cmp_ge_u32 s34, 8
    s_cbranch_scc1 LD42
    s_sleep 1
    s_branch LW41
LD42:
    ds_read_b64 v[12:13], v6 offset:0
    buffer_load_dwordx4 v[16:19], v4, s[4:7], s17 offen offset:0
    buffer_load_dwordx4 v[56:59], v5, s[8:11], 0 offen offset:0
    buffer_load_dwordx4 v[20:23], v4, s[4:7], s17 offen offset:64
    buffer_load_dwordx4 v[60:63], v5, s[8:11], 0 offen offset:64
    buffer_load_dwordx4 v[24:27], v4, s[4:7], s17 offen offset:128
    buffer_load_dwordx4 v[64:67], v5, s[8:11], 0 offen offset:128
    buffer_load_dwordx4 v[28:31], v4, s[4:7], s17 offen offset:192
    buffer_load_dwordx4 v[68:71], v5, s[8:11], 0 offen offset:192
    buffer_load_dwordx4 v[32:35], v4, s[4:7], s17 offen offset:256
    buffer_load_dwordx4 v[72:75], v5, s[8:11], 0 offen offset:256
    buffer_load_dwordx4 v[36:39], v4, s[4:7], s17 offen offset:320
    buffer_load_dwordx4 v[76:79], v5, s[8:11], 0 offen offset:320
    buffer_load_dwordx4 v[40:43], v4, s[4:7], s17 offen offset:384
    buffer_load_dwordx4 v[80:83], v5, s[8:11], 0 offen offset:384
    buffer_load_dwordx4 v[44:47], v4, s[4:7], s17 offen offset:448
    buffer_load_dwordx4 v[84:87], v5, s[8:11], 0 offen offset:448
    buffer_load_dwordx4 v[48:51], v4, s[4:7], s17 offen offset:512
    buffer_load_dwordx4 v[88:91], v5, s[8:11], 0 offen offset:512
    buffer_load_dwordx4 v[52:55], v4, s[4:7], s17 offen offset:576
    buffer_load_dwordx4 v[92:95], v5, s[8:11], 0 offen offset:576
    s_waitcnt vmcnt(18)
    v_mfma_f32_16x16x32_bf16 v[8:11], v[56:59], v[16:19], 0
    s_waitcnt vmcnt(16)
    v_mfma_f32_16x16x32_bf16 v[8:11], v[60:63], v[20:23], v[8:11]
    s_waitcnt vmcnt(14)
    v_mfma_f32_16x16x32_bf16 v[8:11], v[64:67], v[24:27], v[8:11]
    s_waitcnt vmcnt(12)
    v_mfma_f32_16x16x32_bf16 v[8:11], v[68:71], v[28:31], v[8:11]
    s_waitcnt vmcnt(10)
    v_mfma_f32_16x16x32_bf16 v[8:11], v[72:75], v[32:35], v[8:11]
    s_waitcnt vmcnt(8)
    v_mfma_f32_16x16x32_bf16 v[8:11], v[76:79], v[36:39], v[8:11]
    s_waitcnt vmcnt(6)
    v_mfma_f32_16x16x32_bf16 v[8:11], v[80:83], v[40:43], v[8:11]
    s_waitcnt vmcnt(4)
    v_mfma_f32_16x16x32_bf16 v[8:11], v[84:87], v[44:47], v[8:11]
    s_waitcnt vmcnt(2)
    v_mfma_f32_16x16x32_bf16 v[8:11], v[88:91], v[48:51], v[8:11]
    s_waitcnt vmcnt(0)
    v_mfma_f32_16x16x32_bf16 v[8:11], v[92:95], v[52:55], v[8:11]
    buffer_load_dwordx4 v[16:19], v4, s[4:7], s17 offen offset:640
    buffer_load_dwordx4 v[56:59], v5, s[8:11], 0 offen offset:640
    buffer_load_dwordx4 v[20:23], v4, s[4:7], s17 offen offset:704
    buffer_load_dwordx4 v[60:63], v5, s[8:11], 0 offen offset:704
    buffer_load_dwordx4 v[24:27], v4, s[4:7], s17 offen offset:768
    buffer_load_dwordx4 v[64:67], v5, s[8:11], 0 offen offset:768
    buffer_load_dwordx4 v[28:31], v4, s[4:7], s17 offen offset:832
    buffer_load_dwordx4 v[68:71], v5, s[8:11], 0 offen offset:832
    buffer_load_dwordx4 v[32:35], v4, s[4:7], s17 offen offset:896
    buffer_load_dwordx4 v[72:75], v5, s[8:11], 0 offen offset:896
    buffer_load_dwordx4 v[36:39], v4, s[4:7], s17 offen offset:960
    buffer_load_dwordx4 v[76:79], v5, s[8:11], 0 offen offset:960
    buffer_load_dwordx4 v[40:43], v4, s[4:7], s17 offen offset:1024
    buffer_load_dwordx4 v[80:83], v5, s[8:11], 0 offen offset:1024
    buffer_load_dwordx4 v[44:47], v4, s[4:7], s17 offen offset:1088
    buffer_load_dwordx4 v[84:87], v5, s[8:11], 0 offen offset:1088
    buffer_load_dwordx4 v[48:51], v4, s[4:7], s17 offen offset:1152
    buffer_load_dwordx4 v[88:91], v5, s[8:11], 0 offen offset:1152
    buffer_load_dwordx4 v[52:55], v4, s[4:7], s17 offen offset:1216
    buffer_load_dwordx4 v[92:95], v5, s[8:11], 0 offen offset:1216
    s_waitcnt vmcnt(18)
    v_mfma_f32_16x16x32_bf16 v[8:11], v[56:59], v[16:19], v[8:11]
    s_waitcnt vmcnt(16)
    v_mfma_f32_16x16x32_bf16 v[8:11], v[60:63], v[20:23], v[8:11]
    s_waitcnt vmcnt(14)
    v_mfma_f32_16x16x32_bf16 v[8:11], v[64:67], v[24:27], v[8:11]
    s_waitcnt vmcnt(12)
    v_mfma_f32_16x16x32_bf16 v[8:11], v[68:71], v[28:31], v[8:11]
    s_waitcnt vmcnt(10)
    v_mfma_f32_16x16x32_bf16 v[8:11], v[72:75], v[32:35], v[8:11]
    s_waitcnt vmcnt(8)
    v_mfma_f32_16x16x32_bf16 v[8:11], v[76:79], v[36:39], v[8:11]
    s_waitcnt vmcnt(6)
    v_mfma_f32_16x16x32_bf16 v[8:11], v[80:83], v[40:43], v[8:11]
    s_waitcnt vmcnt(4)
    v_mfma_f32_16x16x32_bf16 v[8:11], v[84:87], v[44:47], v[8:11]
    s_waitcnt vmcnt(2)
    v_mfma_f32_16x16x32_bf16 v[8:11], v[88:91], v[48:51], v[8:11]
    s_waitcnt vmcnt(0)
    v_mfma_f32_16x16x32_bf16 v[8:11], v[92:95], v[52:55], v[8:11]
    s_mov_b32 s20, 0xbfb8aa3b
    s_nop 7
    v_cvt_pk_bf16_f32 v8, v8, v8
    v_lshlrev_b32 v8, 16, v8
    v_mul_f32 v8, s20, v8
    v_exp_f32 v8, v8
    s_nop 0
    v_add_f32 v8, 1.0, v8
    v_rcp_f32 v8, v8
    s_nop 0
    v_cvt_pk_bf16_f32 v8, v8, v8
    v_lshlrev_b32 v8, 16, v8
    s_lshl_b32 s18, s16, 6
    s_add_u32 s18, s18, 16252928
    v_lshlrev_b32 v9, 2, v2
    s_mov_b64 exec, 0xffff
    buffer_store_dword v8, v9, s[12:15], s18 offen sc1
    s_mov_b64 exec, -1
    s_lshl_b32 s19, s16, 3
    s_add_u32 s19, s19, 16359424
    s_waitcnt vmcnt(0) lgkmcnt(0)
    v_readfirstlane_b32 s32, v12
    v_readfirstlane_b32 s33, v13
    s_nop 0
    v_mov_b32 v8, s32
    v_mov_b32 v9, s33
    v_mov_b32 v10, 0
    s_mov_b64 exec, 1
    buffer_store_dwordx2 v[8:9], v10, s[12:15], s19 offen sc1
    s_mov_b64 exec, -1
    s_endpgm
K_LOADER:
    s_setprio 3
    v_lshlrev_b32 v2, 2, v0
    v_add_u32 v2, 163584, v2
    v_mov_b32 v1, 0
    ds_write_b32 v2, v1
    v_mov_b32 v7, 163584
    s_memrealtime s[32:33]
    s_waitcnt lgkmcnt(0)
    s_or_b32 s32, s32, 1
    s_sub_u32 s34, s32, 2000
    s_cmp_lg_u32 s2, 0
    s_cbranch_scc1 LD_NOTAG
    v_mov_b32 v2, s32
    v_mov_b32 v3, s33
    s_mov_b64 exec, 1
    global_store_dwordx2 v1, v[2:3], s[68:69] sc1
    s_mov_b64 exec, -1
LD_NOTAG:
    global_load_dwordx2 v[2:3], v1, s[68:69] sc1
    s_barrier
    s_barrier
    s_barrier
    s_barrier
    s_waitcnt vmcnt(0)
    v_readfirstlane_b32 s32, v2
    s_nop 0
    s_sub_u32 s35, s32, s34
    s_cmp_lt_u32 s35, 0x100000
    s_cbranch_scc1 LD_T1
    global_load_dwordx2 v[2:3], v1, s[68:69] sc1
LD_T1:
    s_barrier
    s_barrier
    s_barrier
    s_barrier
    s_barrier
    s_barrier
    s_mov_b32 s12, s70
    s_mov_b32 s13, s71
    s_mov_b32 s14, 0x1680000
    s_mov_b32 s15, 0x00020000
    s_mov_b32 s4, s40
    s_mov_b32 s5, s41
    s_mov_b32 s6, 0xc8000
    s_mov_b32 s7, 0x00020000
    s_mov_b32 s35, 0
LD_TAGLOOP:
    s_waitcnt vmcnt(0)
    v_readfirstlane_b32 s32, v2
    v_readfirstlane_b32 s33, v3
    s_add_u32 s35, s35, 1
    s_cmp_eq_u32 s32, 0
    s_cbranch_scc1 LD_TAGRE
    s_sub_u32 vcc_lo, s32, s34
    s_cmp_lt_u32 vcc_lo, 0x100000
    s_cbranch_scc1 LD_TAGOK
    s_cmp_ge_u32 s35, 64
    s_cbranch_scc1 LD_TAGOK
LD_TAGRE:
    s_cmp_ge_u32 s35, 0x100000
    s_cbranch_scc1 LD_TAGOK
    global_load_dwordx2 v[2:3], v1, s[68:69] sc1
    s_branch LD_TAGLOOP
LD_TAGOK:
    ds_write_b64 v7, v[2:3]
    v_lshrrev_b32 v3, 4, v0
    v_add_u32 v3, 1, v3
    v_cmp_le_u32 vcc, 32, v0
    s_nop 1
    v_cndmask_b32 v3, v3, 0, vcc
    v_lshl_add_u32 v3, v3, 5, s44
    v_mul_u32_u24 v3, 43, v3
    v_lshrrev_b32 v3, 8, v3
    v_and_b32 v9, 15, v0
    v_and_b32 v10, 1, v0
    s_lshl_b32 s18, s45, 1
    v_add_u32 v10, s18, v10
    v_cndmask_b32 v10, v9, v10, vcc
    v_lshlrev_b32 v10, 5, v10
    v_lshl_add_u32 v4, v3, 9, v10
    s_mul_i32 s22, s2, 3
    v_cndmask_b32 v3, 0, 2, vcc
    v_add_u32 v3, s22, v3
    v_min_u32 v3, 639, v3
    v_lshrrev_b32 v3, 6, v3
    v_and_b32 v10, 3, v0
    v_mul_u32_u24 v10, 5, v10
    v_lshrrev_b32 v10, 1, v10
    v_sub_u32 v3, v3, v10
    v_add_u32 v10, 10, v3
    v_cmp_gt_i32 vcc, 0, v3
    s_nop 1
    v_cndmask_b32 v3, v3, v10, vcc
    v_lshlrev_b32 v9, 5, v9
    v_lshl_add_u32 v5, v3, 9, v9
    s_mov_b32 s18, 16318464
    v_lshlrev_b32 v6, 4, v0
    s_and_b32 s16, s2, 6
    s_lshl_b32 s16, s16, 1
    s_bfe_u32 s17, s2, 0x20003
    s_add_u32 s16, s16, s17
    s_and_b32 s17, s2, 1
    s_mul_i32 s19, s17, 5
    s_add_u32 s19, s19, 3
    s_mul_i32 s17, s17, 3
    s_cmp_lt_u32 s2, 96
    s_cselect_b32 s17, s17, s19
    s_lshr_b32 s19, s2, 5
    s_add_u32 s17, s17, s19
    s_cmp_ge_u32 s17, 6
    s_cselect_b32 s29, s16, 0
    s_mul_i32 s21, s17, 491520
    s_mul_i32 s22, s16, 5120
    s_add_u32 s21, s21, s22
    s_add_u32 s21, s21, 0
    s_lshl_b32 s19, s17, 9
    s_lshl_b32 s22, s16, 5
    s_add_u32 s19, s19, s22
    s_add_u32 s19, s19, 16318464
    s_mul_i32 s20, s44, 81920
    s_add_u32 s20, s20, 2621440
    s_add_u32 s28, s20, 2621440
    v_add_u32 v14, 65536, v6
    s_mov_b32 s23, 16334848
LW43:
    ds_read_b32 v11, v7 offset:68
    s_waitcnt lgkmcnt(0)
    v_readfirstlane_b32 s34, v11
    s_nop 0
    s_cmp_ge_u32 s34, 8
    s_cbranch_scc1 LD44
    s_branch LW43
LD44:
    s_cmp_ge_u32 s29, 16
    s_cbranch_scc1 LD_LATE
    ds_read_b128 v[16:19], v14 offset:0
    ds_read_b128 v[20:23], v14 offset:1024
    ds_read_b128 v[24:27], v14 offset:2048
    ds_read_b128 v[28:31], v14 offset:3072
    ds_read_b128 v[32:35], v14 offset:4096
    ds_read_b128 v[36:39], v14 offset:5120
    ds_read_b128 v[40:43], v14 offset:6144
    ds_read_b128 v[44:47], v14 offset:7168
    ds_read_b128 v[48:51], v14 offset:8192
    ds_read_b128 v[52:55], v14 offset:9216
    ds_read_b128 v[56:59], v14 offset:10240
    ds_read_b128 v[60:63], v14 offset:11264
    ds_read_b128 v[64:67], v14 offset:12288
    ds_read_b128 v[68:71], v14 offset:13312
    ds_read_b128 v[72:75], v14 offset:14336
    ds_read_b128 v[76:79], v14 offset:15360
    ds_read_b128 v[80:83], v14 offset:16384
    ds_read_b128 v[84:87], v14 offset:17408
    ds_read_b128 v[88:91], v14 offset:18432
    ds_read_b128 v[92:95], v14 offset:19456
    ds_read_b128 v[96:99], v14 offset:20480
    ds_read_b128 v[100:103], v14 offset:21504
    ds_read_b128 v[104:107], v14 offset:22528
    ds_read_b128 v[108:111], v14 offset:23552
    ds_read_b128 v[112:115], v14 offset:24576
    ds_read_b128 v[116:119], v14 offset:25600
    ds_read_b128 v[120:123], v14 offset:26624
    ds_read_b128 v[124:127], v14 offset:27648
    ds_read_b128 v[128:131], v14 offset:28672
    ds_read_b128 v[132:135], v14 offset:29696
    s_waitcnt lgkmcnt(15)
    buffer_store_dwordx4 v[16:19], v6, s[12:15], s21 offen offset:0 sc1
    s_waitcnt lgkmcnt(15)
    buffer_store_dwordx4 v[20:23], v6, s[12:15], s21 offen offset:1024 sc1
    s_waitcnt lgkmcnt(15)
    buffer_store_dwordx4 v[24:27], v6, s[12:15], s21 offen offset:2048 sc1
    s_waitcnt lgkmcnt(15)
    buffer_store_dwordx4 v[28:31], v6, s[12:15], s21 offen offset:3072 sc1
    s_waitcnt lgkmcnt(15)
    s_add_u32 s22, s21, 4096
    buffer_store_dwordx4 v[32:35], v6, s[12:15], s22 offen sc1
    s_add_u32 s21, s21, 81920
    s_waitcnt lgkmcnt(15)
    buffer_store_dwordx4 v[36:39], v6, s[12:15], s21 offen offset:0 sc1
    s_waitcnt lgkmcnt(15)
    buffer_store_dwordx4 v[40:43], v6, s[12:15], s21 offen offset:1024 sc1
    s_waitcnt lgkmcnt(15)
    buffer_store_dwordx4 v[44:47], v6, s[12:15], s21 offen offset:2048 sc1
    s_waitcnt lgkmcnt(15)
    buffer_store_dwordx4 v[48:51], v6, s[12:15], s21 offen offset:3072 sc1
    s_waitcnt lgkmcnt(15)
    s_add_u32 s22, s21, 4096
    buffer_store_dwordx4 v[52:55], v6, s[12:15], s22 offen sc1
    s_add_u32 s21, s21, 81920
    s_waitcnt lgkmcnt(15)
    buffer_store_dwordx4 v[56:59], v6, s[12:15], s21 offen offset:0 sc1
    s_waitcnt lgkmcnt(15)
    buffer_store_dwordx4 v[60:63], v6, s[12:15], s21 offen offset:1024 sc1
    s_waitcnt lgkmcnt(15)
    buffer_store_dwordx4 v[64:67], v6, s[12:15], s21 offen offset:2048 sc1
    s_waitcnt lgkmcnt(15)
    buffer_store_dwordx4 v[68:71], v6, s[12:15], s21 offen offset:3072 sc1
    s_waitcnt lgkmcnt(15)
    s_add_u32 s22, s21, 4096
    buffer_store_dwordx4 v[72:75], v6, s[12:15], s22 offen sc1
    s_add_u32 s21, s21, 81920
    s_waitcnt lgkmcnt(14)
    buffer_store_dwordx4 v[76:79], v6, s[12:15], s21 offen offset:0 sc1
    s_waitcnt lgkmcnt(13)
    buffer_store_dwordx4 v[80:83], v6, s[12:15], s21 offen offset:1024 sc1
    s_waitcnt lgkmcnt(12)
    buffer_store_dwordx4 v[84:87], v6, s[12:15], s21 offen offset:2048 sc1
    s_waitcnt lgkmcnt(11)
    buffer_store_dwordx4 v[88:91], v6, s[12:15], s21 offen offset:3072 sc1
    s_waitcnt lgkmcnt(10)
    s_add_u32 s22, s21, 4096
    buffer_store_dwordx4 v[92:95], v6, s[12:15], s22 offen sc1
    s_add_u32 s21, s21, 81920
    s_waitcnt lgkmcnt(9)
    buffer_store_dwordx4 v[96:99], v6, s[12:15], s21 offen offset:0 sc1
    s_waitcnt lgkmcnt(8)
    buffer_store_dwordx4 v[100:103], v6, s[12:15], s21 offen offset:1024 sc1
    s_waitcnt lgkmcnt(7)
    buffer_store_dwordx4 v[104:107], v6, s[12:15], s21 offen offset:2048 sc1
    s_waitcnt lgkmcnt(6)
    buffer_store_dwordx4 v[108:111], v6, s[12:15], s21 offen offset:3072 sc1
    s_waitcnt lgkmcnt(5)
    s_add_u32 s22, s21, 4096
    buffer_store_dwordx4 v[112:115], v6, s[12:15], s22 offen sc1
    s_add_u32 s21, s21, 81920
    s_waitcnt lgkmcnt(4)
    buffer_store_dwordx4 v[116:119], v6, s[12:15], s21 offen offset:0 sc1
    s_waitcnt lgkmcnt(3)
    buffer_store_dwordx4 v[120:123], v6, s[12:15], s21 offen offset:1024 sc1
    s_waitcnt lgkmcnt(2)
    buffer_store_dwordx4 v[124:127], v6, s[12:15], s21 offen offset:2048 sc1
    s_waitcnt lgkmcnt(1)
    buffer_store_dwordx4 v[128:131], v6, s[12:15], s21 offen offset:3072 sc1
    s_waitcnt lgkmcnt(0)
    s_add_u32 s22, s21, 4096
    buffer_store_dwordx4 v[132:135], v6, s[12:15], s22 offen sc1
    s_add_u32 s21, s21, 81920
    s_waitcnt vmcnt(0)
    v_mov_b32 v8, s32
    v_mov_b32 v9, s33
    v_mov_b32 v10, 0
    s_mov_b64 exec, 1
    buffer_store_dwordx2 v[8:9], v10, s[12:15], s19 offen sc1
    s_mov_b64 exec, -1
LD_LATE:
    s_add_u32 s22, s19, 16384
LW45:
    ds_read_b32 v11, v7 offset:8
    s_waitcnt lgkmcnt(0)
    v_readfirstlane_b32 s34, v11
    s_nop 0
    s_cmp_ge_u32 s34, 3
    s_cbranch_scc1 LD46
    s_branch LW45
LD46:
    v_mov_b32 v8, s32
    v_mov_b32 v9, s33
    v_mov_b32 v10, 0
    s_mov_b64 exec, 1
    buffer_store_dwordx2 v[8:9], v10, s[12:15], s22 offen sc1
    s_mov_b64 exec, -1
    s_mov_b64 s[26:27], 0
    s_and_b32 s34, s27, 3
    s_lshl_b32 s34, s34, 1
    s_and_b32 s22, s26, 0x10001
    s_or_b32 s34, s34, s22
    s_cmp_eq_u32 s34, 0x10007
    s_cbranch_scc1 ND48
    s_mov_b32 s35, 0
NW47:
    buffer_load_dwordx2 v[10:11], v4, s[12:15], s18 offen sc1
    s_waitcnt vmcnt(0)
    v_cmp_eq_u64 s[26:27], s[32:33], v[10:11]
    s_add_u32 s35, s35, 1
    s_and_b32 s34, s27, 3
    s_lshl_b32 s34, s34, 1
    s_and_b32 s22, s26, 0x10001
    s_or_b32 s34, s34, s22
    s_cmp_eq_u32 s34, 0x10007
    s_cbranch_scc1 ND48
    s_cmp_lt_u32 s35, 0x100000
    s_cbranch_scc1 NW47
ND48:
    v_mov_b32 v8, 1
    ds_write_b32 v7, v8 offset:72
    s_mov_b32 m0, 0
    s_add_u32 s22, s20, 4096
    buffer_load_dwordx4 v6, s[12:15], s20 offen offset:0 sc1 lds
    buffer_load_dwordx4 v6, s[12:15], s20 offen offset:1024 sc1 lds
    buffer_load_dwordx4 v6, s[12:15], s20 offen offset:2048 sc1 lds
    buffer_load_dwordx4 v6, s[12:15], s20 offen offset:3072 sc1 lds
    s_mov_b32 m0, 4096
    s_add_u32 s20, s20, 5120
    buffer_load_dwordx4 v6, s[12:15], s22 offen sc1 lds
    s_mov_b32 m0, 5120
    s_add_u32 s22, s28, 4096
    buffer_load_dwordx4 v6, s[12:15], s28 offen offset:0 sc1 lds
    buffer_load_dwordx4 v6, s[12:15], s28 offen offset:1024 sc1 lds
    buffer_load_dwordx4 v6, s[12:15], s28 offen offset:2048 sc1 lds
    buffer_load_dwordx4 v6, s[12:15], s28 offen offset:3072 sc1 lds
    s_mov_b32 m0, 9216
    s_add_u32 s28, s28, 5120
    buffer_load_dwordx4 v6, s[12:15], s22 offen sc1 lds
    s_and_b32 s34, s26, 0x20002
    s_cmp_eq_u32 s34, 0x20002
    s_cbranch_scc1 ND50
    s_mov_b32 s35, 0
NW49:
    buffer_load_dwordx2 v[10:11], v4, s[12:15], s18 offen sc1
    s_waitcnt vmcnt(0)
    v_mov_b32 v8, 1
    s_mov_b64 exec, 1
    ds_max_u32 v7, v8 offset:12
    s_mov_b64 exec, -1
    v_cmp_eq_u64 s[26:27], s[32:33], v[10:11]
    s_add_u32 s35, s35, 1
    s_and_b32 s34, s26, 0x20002
    s_cmp_eq_u32 s34, 0x20002
    s_cbranch_scc1 ND50
    s_cmp_lt_u32 s35, 0x100000
    s_cbranch_scc1 NW49
ND50:
    s_mov_b32 m0, 10240
    s_add_u32 s22, s20, 4096
    buffer_load_dwordx4 v6, s[12:15], s20 offen offset:0 sc1 lds
    buffer_load_dwordx4 v6, s[12:15], s20 offen offset:1024 sc1 lds
    buffer_load_dwordx4 v6, s[12:15], s20 offen offset:2048 sc1 lds
    buffer_load_dwordx4 v6, s[12:15], s20 offen offset:3072 sc1 lds
    s_mov_b32 m0, 14336
    s_add_u32 s20, s20, 5120
    buffer_load_dwordx4 v6, s[12:15], s22 offen sc1 lds
    s_mov_b32 m0, 15360
    s_add_u32 s22, s28, 4096
    buffer_load_dwordx4 v6, s[12:15], s28 offen offset:0 sc1 lds
    buffer_load_dwordx4 v6, s[12:15], s28 offen offset:1024 sc1 lds
    buffer_load_dwordx4 v6, s[12:15], s28 offen offset:2048 sc1 lds
    buffer_load_dwordx4 v6, s[12:15], s28 offen offset:3072 sc1 lds
    s_mov_b32 m0, 19456
    s_add_u32 s28, s28, 5120
    buffer_load_dwordx4 v6, s[12:15], s22 offen sc1 lds
    s_and_b32 s34, s26, 0x40004
    s_cmp_eq_u32 s34, 0x40004
    s_cbranch_scc1 ND52
    s_mov_b32 s35, 0
NW51:
    buffer_load_dwordx2 v[10:11], v4, s[12:15], s18 offen sc1
    s_waitcnt vmcnt(0)
    v_mov_b32 v8, 2
    s_mov_b64 exec, 1
    ds_max_u32 v7, v8 offset:12
    s_mov_b64 exec, -1
    v_cmp_eq_u64 s[26:27], s[32:33], v[10:11]
    s_add_u32 s35, s35, 1
    s_and_b32 s34, s26, 0x40004
    s_cmp_eq_u32 s34, 0x40004
    s_cbranch_scc1 ND52
    s_cmp_lt_u32 s35, 0x100000
    s_cbranch_scc1 NW51
ND52:
    s_mov_b32 m0, 20480
    s_add_u32 s22, s20, 4096
    buffer_load_dwordx4 v6, s[12:15], s20 offen offset:0 sc1 lds
    buffer_load_dwordx4 v6, s[12:15], s20 offen offset:1024 sc1 lds
    buffer_load_dwordx4 v6, s[12:15], s20 offen offset:2048 sc1 lds
    buffer_load_dwordx4 v6, s[12:15], s20 offen offset:3072 sc1 lds
    s_mov_b32 m0, 24576
    s_add_u32 s20, s20, 5120
    buffer_load_dwordx4 v6, s[12:15], s22 offen sc1 lds
    s_mov_b32 m0, 25600
    s_add_u32 s22, s28, 4096
    buffer_load_dwordx4 v6, s[12:15], s28 offen offset:0 sc1 lds
    buffer_load_dwordx4 v6, s[12:15], s28 offen offset:1024 sc1 lds
    buffer_load_dwordx4 v6, s[12:15], s28 offen offset:2048 sc1 lds
    buffer_load_dwordx4 v6, s[12:15], s28 offen offset:3072 sc1 lds
    s_mov_b32 m0, 29696
    s_add_u32 s28, s28, 5120
    buffer_load_dwordx4 v6, s[12:15], s22 offen sc1 lds
    buffer_load_dwordx2 v[12:13], v5, s[12:15], s23 offen sc1
    s_waitcnt vmcnt(21)
    v_mov_b32 v8, 1
    s_mov_b64 exec, 1
    ds_max_u32 v7, v8 offset:12
    s_mov_b64 exec, -1
    s_and_b32 s34, s26, 0x80008
    s_cmp_eq_u32 s34, 0x80008
    s_cbranch_scc1 ND54
    s_mov_b32 s35, 0
NW53:
    buffer_load_dwordx2 v[10:11], v4, s[12:15], s18 offen sc1
    s_waitcnt vmcnt(0)
    v_mov_b32 v8, 3
    s_mov_b64 exec, 1
    ds_max_u32 v7, v8 offset:12
    s_mov_b64 exec, -1
    v_cmp_eq_u64 s[26:27], s[32:33], v[10:11]
    s_add_u32 s35, s35, 1
    s_and_b32 s34, s26, 0x80008
    s_cmp_eq_u32 s34, 0x80008
    s_cbranch_scc1 ND54
    s_cmp_lt_u32 s35, 0x100000
    s_cbranch_scc1 NW53
ND54:
    s_mov_b32 m0, 30720
    s_add_u32 s22, s20, 4096
    buffer_load_dwordx4 v6, s[12:15], s20 offen offset:0 sc1 lds
    buffer_load_dwordx4 v6, s[12:15], s20 offen offset:1024 sc1 lds
    buffer_load_dwordx4 v6, s[12:15], s20 offen offset:2048 sc1 lds
    buffer_load_dwordx4 v6, s[12:15], s20 offen offset:3072 sc1 lds
    s_mov_b32 m0, 34816
    s_add_u32 s20, s20, 5120
    buffer_load_dwordx4 v6, s[12:15], s22 offen sc1 lds
    s_mov_b32 m0, 35840
    s_add_u32 s22, s28, 4096
    buffer_load_dwordx4 v6, s[12:15], s28 offen offset:0 sc1 lds
    buffer_load_dwordx4 v6, s[12:15], s28 offen offset:1024 sc1 lds
    buffer_load_dwordx4 v6, s[12:15], s28 offen offset:2048 sc1 lds
    buffer_load_dwordx4 v6, s[12:15], s28 offen offset:3072 sc1 lds
    s_mov_b32 m0, 39936
    s_add_u32 s28, s28, 5120
    buffer_load_dwordx4 v6, s[12:15], s22 offen sc1 lds
    s_waitcnt vmcnt(21)
    v_mov_b32 v8, 2
    s_mov_b64 exec, 1
    ds_max_u32 v7, v8 offset:12
    s_mov_b64 exec, -1
    s_and_b32 s34, s26, 0x100010
    s_cmp_eq_u32 s34, 0x100010
    s_cbranch_scc1 ND56
    s_mov_b32 s35, 0
NW55:
    buffer_load_dwordx2 v[10:11], v4, s[12:15], s18 offen sc1
    s_waitcnt vmcnt(0)
    v_mov_b32 v8, 4
    s_mov_b64 exec, 1
    ds_max_u32 v7, v8 offset:12
    s_mov_b64 exec, -1
    v_cmp_eq_u64 s[26:27], s[32:33], v[10:11]
    s_add_u32 s35, s35, 1
    s_and_b32 s34, s26, 0x100010
    s_cmp_eq_u32 s34, 0x100010
    s_cbranch_scc1 ND56
    s_cmp_lt_u32 s35, 0x100000
    s_cbranch_scc1 NW55
ND56:
    s_mov_b32 m0, 40960
    s_add_u32 s22, s20, 4096
    buffer_load_dwordx4 v6, s[12:15], s20 offen offset:0 sc1 lds
    buffer_load_dwordx4 v6, s[12:15], s20 offen offset:1024 sc1 lds
    buffer_load_dwordx4 v6, s[12:15], s20 offen offset:2048 sc1 lds
    buffer_load_dwordx4 v6, s[12:15], s20 offen offset:3072 sc1 lds
    s_mov_b32 m0, 45056
    s_add_u32 s20, s20, 5120
    buffer_load_dwordx4 v6, s[12:15], s22 offen sc1 lds
    s_mov_b32 m0, 46080
    s_add_u32 s22, s28, 4096
    buffer_load_dwordx4 v6, s[12:15], s28 offen offset:0 sc1 lds
    buffer_load_dwordx4 v6, s[12:15], s28 offen offset:1024 sc1 lds
    buffer_load_dwordx4 v6, s[12:15], s28 offen offset:2048 sc1 lds
    buffer_load_dwordx4 v6, s[12:15], s28 offen offset:3072 sc1 lds
    s_mov_b32 m0, 50176
    s_add_u32 s28, s28, 5120
    buffer_load_dwordx4 v6, s[12:15], s22 offen sc1 lds
    s_waitcnt vmcnt(20)
    v_cmp_ne_u64 vcc, s[32:33], v[12:13]
    s_nop 0
    s_cmp_lg_u64 vcc, 0
    s_cbranch_scc1 XK57
    v_mov_b32 v8, 1
    ds_write_b32 v7, v8 offset:64
XK57:
    s_waitcnt vmcnt(21)
    v_mov_b32 v8, 3
    s_mov_b64 exec, 1
    ds_max_u32 v7, v8 offset:12
    s_mov_b64 exec, -1
    s_and_b32 s34, s26, 0x200020
    s_cmp_eq_u32 s34, 0x200020
    s_cbranch_scc1 ND59
    s_mov_b32 s35, 0
NW58:
    buffer_load_dwordx2 v[10:11], v4, s[12:15], s18 offen sc1
    s_waitcnt vmcnt(0)
    v_mov_b32 v8, 5
    s_mov_b64 exec, 1
    ds_max_u32 v7, v8 offset:12
    s_mov_b64 exec, -1
    v_cmp_eq_u64 s[26:27], s[32:33], v[10:11]
    s_add_u32 s35, s35, 1
    s_and_b32 s34, s26, 0x200020
    s_cmp_eq_u32 s34, 0x200020
    s_cbranch_scc1 ND59
    s_cmp_lt_u32 s35, 0x100000
    s_cbranch_scc1 NW58
ND59:
    s_mov_b32 m0, 51200
    s_add_u32 s22, s20, 4096
    buffer_load_dwordx4 v6, s[12:15], s20 offen offset:0 sc1 lds
    buffer_load_dwordx4 v6, s[12:15], s20 offen offset:1024 sc1 lds
    buffer_load_dwordx4 v6, s[12:15], s20 offen offset:2048 sc1 lds
    buffer_load_dwordx4 v6, s[12:15], s20 offen offset:3072 sc1 lds
    s_mov_b32 m0, 55296
    s_add_u32 s20, s20, 5120
    buffer_load_dwordx4 v6, s[12:15], s22 offen sc1 lds
    s_mov_b32 m0, 56320
    s_add_u32 s22, s28, 4096
    buffer_load_dwordx4 v6, s[12:15], s28 offen offset:0 sc1 lds
    buffer_load_dwordx4 v6, s[12:15], s28 offen offset:1024 sc1 lds
    buffer_load_dwordx4 v6, s[12:15], s28 offen offset:2048 sc1 lds
    buffer_load_dwordx4 v6, s[12:15], s28 offen offset:3072 sc1 lds
    s_mov_b32 m0, 60416
    s_add_u32 s28, s28, 5120
    buffer_load_dwordx4 v6, s[12:15], s22 offen sc1 lds
    s_and_b32 s34, s26, 0x400040
    s_cmp_eq_u32 s34, 0x400040
    s_cbranch_scc1 ND61
    s_mov_b32 s35, 0
NW60:
    buffer_load_dwordx2 v[10:11], v4, s[12:15], s18 offen sc1
    s_waitcnt vmcnt(0)
    v_mov_b32 v8, 6
    s_mov_b64 exec, 1
    ds_max_u32 v7, v8 offset:12
    s_mov_b64 exec, -1
    v_cmp_eq_u64 s[26:27], s[32:33], v[10:11]
    s_add_u32 s35, s35, 1
    s_and_b32 s34, s26, 0x400040
    s_cmp_eq_u32 s34, 0x400040
    s_cbranch_scc1 ND61
    s_cmp_lt_u32 s35, 0x100000
    s_cbranch_scc1 NW60
ND61:
    s_mov_b32 m0, 61440
    s_add_u32 s22, s20, 4096
    buffer_load_dwordx4 v6, s[12:15], s20 offen offset:0 sc1 lds
    buffer_load_dwordx4 v6, s[12:15], s20 offen offset:1024 sc1 lds
    buffer_load_dwordx4 v6, s[12:15], s20 offen offset:2048 sc1 lds
    buffer_load_dwordx4 v6, s[12:15], s20 offen offset:3072 sc1 lds
    s_mov_b32 m0, 65536
    s_add_u32 s20, s20, 5120
    buffer_load_dwordx4 v6, s[12:15], s22 offen sc1 lds
    s_mov_b32 m0, 66560
    s_add_u32 s22, s28, 4096
    buffer_load_dwordx4 v6, s[12:15], s28 offen offset:0 sc1 lds
    buffer_load_dwordx4 v6, s[12:15], s28 offen offset:1024 sc1 lds
    buffer_load_dwordx4 v6, s[12:15], s28 offen offset:2048 sc1 lds
    buffer_load_dwordx4 v6, s[12:15], s28 offen offset:3072 sc1 lds
    s_mov_b32 m0, 70656
    s_add_u32 s28, s28, 5120
    buffer_load_dwordx4 v6, s[12:15], s22 offen sc1 lds
    s_and_b32 s34, s26, 0x800080
    s_cmp_eq_u32 s34, 0x800080
    s_cbranch_scc1 ND63
    s_mov_b32 s35, 0
NW62:
    buffer_load_dwordx2 v[10:11], v4, s[12:15], s18 offen sc1
    s_waitcnt vmcnt(0)
    v_mov_b32 v8, 7
    s_mov_b64 exec, 1
    ds_max_u32 v7, v8 offset:12
    s_mov_b64 exec, -1
    v_cmp_eq_u64 s[26:27], s[32:33], v[10:11]
    s_add_u32 s35, s35, 1
    s_and_b32 s34, s26, 0x800080
    s_cmp_eq_u32 s34, 0x800080
    s_cbranch_scc1 ND63
    s_cmp_lt_u32 s35, 0x100000
    s_cbranch_scc1 NW62
ND63:
    s_mov_b32 m0, 71680
    s_add_u32 s22, s20, 4096
    buffer_load_dwordx4 v6, s[12:15], s20 offen offset:0 sc1 lds
    buffer_load_dwordx4 v6, s[12:15], s20 offen offset:1024 sc1 lds
    buffer_load_dwordx4 v6, s[12:15], s20 offen offset:2048 sc1 lds
    buffer_load_dwordx4 v6, s[12:15], s20 offen offset:3072 sc1 lds
    s_mov_b32 m0, 75776
    s_add_u32 s20, s20, 5120
    buffer_load_dwordx4 v6, s[12:15], s22 offen sc1 lds
    s_mov_b32 m0, 76800
    s_add_u32 s22, s28, 4096
    buffer_load_dwordx4 v6, s[12:15], s28 offen offset:0 sc1 lds
    buffer_load_dwordx4 v6, s[12:15], s28 offen offset:1024 sc1 lds
    buffer_load_dwordx4 v6, s[12:15], s28 offen offset:2048 sc1 lds
    buffer_load_dwordx4 v6, s[12:15], s28 offen offset:3072 sc1 lds
    s_mov_b32 m0, 80896
    s_add_u32 s28, s28, 5120
    buffer_load_dwordx4 v6, s[12:15], s22 offen sc1 lds
    s_waitcnt vmcnt(40)
    v_mov_b32 v8, 4
    s_mov_b64 exec, 1
    ds_max_u32 v7, v8 offset:12
    s_mov_b64 exec, -1
    s_and_b32 s34, s26, 0x1000100
    s_cmp_eq_u32 s34, 0x1000100
    s_cbranch_scc1 ND65
    s_mov_b32 s35, 0
NW64:
    buffer_load_dwordx2 v[10:11], v4, s[12:15], s18 offen sc1
    s_waitcnt vmcnt(0)
    v_mov_b32 v8, 8
    s_mov_b64 exec, 1
    ds_max_u32 v7, v8 offset:12
    s_mov_b64 exec, -1
    v_cmp_eq_u64 s[26:27], s[32:33], v[10:11]
    s_add_u32 s35, s35, 1
    s_and_b32 s34, s26, 0x1000100
    s_cmp_eq_u32 s34, 0x1000100
    s_cbranch_scc1 ND65
    s_cmp_lt_u32 s35, 0x100000
    s_cbranch_scc1 NW64
ND65:
    s_mov_b32 m0, 81920
    s_add_u32 s22, s20, 4096
    buffer_load_dwordx4 v6, s[12:15], s20 offen offset:0 sc1 lds
    buffer_load_dwordx4 v6, s[12:15], s20 offen offset:1024 sc1 lds
    buffer_load_dwordx4 v6, s[12:15], s20 offen offset:2048 sc1 lds
    buffer_load_dwordx4 v6, s[12:15], s20 offen offset:3072 sc1 lds
    s_mov_b32 m0, 86016
    s_add_u32 s20, s20, 5120
    buffer_load_dwordx4 v6, s[12:15], s22 offen sc1 lds
    s_mov_b32 m0, 87040
    s_add_u32 s22, s28, 4096
    buffer_load_dwordx4 v6, s[12:15], s28 offen offset:0 sc1 lds
    buffer_load_dwordx4 v6, s[12:15], s28 offen offset:1024 sc1 lds
    buffer_load_dwordx4 v6, s[12:15], s28 offen offset:2048 sc1 lds
    buffer_load_dwordx4 v6, s[12:15], s28 offen offset:3072 sc1 lds
    s_mov_b32 m0, 91136
    s_add_u32 s28, s28, 5120
    buffer_load_dwordx4 v6, s[12:15], s22 offen sc1 lds
    s_waitcnt vmcnt(40)
    v_mov_b32 v8, 5
    s_mov_b64 exec, 1
    ds_max_u32 v7, v8 offset:12
    s_mov_b64 exec, -1
    s_and_b32 s34, s26, 0x2000200
    s_cmp_eq_u32 s34, 0x2000200
    s_cbranch_scc1 ND67
    s_mov_b32 s35, 0
NW66:
    buffer_load_dwordx2 v[10:11], v4, s[12:15], s18 offen sc1
    s_waitcnt vmcnt(0)
    v_mov_b32 v8, 9
    s_mov_b64 exec, 1
    ds_max_u32 v7, v8 offset:12
    s_mov_b64 exec, -1
    v_cmp_eq_u64 s[26:27], s[32:33], v[10:11]
    s_add_u32 s35, s35, 1
    s_and_b32 s34, s26, 0x2000200
    s_cmp_eq_u32 s34, 0x2000200
    s_cbranch_scc1 ND67
    s_cmp_lt_u32 s35, 0x100000
    s_cbranch_scc1 NW66
ND67:
    s_mov_b32 m0, 92160
    s_add_u32 s22, s20, 4096
    buffer_load_dwordx4 v6, s[12:15], s20 offen offset:0 sc1 lds
    buffer_load_dwordx4 v6, s[12:15], s20 offen offset:1024 sc1 lds
    buffer_load_dwordx4 v6, s[12:15], s20 offen offset:2048 sc1 lds
    buffer_load_dwordx4 v6, s[12:15], s20 offen offset:3072 sc1 lds
    s_mov_b32 m0, 96256
    s_add_u32 s20, s20, 5120
    buffer_load_dwordx4 v6, s[12:15], s22 offen sc1 lds
    s_mov_b32 m0, 97280
    s_add_u32 s22, s28, 4096
    buffer_load_dwordx4 v6, s[12:15], s28 offen offset:0 sc1 lds
    buffer_load_dwordx4 v6, s[12:15], s28 offen offset:1024 sc1 lds
    buffer_load_dwordx4 v6, s[12:15], s28 offen offset:2048 sc1 lds
    buffer_load_dwordx4 v6, s[12:15], s28 offen offset:3072 sc1 lds
    s_mov_b32 m0, 101376
    s_add_u32 s28, s28, 5120
    buffer_load_dwordx4 v6, s[12:15], s22 offen sc1 lds
    s_waitcnt vmcnt(40)
    v_mov_b32 v8, 6
    s_mov_b64 exec, 1
    ds_max_u32 v7, v8 offset:12
    s_mov_b64 exec, -1
    s_and_b32 s34, s26, 0x4000400
    s_cmp_eq_u32 s34, 0x4000400
    s_cbranch_scc1 ND69
    s_mov_b32 s35, 0
NW68:
    buffer_load_dwordx2 v[10:11], v4, s[12:15], s18 offen sc1
    s_waitcnt vmcnt(0)
    v_mov_b32 v8, 10
    s_mov_b64 exec, 1
    ds_max_u32 v7, v8 offset:12
    s_mov_b64 exec, -1
    v_cmp_eq_u64 s[26:27], s[32:33], v[10:11]
    s_add_u32 s35, s35, 1
    s_and_b32 s34, s26, 0x4000400
    s_cmp_eq_u32 s34, 0x4000400
    s_cbranch_scc1 ND69
    s_cmp_lt_u32 s35, 0x100000
    s_cbranch_scc1 NW68
ND69:
    s_mov_b32 m0, 102400
    s_add_u32 s22, s20, 4096
    buffer_load_dwordx4 v6, s[12:15], s20 offen offset:0 sc1 lds
    buffer_load_dwordx4 v6, s[12:15], s20 offen offset:1024 sc1 lds
    buffer_load_dwordx4 v6, s[12:15], s20 offen offset:2048 sc1 lds
    buffer_load_dwordx4 v6, s[12:15], s20 offen offset:3072 sc1 lds
    s_mov_b32 m0, 106496
    s_add_u32 s20, s20, 5120
    buffer_load_dwordx4 v6, s[12:15], s22 offen sc1 lds
    s_mov_b32 m0, 107520
    s_add_u32 s22, s28, 4096
    buffer_load_dwordx4 v6, s[12:15], s28 offen offset:0 sc1 lds
    buffer_load_dwordx4 v6, s[12:15], s28 offen offset:1024 sc1 lds
    buffer_load_dwordx4 v6, s[12:15], s28 offen offset:2048 sc1 lds
    buffer_load_dwordx4 v6, s[12:15], s28 offen offset:3072 sc1 lds
    s_mov_b32 m0, 111616
    s_add_u32 s28, s28, 5120
    buffer_load_dwordx4 v6, s[12:15], s22 offen sc1 lds
    s_waitcnt vmcnt(40)
    v_mov_b32 v8, 7
    s_mov_b64 exec, 1
    ds_max_u32 v7, v8 offset:12
    s_mov_b64 exec, -1
    s_and_b32 s34, s26, 0x8000800
    s_cmp_eq_u32 s34, 0x8000800
    s_cbranch_scc1 ND71
    s_mov_b32 s35, 0
NW70:
    buffer_load_dwordx2 v[10:11], v4, s[12:15], s18 offen sc1
    s_waitcnt vmcnt(0)
    v_mov_b32 v8, 11
    s_mov_b64 exec, 1
    ds_max_u32 v7, v8 offset:12
    s_mov_b64 exec, -1
    v_cmp_eq_u64 s[26:27], s[32:33], v[10:11]
    s_add_u32 s35, s35, 1
    s_and_b32 s34, s26, 0x8000800
    s_cmp_eq_u32 s34, 0x8000800
    s_cbranch_scc1 ND71
    s_cmp_lt_u32 s35, 0x100000
    s_cbranch_scc1 NW70
ND71:
    s_mov_b32 m0, 112640
    s_add_u32 s22, s20, 4096
    buffer_load_dwordx4 v6, s[12:15], s20 offen offset:0 sc1 lds
    buffer_load_dwordx4 v6, s[12:15], s20 offen offset:1024 sc1 lds
    buffer_load_dwordx4 v6, s[12:15], s20 offen offset:2048 sc1 lds
    buffer_load_dwordx4 v6, s[12:15], s20 offen offset:3072 sc1 lds
    s_mov_b32 m0, 116736
    s_add_u32 s20, s20, 5120
    buffer_load_dwordx4 v6, s[12:15], s22 offen sc1 lds
    s_mov_b32 m0, 117760
    s_add_u32 s22, s28, 4096
    buffer_load_dwordx4 v6, s[12:15], s28 offen offset:0 sc1 lds
    buffer_load_dwordx4 v6, s[12:15], s28 offen offset:1024 sc1 lds
    buffer_load_dwordx4 v6, s[12:15], s28 offen offset:2048 sc1 lds
    buffer_load_dwordx4 v6, s[12:15], s28 offen offset:3072 sc1 lds
    s_mov_b32 m0, 121856
    s_add_u32 s28, s28, 5120
    buffer_load_dwordx4 v6, s[12:15], s22 offen sc1 lds
    s_waitcnt vmcnt(40)
    v_mov_b32 v8, 8
    s_mov_b64 exec, 1
    ds_max_u32 v7, v8 offset:12
    s_mov_b64 exec, -1
    s_and_b32 s34, s26, 0x10001000
    s_cmp_eq_u32 s34, 0x10001000
    s_cbranch_scc1 ND73
    s_mov_b32 s35, 0
NW72:
    buffer_load_dwordx2 v[10:11], v4, s[12:15], s18 offen sc1
    s_waitcnt vmcnt(0)
    v_mov_b32 v8, 12
    s_mov_b64 exec, 1
    ds_max_u32 v7, v8 offset:12
    s_mov_b64 exec, -1
    v_cmp_eq_u64 s[26:27], s[32:33], v[10:11]
    s_add_u32 s35, s35, 1
    s_and_b32 s34, s26, 0x10001000
    s_cmp_eq_u32 s34, 0x10001000
    s_cbranch_scc1 ND73
    s_cmp_lt_u32 s35, 0x100000
    s_cbranch_scc1 NW72
ND73:
KW74:
    ds_read_b96 v[10:12], v7 offset:16
    s_waitcnt lgkmcnt(0)
    v_and_b32 v10, v10, v11
    v_and_b32 v10, v10, v12
    s_nop 0
    v_readfirstlane_b32 s34, v10
    s_nop 0
    s_cmp_eq_u32 s34, 1
    s_cbranch_scc1 KD75
    s_waitcnt vmcnt(0)
    v_mov_b32 v8, 12
    s_mov_b64 exec, 1
    ds_max_u32 v7, v8 offset:12
    s_mov_b64 exec, -1
    s_sleep 1
    s_branch KW74
KD75:
    s_mov_b32 m0, 122880
    s_add_u32 s22, s20, 4096
    buffer_load_dwordx4 v6, s[12:15], s20 offen offset:0 sc1 lds
    buffer_load_dwordx4 v6, s[12:15], s20 offen offset:1024 sc1 lds
    buffer_load_dwordx4 v6, s[12:15], s20 offen offset:2048 sc1 lds
    buffer_load_dwordx4 v6, s[12:15], s20 offen offset:3072 sc1 lds
    s_mov_b32 m0, 126976
    s_add_u32 s20, s20, 5120
    buffer_load_dwordx4 v6, s[12:15], s22 offen sc1 lds
    s_mov_b32 m0, 128000
    s_add_u32 s22, s28, 4096
    buffer_load_dwordx4 v6, s[12:15], s28 offen offset:0 sc1 lds
    buffer_load_dwordx4 v6, s[12:15], s28 offen offset:1024 sc1 lds
    buffer_load_dwordx4 v6, s[12:15], s28 offen offset:2048 sc1 lds
    buffer_load_dwordx4 v6, s[12:15], s28 offen offset:3072 sc1 lds
    s_mov_b32 m0, 132096
    s_add_u32 s28, s28, 5120
    buffer_load_dwordx4 v6, s[12:15], s22 offen sc1 lds
    s_waitcnt vmcnt(40)
    v_mov_b32 v8, 9
    s_mov_b64 exec, 1
    ds_max_u32 v7, v8 offset:12
    s_mov_b64 exec, -1
    s_and_b32 s34, s26, 0x20002000
    s_cmp_eq_u32 s34, 0x20002000
    s_cbranch_scc1 ND77
    s_mov_b32 s35, 0
NW76:
    buffer_load_dwordx2 v[10:11], v4, s[12:15], s18 offen sc1
    s_waitcnt vmcnt(0)
    v_mov_b32 v8, 13
    s_mov_b64 exec, 1
    ds_max_u32 v7, v8 offset:12
    s_mov_b64 exec, -1
    v_cmp_eq_u64 s[26:27], s[32:33], v[10:11]
    s_add_u32 s35, s35, 1
    s_and_b32 s34, s26, 0x20002000
    s_cmp_eq_u32 s34, 0x20002000
    s_cbranch_scc1 ND77
    s_cmp_lt_u32 s35, 0x100000
    s_cbranch_scc1 NW76
ND77:
    s_mov_b32 m0, 133120
    s_add_u32 s22, s20, 4096
    buffer_load_dwordx4 v6, s[12:15], s20 offen offset:0 sc1 lds
    buffer_load_dwordx4 v6, s[12:15], s20 offen offset:1024 sc1 lds
    buffer_load_dwordx4 v6, s[12:15], s20 offen offset:2048 sc1 lds
    buffer_load_dwordx4 v6, s[12:15], s20 offen offset:3072 sc1 lds
    s_mov_b32 m0, 137216
    s_add_u32 s20, s20, 5120
    buffer_load_dwordx4 v6, s[12:15], s22 offen sc1 lds
    s_mov_b32 m0, 138240
    s_add_u32 s22, s28, 4096
    buffer_load_dwordx4 v6, s[12:15], s28 offen offset:0 sc1 lds
    buffer_load_dwordx4 v6, s[12:15], s28 offen offset:1024 sc1 lds
    buffer_load_dwordx4 v6, s[12:15], s28 offen offset:2048 sc1 lds
    buffer_load_dwordx4 v6, s[12:15], s28 offen offset:3072 sc1 lds
    s_mov_b32 m0, 142336
    s_add_u32 s28, s28, 5120
    buffer_load_dwordx4 v6, s[12:15], s22 offen sc1 lds
    s_waitcnt vmcnt(40)
    v_mov_b32 v8, 10
    s_mov_b64 exec, 1
    ds_max_u32 v7, v8 offset:12
    s_mov_b64 exec, -1
    s_and_b32 s34, s26, 0x40004000
    s_cmp_eq_u32 s34, 0x40004000
    s_cbranch_scc1 ND79
    s_mov_b32 s35, 0
NW78:
    buffer_load_dwordx2 v[10:11], v4, s[12:15], s18 offen sc1
    s_waitcnt vmcnt(0)
    v_mov_b32 v8, 14
    s_mov_b64 exec, 1
    ds_max_u32 v7, v8 offset:12
    s_mov_b64 exec, -1
    v_cmp_eq_u64 s[26:27], s[32:33], v[10:11]
    s_add_u32 s35, s35, 1
    s_and_b32 s34, s26, 0x40004000
    s_cmp_eq_u32 s34, 0x40004000
    s_cbranch_scc1 ND79
    s_cmp_lt_u32 s35, 0x100000
    s_cbranch_scc1 NW78
ND79:
    s_mov_b32 m0, 143360
    s_add_u32 s22, s20, 4096
    buffer_load_dwordx4 v6, s[12:15], s20 offen offset:0 sc1 lds
    buffer_load_dwordx4 v6, s[12:15], s20 offen offset:1024 sc1 lds
    buffer_load_dwordx4 v6, s[12:15], s20 offen offset:2048 sc1 lds
    buffer_load_dwordx4 v6, s[12:15], s20 offen offset:3072 sc1 lds
    s_mov_b32 m0, 147456
    s_add_u32 s20, s20, 5120
    buffer_load_dwordx4 v6, s[12:15], s22 offen sc1 lds
    s_mov_b32 m0, 148480
    s_add_u32 s22, s28, 4096
    buffer_load_dwordx4 v6, s[12:15], s28 offen offset:0 sc1 lds
    buffer_load_dwordx4 v6, s[12:15], s28 offen offset:1024 sc1 lds
    buffer_load_dwordx4 v6, s[12:15], s28 offen offset:2048 sc1 lds
    buffer_load_dwordx4 v6, s[12:15], s28 offen offset:3072 sc1 lds
    s_mov_b32 m0, 152576
    s_add_u32 s28, s28, 5120
    buffer_load_dwordx4 v6, s[12:15], s22 offen sc1 lds
    s_waitcnt vmcnt(40)
    v_mov_b32 v8, 11
    s_mov_b64 exec, 1
    ds_max_u32 v7, v8 offset:12
    s_mov_b64 exec, -1
    s_waitcnt vmcnt(30)
    v_mov_b32 v8, 12
    s_mov_b64 exec, 1
    ds_max_u32 v7, v8 offset:12
    s_mov_b64 exec, -1
    s_waitcnt vmcnt(20)
    v_mov_b32 v8, 13
    s_mov_b64 exec, 1
    ds_max_u32 v7, v8 offset:12
    s_mov_b64 exec, -1
    s_waitcnt vmcnt(10)
    v_mov_b32 v8, 14
    s_mov_b64 exec, 1
    ds_max_u32 v7, v8 offset:12
    s_mov_b64 exec, -1
    s_waitcnt vmcnt(0)
    v_mov_b32 v8, 15
    s_mov_b64 exec, 1
    ds_max_u32 v7, v8 offset:12
    s_mov_b64 exec, -1
    s_mov_b32 s35, 0
FP80:
    buffer_load_dwordx2 v[10:11], v5, s[12:15], s23 offen sc1
    s_waitcnt vmcnt(0)
    v_cmp_ne_u64 s[24:25], s[32:33], v[10:11]
    s_nop 0
    s_cmp_eq_u64 s[24:25], 0
    s_cbranch_scc1 FD81
    s_add_u32 s35, s35, 1
    s_sleep 1
    s_cmp_lt_u32 s35, 0x100000
    s_cbranch_scc1 FP80
FD81:
    v_mov_b32 v8, 1
    ds_write_b32 v7, v8 offset:64
    s_and_b32 s34, s26, 0x80008000
    s_cmp_eq_u32 s34, 0x80008000
    s_cbranch_scc1 ND83
    s_mov_b32 s35, 0
NW82:
    buffer_load_dwordx2 v[10:11], v4, s[12:15], s18 offen sc1
    s_waitcnt vmcnt(0)
    v_cmp_eq_u64 s[26:27], s[32:33], v[10:11]
    s_add_u32 s35, s35, 1
    s_and_b32 s34, s26, 0x80008000
    s_cmp_eq_u32 s34, 0x80008000
    s_cbranch_scc1 ND83
    s_cmp_lt_u32 s35, 0x100000
    s_cbranch_scc1 NW82
ND83:
    s_mov_b32 s21, s20
    s_setprio 0
    s_and_b32 s16, s2, 7
    s_lshr_b32 s17, s2, 3
    s_lshl_b32 s16, s16, 2
    s_and_b32 s18, s17, 3
    s_add_u32 s16, s16, s18
    s_lshr_b32 s17, s17, 2
    v_mul_u32_u24 v2, 26, v0
    v_lshrrev_b32 v2, 8, v2
    v_mul_u32_u24 v2, 1120, v2
    v_lshl_add_u32 v2, v0, 4, v2
    s_mul_i32 s20, s17, 160
    s_sub_u32 s20, s20, 6400
    s_mul_i32 s18, s17, 640
    s_add_u32 s18, s18, 16351232
    v_lshlrev_b32 v3, 3, v0
    v_and_b32 v4, 15, v0
    v_lshlrev_b32 v4, 3, v4
    v_add_u32 v4, s18, v4
    v_add_u32 v4, 512, v4
    v_and_b32 v5, 3, v0
    v_lshlrev_b32 v5, 3, v5
    s_lshl_b32 s19, s16, 5
    s_add_u32 s19, s19, 16359424
    v_add_u32 v5, s19, v5
    v_cmp_gt_u32 vcc, 32, v0
    s_nop 1
    v_cndmask_b32 v4, v5, v4, vcc
    s_mov_b32 s23, s20
    s_mov_b32 s19, 10240
PW86:
    s_sleep 8
    ds_read_b128 v[8:11], v7 offset:32
    ds_read_b128 v[12:15], v7 offset:48
    s_waitcnt lgkmcnt(0)
    v_min3_u32 v8, v8, v9, v10
    v_min3_u32 v11, v11, v12, v13
    v_min3_u32 v8, v8, v14, v15
    v_min_u32 v8, v8, v11
    s_nop 0
    v_readfirstlane_b32 s34, v8
    s_nop 0
    s_cmp_ge_u32 s34, 1
    s_cbranch_scc0 PW86
    s_mov_b32 s20, s21
    s_mov_b32 m0, 0
    s_add_u32 s22, s20, 4096
    buffer_load_dwordx4 v6, s[12:15], s20 offen offset:0 sc1 lds
    buffer_load_dwordx4 v6, s[12:15], s20 offen offset:1024 sc1 lds
    buffer_load_dwordx4 v6, s[12:15], s20 offen offset:2048 sc1 lds
    buffer_load_dwordx4 v6, s[12:15], s20 offen offset:3072 sc1 lds
    s_mov_b32 m0, 4096
    s_add_u32 s20, s20, 5120
    buffer_load_dwordx4 v6, s[12:15], s22 offen sc1 lds
    s_mov_b32 m0, 5120
    s_add_u32 s22, s28, 4096
    buffer_load_dwordx4 v6, s[12:15], s28 offen offset:0 sc1 lds
    buffer_load_dwordx4 v6, s[12:15], s28 offen offset:1024 sc1 lds
    buffer_load_dwordx4 v6, s[12:15], s28 offen offset:2048 sc1 lds
    buffer_load_dwordx4 v6, s[12:15], s28 offen offset:3072 sc1 lds
    s_mov_b32 m0, 9216
    s_add_u32 s28, s28, 5120
    buffer_load_dwordx4 v6, s[12:15], s22 offen sc1 lds
    s_mov_b32 exec_hi, 0x3ffff
WL87:
    s_add_u32 m0, s19, 0
    s_add_u32 s23, s23, 6400
    buffer_load_dwordx4 v2, s[4:7], s23 offen lds
    s_add_u32 m0, s19, 800
    s_add_u32 s23, s23, 6400
    buffer_load_dwordx4 v2, s[4:7], s23 offen lds
    s_add_u32 m0, s19, 1600
    s_add_u32 s23, s23, 6400
    buffer_load_dwordx4 v2, s[4:7], s23 offen lds
    s_add_u32 m0, s19, 2400
    s_add_u32 s23, s23, 6400
    buffer_load_dwordx4 v2, s[4:7], s23 offen lds
    s_add_u32 m0, s19, 3200
    s_add_u32 s23, s23, 6400
    buffer_load_dwordx4 v2, s[4:7], s23 offen lds
    s_add_u32 m0, s19, 4000
    s_add_u32 s23, s23, 6400
    buffer_load_dwordx4 v2, s[4:7], s23 offen lds
    s_add_u32 m0, s19, 4800
    s_add_u32 s23, s23, 6400
    buffer_load_dwordx4 v2, s[4:7], s23 offen lds
    s_add_u32 m0, s19, 5600
    s_add_u32 s23, s23, 6400
    buffer_load_dwordx4 v2, s[4:7], s23 offen lds
    s_add_u32 s19, s19, 6400
    s_waitcnt vmcnt(40)
    s_cmp_lt_u32 s19, 35840
    s_cbranch_scc1 WL87
    s_mov_b32 exec_hi, -1
PW88:
    s_sleep 8
    ds_read_b128 v[8:11], v7 offset:32
    ds_read_b128 v[12:15], v7 offset:48
    s_waitcnt lgkmcnt(0)
    v_min3_u32 v8, v8, v9, v10
    v_min3_u32 v11, v11, v12, v13
    v_min3_u32 v8, v8, v14, v15
    v_min_u32 v8, v8, v11
    s_nop 0
    v_readfirstlane_b32 s34, v8
    s_nop 0
    s_cmp_ge_u32 s34, 2
    s_cbranch_scc0 PW88
    s_waitcnt vmcnt(0)
    v_mov_b32 v8, 16
    s_mov_b64 exec, 1
    ds_max_u32 v7, v8 offset:12
    s_mov_b64 exec, -1
    s_mov_b32 exec_hi, 0x3ffff
WL89:
    s_add_u32 m0, s19, 0
    s_add_u32 s23, s23, 6400
    buffer_load_dwordx4 v2, s[4:7], s23 offen lds
    s_add_u32 m0, s19, 800
    s_add_u32 s23, s23, 6400
    buffer_load_dwordx4 v2, s[4:7], s23 offen lds
    s_add_u32 m0, s19, 1600
    s_add_u32 s23, s23, 6400
    buffer_load_dwordx4 v2, s[4:7], s23 offen lds
    s_add_u32 m0, s19, 2400
    s_add_u32 s23, s23, 6400
    buffer_load_dwordx4 v2, s[4:7], s23 offen lds
    s_add_u32 m0, s19, 3200
    s_add_u32 s23, s23, 6400
    buffer_load_dwordx4 v2, s[4:7], s23 offen lds
    s_add_u32 m0, s19, 4000
    s_add_u32 s23, s23, 6400
    buffer_load_dwordx4 v2, s[4:7], s23 offen lds
    s_add_u32 m0, s19, 4800
    s_add_u32 s23, s23, 6400
    buffer_load_dwordx4 v2, s[4:7], s23 offen lds
    s_add_u32 m0, s19, 5600
    s_add_u32 s23, s23, 6400
    buffer_load_dwordx4 v2, s[4:7], s23 offen lds
    s_add_u32 s19, s19, 6400
    s_waitcnt vmcnt(40)
    s_cmp_lt_u32 s19, 80640
    s_cbranch_scc1 WL89
    s_mov_b32 exec_hi, -1
PW90:
    s_sleep 8
    ds_read_b128 v[8:11], v7 offset:32
    ds_read_b128 v[12:15], v7 offset:48
    s_waitcnt lgkmcnt(0)
    v_min3_u32 v8, v8, v9, v10
    v_min3_u32 v11, v11, v12, v13
    v_min3_u32 v8, v8, v14, v15
    v_min_u32 v8, v8, v11
    s_nop 0
    v_readfirstlane_b32 s34, v8
    s_nop 0
    s_cmp_ge_u32 s34, 3
    s_cbranch_scc0 PW90
    s_mov_b32 exec_hi, 0x3ffff
WL91:
    s_add_u32 m0, s19, 0
    s_add_u32 s23, s23, 6400
    buffer_load_dwordx4 v2, s[4:7], s23 offen lds
    s_add_u32 m0, s19, 800
    s_add_u32 s23, s23, 6400
    buffer_load_dwordx4 v2, s[4:7], s23 offen lds
    s_add_u32 m0, s19, 1600
    s_add_u32 s23, s23, 6400
    buffer_load_dwordx4 v2, s[4:7], s23 offen lds
    s_add_u32 m0, s19, 2400
    s_add_u32 s23, s23, 6400
    buffer_load_dwordx4 v2, s[4:7], s23 offen lds
    s_add_u32 m0, s19, 3200
    s_add_u32 s23, s23, 6400
    buffer_load_dwordx4 v2, s[4:7], s23 offen lds
    s_add_u32 m0, s19, 4000
    s_add_u32 s23, s23, 6400
    buffer_load_dwordx4 v2, s[4:7], s23 offen lds
    s_add_u32 m0, s19, 4800
    s_add_u32 s23, s23, 6400
    buffer_load_dwordx4 v2, s[4:7], s23 offen lds
    s_add_u32 m0, s19, 5600
    s_add_u32 s23, s23, 6400
    buffer_load_dwordx4 v2, s[4:7], s23 offen lds
    s_add_u32 s19, s19, 6400
    s_waitcnt vmcnt(40)
    s_cmp_lt_u32 s19, 112640
    s_cbranch_scc1 WL91
    s_mov_b32 exec_hi, -1
    s_lshl_b32 s19, s16, 11
    s_add_u32 s19, s19, 16384000
    v_lshlrev_b32 v17, 5, v0
    s_mov_b32 s35, 0
    s_mov_b64 s[24:25], -1
    v_mov_b32 v16, 1
    s_setprio 3
FP92:
    buffer_load_dwordx2 v[14:15], v17, s[12:15], s19 offen sc1
    s_cmp_eq_u64 s[24:25], 0
    s_cbranch_scc1 FP92y
    buffer_load_dwordx2 v[10:11], v3, s[12:15], s18 offen sc1
    buffer_load_dwordx2 v[12:13], v4, s[12:15], 0 offen sc1
    s_waitcnt vmcnt(0)
    v_cmp_ne_u64 s[24:25], s[32:33], v[10:11]
    v_cmp_ne_u64 vcc, s[32:33], v[12:13]
    s_nop 0
    s_or_b64 s[24:25], s[24:25], vcc
    s_cmp_eq_u64 s[24:25], 0
    s_cbranch_scc0 FP92y
    ds_write_b32 v7, v16 offset:76
FP92y:
    s_waitcnt vmcnt(0)
    v_cmp_eq_u64 vcc, s[32:33], v[14:15]
    s_add_u32 s35, s35, 1
    s_nop 0
    v_mov_b32 v10, vcc_lo
    v_mov_b32 v11, vcc_hi
    ds_write_b64 v7, v[10:11] offset:80
    s_orn2_b64 s[26:27], s[24:25], vcc
    s_cmp_eq_u64 s[26:27], 0
    s_cbranch_scc1 FD93
    s_cmp_lt_u32 s35, 0x100000
    s_cbranch_scc1 FP92
FP92t:
    v_mov_b32 v10, -1
    v_mov_b32 v11, -1
    ds_write_b32 v7, v16 offset:76
    ds_write_b64 v7, v[10:11] offset:80
FD93:
    s_waitcnt lgkmcnt(0)
    s_endpgm
K_END:
    s_endpgm
.section .rodata,"a"
.p2align 6
.amdhsa_kernel gated_mix__softmax_full_mha__ssm_conv_s4__prompt_kernel
  .amdhsa_next_free_vgpr 168
  .amdhsa_next_free_sgpr 102
  .amdhsa_accum_offset 168
  .amdhsa_group_segment_fixed_size 0
  .amdhsa_kernarg_size 128
  .amdhsa_user_sgpr_count 2
  .amdhsa_user_sgpr_kernarg_segment_ptr 1
  .amdhsa_system_sgpr_workgroup_id_x 1
.end_amdhsa_kernel
```
